```python
import torch

def _softmax(x, axis=-1):
    return torch.softmax(x, dim=axis)

def _gelu(x):
    return torch.nn.functional.gelu(x, approximate='tanh')

def _silu(x):
    return torch.nn.functional.silu(x)

def _sigmoid(x):
    return torch.sigmoid(x)

def _layernorm(x, axis=-1, eps=1e-05):
    m = x.mean(dim=axis, keepdim=True)
    v = x.var(dim=axis, keepdim=True, unbiased=False)
    return (x - m) / torch.sqrt(v + eps)

def _scatter_add(tgt, idx, src, axis=0):
    return tgt.clone().index_add_(axis, idx, src)

def _segment_sum(src, seg, n):
    out = torch.zeros((n,) + src.shape[1:], dtype=src.dtype)
    return out.index_add_(0, seg, src)

def _pad(x, pw):
    flat = tuple((v for pair in reversed(pw) for v in pair))
    return torch.nn.functional.pad(x, flat)
kernel_name = 'adaLN_cond__memory_aug_recurrent_mem_tr__dense_activation_silu__prompt'

def setup_inputs():

    _w = lambda a: (lambda t: t.to(torch.bfloat16) if t.is_floating_point() else t)(torch.as_tensor(a))

    def _A_setup():
        B, S, Dm = (1, 2048, 512)
        H, Dh = (32, 128)
        M, seg = (8, 32)
        seg = min(seg, S)
        S = S // seg * seg
        return {'x': _w((lambda *s: torch.randn(*s, dtype=torch.bfloat16) * 0.05)(B, S, Dm)), 'mem0': _w((lambda *s: torch.randn(*s, dtype=torch.bfloat16) * 0.8)(B, M, Dm)), 'Wq': _w((lambda *s: torch.randn(*s, dtype=torch.bfloat16) * 1.6)(Dm, H, Dh) * Dm ** (-0.5)), 'Wk': _w((lambda *s: torch.randn(*s, dtype=torch.bfloat16) * 1.6)(Dm, H, Dh) * Dm ** (-0.5)), 'Wv': _w((lambda *s: torch.randn(*s, dtype=torch.bfloat16) * 0.8)(Dm, H, Dh) * Dm ** (-0.5)), 'Wo': _w((lambda *s: torch.randn(*s, dtype=torch.bfloat16) * 0.8)(H, Dh, Dm) * (H * Dh) ** (-0.5)), 'seg_len': seg}
    _A_in = _A_setup()

    def _B_setup():
        B, S, D, F = (1, 2048, 512, 1792)
        return {'x': _w((lambda *s: torch.randn(*s, dtype=torch.bfloat16) * 0.05)(B, S, D)), 'w1': _w((lambda *s: torch.randn(*s, dtype=torch.bfloat16) * 3.2)(D, F) * D ** (-0.5)), 'w2': _w((lambda *s: torch.randn(*s, dtype=torch.bfloat16) * 0.2)(F, D) * F ** (-0.5))}
    _B_in = _B_setup()
    return {'A_x': _A_in['x'], 'A_mem0': _A_in['mem0'], 'A_Wq': _A_in['Wq'], 'A_Wk': _A_in['Wk'], 'A_Wv': _A_in['Wv'], 'A_Wo': _A_in['Wo'], 'A_seg_len': _A_in['seg_len'], 'B_x': _B_in['x'], 'B_w1': _B_in['w1'], 'B_w2': _B_in['w2'], 'c': _w((lambda *s: torch.randn(*s, dtype=torch.bfloat16) * 0.1)(1, 512) * 8.0), 'w_mod': _w((lambda *s: torch.randn(*s, dtype=torch.bfloat16) * 0.1)(512, 6 * 512) * 512 ** (-0.5) * 8.0)}

def reference(A_x, A_mem0, A_Wq, A_Wk, A_Wv, A_Wo, A_seg_len, B_x, B_w1, B_w2, c, w_mod):

    def _A_ref(x, mem0, Wq, Wk, Wv, Wo, seg_len):
        B, S, Dm = x.shape
        H, Dh = (Wq.shape[1], Wq.shape[2])
        M = mem0.shape[1]
        scale = Dh ** (-0.5)
        n_seg = S // seg_len
        L = M + seg_len
        idx = torch.arange(L)
        mask = (idx[:, None] < M) | (idx[:, None] >= idx[None, :])
        mem = mem0
        outs = []
        for s in range(n_seg):
            xs = x[:, s * seg_len:(s + 1) * seg_len, :].clone()
            h = torch.concatenate([mem, xs], axis=1)
            q = torch.einsum('btd,dhe->bhte', h, Wq)
            k = torch.einsum('btd,dhe->bhte', h, Wk)
            v = torch.einsum('btd,dhe->bhte', h, Wv)
            scores = torch.einsum('bhqe,bhke->bhqk', q, k) * scale
            scores = torch.where(mask[None, None], scores, -1000000000.0)
            p = _softmax(scores, axis=-1)
            o = torch.einsum('bhqk,bhke->bhqe', p, v)
            o = torch.einsum('bhte,hed->btd', o, Wo)
            mem = o[:, :M, :].clone()
            outs.append(o[:, M:, :])
        return torch.concatenate(outs, axis=1)

    def _B_ref(x, w1, w2):
        h = torch.einsum('bsd,df->bsf', x, w1)
        h = _silu(h)
        out = torch.einsum('bsf,fd->bsd', h, w2)
        return out
    x = A_x
    mod = (_silu(c) @ w_mod).reshape(c.shape[0], 6, 1, -1)
    sa, ca, ga, sb, cb, gb = (mod[:, 0].clone(), mod[:, 1].clone(), mod[:, 2].clone(), mod[:, 3].clone(), mod[:, 4].clone(), mod[:, 5].clone())
    h = _layernorm(x, axis=-1) * (1 + ca) + sa
    x = x + ga * _A_ref(h, A_mem0, A_Wq, A_Wk, A_Wv, A_Wo, A_seg_len)
    h = _layernorm(x, axis=-1) * (1 + cb) + sb
    x = x + gb * _B_ref(h, B_w1, B_w2)
    return x
```

```asm
; @launch grid=(256,1,1) block=(256,1,1) lds=163840
.amdgcn_target "amdgcn-amd-amdhsa--gfx950"
.text
.globl adaLN_cond__memory_aug_recurrent_mem_tr__dense_activation_silu__prompt_kernel
.p2align 8
.type adaLN_cond__memory_aug_recurrent_mem_tr__dense_activation_silu__prompt_kernel,@function
adaLN_cond__memory_aug_recurrent_mem_tr__dense_activation_silu__prompt_kernel:
    s_cmp_ge_u32 s2, 256
    s_cbranch_scc1 L_end
    s_load_dwordx4 s[44:47], s[0:1], 104
    s_load_dwordx16 s[48:63], s[0:1], 0
    s_load_dwordx8 s[64:71], s[0:1], 64
    s_load_dwordx2 s[72:73], s[0:1], 96
    s_getreg_b32 s5, hwreg(HW_REG_XCC_ID, 0, 4)
    v_lshrrev_b32 v1, 6, v0
    s_and_b32 s5, s5, 7
    v_readfirstlane_b32 s3, v1
    s_lshl_b32 s6, s5, 2
    s_add_u32 s6, s6, 128
    s_cmp_eq_u32 s5, 0
    s_cselect_b32 s6, 0, s6
    s_waitcnt lgkmcnt(0)
    s_mov_b32 s16, s44
    s_and_b32 s17, s45, 0xffff
    s_mov_b32 s18, 0x100
    s_mov_b32 s19, 0x20000
    s_mov_b32 s8, s46
    s_and_b32 s9, s47, 0xffff
    s_mov_b32 s10, 0x10000000
    s_mov_b32 s11, 0x20000
    s_cmp_eq_u32 s3, 0
    s_cbranch_scc0 L_touch
    v_mov_b32 v1, 1
    s_mov_b64 exec, 1
    buffer_atomic_add v1, off, s[16:19], s6 sc0 sc1
    s_waitcnt vmcnt(0)
    v_mov_b32 v2, 0
    ds_write_b32 v2, v1
    s_waitcnt lgkmcnt(0)
    s_mov_b64 exec, -1
    s_branch L_rank_wait
L_touch:
    s_nop 8
    s_mov_b32 m0, 0x3400
    v_and_b32 v1, 63, v0
    v_lshlrev_b32 v1, 21, v1
    s_cmp_eq_u32 s3, 1
    s_cbranch_scc0 L_touch2
    s_getpc_b64 s[74:75]
L_pc0:
    v_and_b32 v3, 63, v0
    v_lshlrev_b32 v3, 7, v3
    v_min_u32 v4, L_end-L_pc0, v3
    global_load_lds_dword v4, s[74:75]
    v_add_u32 v3, 0x2000, v3
    v_min_u32 v4, L_end-L_pc0, v3
    global_load_lds_dword v4, s[74:75]
    v_add_u32 v3, 0x2000, v3
    v_min_u32 v4, L_end-L_pc0, v3
    global_load_lds_dword v4, s[74:75]
    v_add_u32 v3, 0x2000, v3
    v_min_u32 v4, L_end-L_pc0, v3
    global_load_lds_dword v4, s[74:75]
    v_add_u32 v3, 0x2000, v3
    v_min_u32 v4, L_end-L_pc0, v3
    global_load_lds_dword v4, s[74:75]
    v_add_u32 v3, 0x2000, v3
    v_min_u32 v4, L_end-L_pc0, v3
    global_load_lds_dword v4, s[74:75]
    v_add_u32 v3, 0x2000, v3
    v_min_u32 v4, L_end-L_pc0, v3
    global_load_lds_dword v4, s[74:75]
    s_branch L_rank_wait
L_touch2:
    s_cmp_eq_u32 s5, 0
    s_cbranch_scc0 L_nospec
    s_mov_b32 s12, s54
    s_and_b32 s13, s55, 0xffff
    s_mov_b32 s14, 0x400000
    s_mov_b32 s15, 0x20000
    v_and_b32 v3, 63, v0
    v_lshrrev_b32 v4, 4, v3
    v_and_b32 v3, 15, v3
    v_lshlrev_b32 v3, 4, v3
    v_lshl_add_u32 v3, v4, 13, v3
    s_lshr_b32 s20, s2, 3
    s_lshl_b32 s20, s20, 8
    s_sub_u32 s21, s3, 2
    s_mul_i32 s21, s21, 524288
    s_add_u32 s20, s20, s21
    s_mov_b32 m0, 0x8000
    s_nop 0
    buffer_load_dwordx4 v3, s[12:15], s20 offen lds
    s_add_u32 s20, s20, 32768
    buffer_load_dwordx4 v3, s[12:15], s20 offen lds
    s_add_u32 s20, s20, 32768
    buffer_load_dwordx4 v3, s[12:15], s20 offen lds
    s_add_u32 s20, s20, 32768
    buffer_load_dwordx4 v3, s[12:15], s20 offen lds
    s_add_u32 s20, s20, 32768
    buffer_load_dwordx4 v3, s[12:15], s20 offen lds
    s_add_u32 s20, s20, 32768
    buffer_load_dwordx4 v3, s[12:15], s20 offen lds
    s_add_u32 s20, s20, 32768
    buffer_load_dwordx4 v3, s[12:15], s20 offen lds
    s_add_u32 s20, s20, 32768
    buffer_load_dwordx4 v3, s[12:15], s20 offen lds
    s_add_u32 s20, s20, 32768
    buffer_load_dwordx4 v3, s[12:15], s20 offen lds
    s_add_u32 s20, s20, 32768
    buffer_load_dwordx4 v3, s[12:15], s20 offen lds
    s_add_u32 s20, s20, 32768
    buffer_load_dwordx4 v3, s[12:15], s20 offen lds
    s_add_u32 s20, s20, 32768
    buffer_load_dwordx4 v3, s[12:15], s20 offen lds
    s_add_u32 s20, s20, 32768
    buffer_load_dwordx4 v3, s[12:15], s20 offen lds
    s_add_u32 s20, s20, 32768
    buffer_load_dwordx4 v3, s[12:15], s20 offen lds
    s_add_u32 s20, s20, 32768
    buffer_load_dwordx4 v3, s[12:15], s20 offen lds
    s_add_u32 s20, s20, 32768
    buffer_load_dwordx4 v3, s[12:15], s20 offen lds
    s_mov_b32 m0, 0x3400
L_nospec:
    s_mov_b64 exec, 3
    s_cmp_eq_u32 s3, 2
    s_cbranch_scc0 L_touch3
    s_mov_b64 exec, -1
    s_branch L_rank_wait
L_touch3:
    s_cmp_eq_u32 s2, 0
    s_cbranch_scc0 L_touch4
    s_mov_b32 s20, 0x13000
    buffer_load_dword v2, off, s[8:11], s20 sc1
    s_waitcnt vmcnt(0)
    v_add_u32 v2, 1, v2
    v_lshlrev_b32 v3, 8, v2
    v_or_b32 v3, 0x80, v3
    buffer_store_dword v3, off, s[16:19], 0 offset:8 sc1
    buffer_store_dword v2, off, s[8:11], s20 sc1
L_touch4:
    s_mov_b64 exec, -1
L_rank_wait:
    s_barrier
    v_mov_b32 v2, 0
    ds_read_b32 v1, v2
    s_waitcnt lgkmcnt(0)
    v_readfirstlane_b32 s4, v1
    s_barrier
    s_cmp_ge_u32 s4, 32
    s_cbranch_scc1 L_fail
    s_cmp_eq_u32 s5, 0
    s_cbranch_scc1 L_role_chain
    s_cmp_lt_u32 s5, 3
    s_cbranch_scc1 L_role_qkv
    s_cmp_eq_u32 s5, 3
    s_cbranch_scc1 L_role_att
    s_load_dwordx4 s[60:63], s[0:1], 0
    s_load_dwordx4 s[64:67], s[0:1], 80
    s_lshl_b32 s20, s4, 2
    s_add_u32 s20, s20, s5
    s_sub_u32 s20, s20, 4
    s_mov_b32 s24, 0xbfb8aa3b
    v_and_b32 v1, 63, v0
    v_lshrrev_b32 v2, 4, v1
    v_and_b32 v3, 15, v1
    v_lshlrev_b32 v4, 4, v1
    v_lshlrev_b32 v5, 10, v3
    v_lshl_add_u32 v5, v2, 4, v5
    s_lshl_b32 s21, s20, 14
    s_lshl_b32 s22, s3, 8
    s_add_u32 s21, s21, s22
    s_waitcnt lgkmcnt(0)
    s_mov_b32 s12, s60
    s_and_b32 s13, s61, 0xffff
    s_mov_b32 s14, 0x200000
    s_mov_b32 s15, 0x20000
    buffer_load_dwordx4 v[16:19], v5, s[12:15], s21 offen offset:0
    buffer_load_dwordx4 v[20:23], v5, s[12:15], s21 offen offset:64
    buffer_load_dwordx4 v[24:27], v5, s[12:15], s21 offen offset:128
    buffer_load_dwordx4 v[28:31], v5, s[12:15], s21 offen offset:192
    s_cmp_lt_u32 s20, 96
    s_cbranch_scc1 L_nomod_1
    s_sub_u32 s25, s20, 96
    s_mov_b32 s28, s64
    s_and_b32 s29, s65, 0xffff
    s_mov_b32 s30, 0x400
    s_mov_b32 s31, 0x20000
    s_mov_b32 s32, s66
    s_and_b32 s33, s67, 0xffff
    s_mov_b32 s34, 0x300000
    s_mov_b32 s35, 0x20000
    v_lshrrev_b32 v6, 2, v0
    v_lshlrev_b32 v7, 1, v6
    buffer_load_ushort v32, v7, s[28:31], 0 offen offset:0
    buffer_load_ushort v33, v7, s[28:31], 0 offen offset:128
    buffer_load_ushort v34, v7, s[28:31], 0 offen offset:256
    buffer_load_ushort v35, v7, s[28:31], 0 offen offset:384
    buffer_load_ushort v36, v7, s[28:31], 0 offen offset:512
    buffer_load_ushort v37, v7, s[28:31], 0 offen offset:640
    buffer_load_ushort v38, v7, s[28:31], 0 offen offset:768
    buffer_load_ushort v39, v7, s[28:31], 0 offen offset:896
    s_mov_b32 s21, 6144
    v_mul_lo_u32 v8, v6, s21
    v_and_b32 v9, 3, v0
    v_lshl_add_u32 v8, v9, 4, v8
    s_lshl_b32 s21, s25, 6
    buffer_load_dwordx4 v[40:43], v8, s[32:35], s21 offen
    s_add_u32 s21, s21, 393216
    buffer_load_dwordx4 v[44:47], v8, s[32:35], s21 offen
    s_add_u32 s21, s21, 393216
    buffer_load_dwordx4 v[48:51], v8, s[32:35], s21 offen
    s_add_u32 s21, s21, 393216
    buffer_load_dwordx4 v[52:55], v8, s[32:35], s21 offen
    s_add_u32 s21, s21, 393216
    buffer_load_dwordx4 v[56:59], v8, s[32:35], s21 offen
    s_add_u32 s21, s21, 393216
    buffer_load_dwordx4 v[60:63], v8, s[32:35], s21 offen
    s_add_u32 s21, s21, 393216
    buffer_load_dwordx4 v[64:67], v8, s[32:35], s21 offen
    s_add_u32 s21, s21, 393216
    buffer_load_dwordx4 v[68:71], v8, s[32:35], s21 offen
    s_waitcnt vmcnt(8)
    v_lshlrev_b32 v32, 16, v32
    v_mul_f32 v10, s24, v32
    v_exp_f32 v10, v10
    s_nop 0
    v_add_f32 v10, 1.0, v10
    v_rcp_f32 v10, v10
    s_nop 0
    v_mul_f32 v32, v32, v10
    v_cvt_pk_bf16_f32 v32, v32, v32
    v_lshlrev_b32 v32, 16, v32
    v_lshlrev_b32 v33, 16, v33
    v_mul_f32 v10, s24, v33
    v_exp_f32 v10, v10
    s_nop 0
    v_add_f32 v10, 1.0, v10
    v_rcp_f32 v10, v10
    s_nop 0
    v_mul_f32 v33, v33, v10
    v_cvt_pk_bf16_f32 v33, v33, v33
    v_lshlrev_b32 v33, 16, v33
    v_lshlrev_b32 v34, 16, v34
    v_mul_f32 v10, s24, v34
    v_exp_f32 v10, v10
    s_nop 0
    v_add_f32 v10, 1.0, v10
    v_rcp_f32 v10, v10
    s_nop 0
    v_mul_f32 v34, v34, v10
    v_cvt_pk_bf16_f32 v34, v34, v34
    v_lshlrev_b32 v34, 16, v34
    v_lshlrev_b32 v35, 16, v35
    v_mul_f32 v10, s24, v35
    v_exp_f32 v10, v10
    s_nop 0
    v_add_f32 v10, 1.0, v10
    v_rcp_f32 v10, v10
    s_nop 0
    v_mul_f32 v35, v35, v10
    v_cvt_pk_bf16_f32 v35, v35, v35
    v_lshlrev_b32 v35, 16, v35
    v_lshlrev_b32 v36, 16, v36
    v_mul_f32 v10, s24, v36
    v_exp_f32 v10, v10
    s_nop 0
    v_add_f32 v10, 1.0, v10
    v_rcp_f32 v10, v10
    s_nop 0
    v_mul_f32 v36, v36, v10
    v_cvt_pk_bf16_f32 v36, v36, v36
    v_lshlrev_b32 v36, 16, v36
    v_lshlrev_b32 v37, 16, v37
    v_mul_f32 v10, s24, v37
    v_exp_f32 v10, v10
    s_nop 0
    v_add_f32 v10, 1.0, v10
    v_rcp_f32 v10, v10
    s_nop 0
    v_mul_f32 v37, v37, v10
    v_cvt_pk_bf16_f32 v37, v37, v37
    v_lshlrev_b32 v37, 16, v37
    v_lshlrev_b32 v38, 16, v38
    v_mul_f32 v10, s24, v38
    v_exp_f32 v10, v10
    s_nop 0
    v_add_f32 v10, 1.0, v10
    v_rcp_f32 v10, v10
    s_nop 0
    v_mul_f32 v38, v38, v10
    v_cvt_pk_bf16_f32 v38, v38, v38
    v_lshlrev_b32 v38, 16, v38
    v_lshlrev_b32 v39, 16, v39
    v_mul_f32 v10, s24, v39
    v_exp_f32 v10, v10
    s_nop 0
    v_add_f32 v10, 1.0, v10
    v_rcp_f32 v10, v10
    s_nop 0
    v_mul_f32 v39, v39, v10
    v_cvt_pk_bf16_f32 v39, v39, v39
    v_lshlrev_b32 v39, 16, v39
    s_waitcnt vmcnt(7)
    v_lshlrev_b32 v10, 16, v40
    v_and_b32 v11, 0xffff0000, v40
    v_mul_f32 v72, v32, v10
    v_mul_f32 v73, v32, v11
    v_lshlrev_b32 v10, 16, v41
    v_and_b32 v11, 0xffff0000, v41
    v_mul_f32 v74, v32, v10
    v_mul_f32 v75, v32, v11
    v_lshlrev_b32 v10, 16, v42
    v_and_b32 v11, 0xffff0000, v42
    v_mul_f32 v76, v32, v10
    v_mul_f32 v77, v32, v11
    v_lshlrev_b32 v10, 16, v43
    v_and_b32 v11, 0xffff0000, v43
    v_mul_f32 v78, v32, v10
    v_mul_f32 v79, v32, v11
    s_waitcnt vmcnt(6)
    v_lshlrev_b32 v10, 16, v44
    v_and_b32 v11, 0xffff0000, v44
    v_fmac_f32 v72, v33, v10
    v_fmac_f32 v73, v33, v11
    v_lshlrev_b32 v10, 16, v45
    v_and_b32 v11, 0xffff0000, v45
    v_fmac_f32 v74, v33, v10
    v_fmac_f32 v75, v33, v11
    v_lshlrev_b32 v10, 16, v46
    v_and_b32 v11, 0xffff0000, v46
    v_fmac_f32 v76, v33, v10
    v_fmac_f32 v77, v33, v11
    v_lshlrev_b32 v10, 16, v47
    v_and_b32 v11, 0xffff0000, v47
    v_fmac_f32 v78, v33, v10
    v_fmac_f32 v79, v33, v11
    s_waitcnt vmcnt(5)
    v_lshlrev_b32 v10, 16, v48
    v_and_b32 v11, 0xffff0000, v48
    v_fmac_f32 v72, v34, v10
    v_fmac_f32 v73, v34, v11
    v_lshlrev_b32 v10, 16, v49
    v_and_b32 v11, 0xffff0000, v49
    v_fmac_f32 v74, v34, v10
    v_fmac_f32 v75, v34, v11
    v_lshlrev_b32 v10, 16, v50
    v_and_b32 v11, 0xffff0000, v50
    v_fmac_f32 v76, v34, v10
    v_fmac_f32 v77, v34, v11
    v_lshlrev_b32 v10, 16, v51
    v_and_b32 v11, 0xffff0000, v51
    v_fmac_f32 v78, v34, v10
    v_fmac_f32 v79, v34, v11
    s_waitcnt vmcnt(4)
    v_lshlrev_b32 v10, 16, v52
    v_and_b32 v11, 0xffff0000, v52
    v_fmac_f32 v72, v35, v10
    v_fmac_f32 v73, v35, v11
    v_lshlrev_b32 v10, 16, v53
    v_and_b32 v11, 0xffff0000, v53
    v_fmac_f32 v74, v35, v10
    v_fmac_f32 v75, v35, v11
    v_lshlrev_b32 v10, 16, v54
    v_and_b32 v11, 0xffff0000, v54
    v_fmac_f32 v76, v35, v10
    v_fmac_f32 v77, v35, v11
    v_lshlrev_b32 v10, 16, v55
    v_and_b32 v11, 0xffff0000, v55
    v_fmac_f32 v78, v35, v10
    v_fmac_f32 v79, v35, v11
    s_waitcnt vmcnt(3)
    v_lshlrev_b32 v10, 16, v56
    v_and_b32 v11, 0xffff0000, v56
    v_fmac_f32 v72, v36, v10
    v_fmac_f32 v73, v36, v11
    v_lshlrev_b32 v10, 16, v57
    v_and_b32 v11, 0xffff0000, v57
    v_fmac_f32 v74, v36, v10
    v_fmac_f32 v75, v36, v11
    v_lshlrev_b32 v10, 16, v58
    v_and_b32 v11, 0xffff0000, v58
    v_fmac_f32 v76, v36, v10
    v_fmac_f32 v77, v36, v11
    v_lshlrev_b32 v10, 16, v59
    v_and_b32 v11, 0xffff0000, v59
    v_fmac_f32 v78, v36, v10
    v_fmac_f32 v79, v36, v11
    s_waitcnt vmcnt(2)
    v_lshlrev_b32 v10, 16, v60
    v_and_b32 v11, 0xffff0000, v60
    v_fmac_f32 v72, v37, v10
    v_fmac_f32 v73, v37, v11
    v_lshlrev_b32 v10, 16, v61
    v_and_b32 v11, 0xffff0000, v61
    v_fmac_f32 v74, v37, v10
    v_fmac_f32 v75, v37, v11
    v_lshlrev_b32 v10, 16, v62
    v_and_b32 v11, 0xffff0000, v62
    v_fmac_f32 v76, v37, v10
    v_fmac_f32 v77, v37, v11
    v_lshlrev_b32 v10, 16, v63
    v_and_b32 v11, 0xffff0000, v63
    v_fmac_f32 v78, v37, v10
    v_fmac_f32 v79, v37, v11
    s_waitcnt vmcnt(1)
    v_lshlrev_b32 v10, 16, v64
    v_and_b32 v11, 0xffff0000, v64
    v_fmac_f32 v72, v38, v10
    v_fmac_f32 v73, v38, v11
    v_lshlrev_b32 v10, 16, v65
    v_and_b32 v11, 0xffff0000, v65
    v_fmac_f32 v74, v38, v10
    v_fmac_f32 v75, v38, v11
    v_lshlrev_b32 v10, 16, v66
    v_and_b32 v11, 0xffff0000, v66
    v_fmac_f32 v76, v38, v10
    v_fmac_f32 v77, v38, v11
    v_lshlrev_b32 v10, 16, v67
    v_and_b32 v11, 0xffff0000, v67
    v_fmac_f32 v78, v38, v10
    v_fmac_f32 v79, v38, v11
    s_waitcnt vmcnt(0)
    v_lshlrev_b32 v10, 16, v68
    v_and_b32 v11, 0xffff0000, v68
    v_fmac_f32 v72, v39, v10
    v_fmac_f32 v73, v39, v11
    v_lshlrev_b32 v10, 16, v69
    v_and_b32 v11, 0xffff0000, v69
    v_fmac_f32 v74, v39, v10
    v_fmac_f32 v75, v39, v11
    v_lshlrev_b32 v10, 16, v70
    v_and_b32 v11, 0xffff0000, v70
    v_fmac_f32 v76, v39, v10
    v_fmac_f32 v77, v39, v11
    v_lshlrev_b32 v10, 16, v71
    v_and_b32 v11, 0xffff0000, v71
    v_fmac_f32 v78, v39, v10
    v_fmac_f32 v79, v39, v11
    v_lshlrev_b32 v10, 5, v6
    s_mov_b32 s21, 2080
    v_mad_u32_u24 v10, v9, s21, v10
    ds_write_b128 v10, v[72:75] offset:4096
    ds_write_b128 v10, v[76:79] offset:4112
    s_waitcnt lgkmcnt(0)
    s_barrier
    v_and_b32 v10, 31, v0
    v_lshrrev_b32 v11, 5, v0
    v_lshrrev_b32 v12, 3, v10
    v_mul_u32_u24 v12, 2080, v12
    v_and_b32 v13, 7, v10
    v_lshl_add_u32 v12, v13, 2, v12
    v_lshl_add_u32 v12, v11, 8, v12
    ds_read_b32 v72, v12 offset:4096
    ds_read_b32 v73, v12 offset:4128
    ds_read_b32 v74, v12 offset:4160
    ds_read_b32 v75, v12 offset:4192
    ds_read_b32 v76, v12 offset:4224
    ds_read_b32 v77, v12 offset:4256
    ds_read_b32 v78, v12 offset:4288
    ds_read_b32 v79, v12 offset:4320
    s_waitcnt lgkmcnt(0)
    v_add_f32 v72, v72, v73
    v_add_f32 v72, v72, v74
    v_add_f32 v72, v72, v75
    v_add_f32 v72, v72, v76
    v_add_f32 v72, v72, v77
    v_add_f32 v72, v72, v78
    v_add_f32 v72, v72, v79
    v_lshlrev_b32 v12, 2, v0
    ds_write_b32 v12, v72
    s_waitcnt lgkmcnt(0)
    s_barrier
    v_lshlrev_b32 v12, 2, v10
    ds_read_b32 v72, v12 offset:0
    ds_read_b32 v73, v12 offset:128
    ds_read_b32 v74, v12 offset:256
    ds_read_b32 v75, v12 offset:384
    ds_read_b32 v76, v12 offset:512
    ds_read_b32 v77, v12 offset:640
    ds_read_b32 v78, v12 offset:768
    ds_read_b32 v79, v12 offset:896
    s_waitcnt lgkmcnt(0)
    v_add_f32 v72, v72, v73
    v_add_f32 v72, v72, v74
    v_add_f32 v72, v72, v75
    v_add_f32 v72, v72, v76
    v_add_f32 v72, v72, v77
    v_add_f32 v72, v72, v78
    v_add_f32 v72, v72, v79
    s_nop 1
    v_mov_b32_dpp v73, v72 quad_perm:[1,0,3,2] row_mask:0xf bank_mask:0xf
    v_cvt_pk_bf16_f32 v72, v72, v73
    v_mov_b32 v13, 13056
    s_cmp_eq_u32 s3, 0
    s_cbranch_scc0 L_nb_2
    s_mov_b64 exec, 1
    s_mov_b32 s23, 0
L_gn_4:
    buffer_load_dword v12, off, s[16:19], 0 offset:8 sc1
    s_add_u32 s23, s23, 1
    s_cmp_gt_u32 s23, 100000
    s_cbranch_scc1 L_fail
    s_waitcnt vmcnt(0)
    v_readfirstlane_b32 s7, v12
    s_nop 0
    s_cmp_lg_u32 s7, 0
    s_cbranch_scc1 L_go_5
    s_sleep 10
    s_branch L_gn_4
L_go_5:
L_nh_3:
    ds_write_b32 v13, v12
    s_mov_b64 exec, -1
    s_waitcnt lgkmcnt(0)
L_nb_2:
    s_barrier
    ds_read_b32 v12, v13
    s_waitcnt lgkmcnt(0)
    v_readfirstlane_b32 s7, v12
    s_nop 1
    v_mov_b32 v73, s7
    v_lshlrev_b32 v12, 2, v10
    s_lshl_b32 s21, s25, 7
    s_add_u32 s21, s21, 0
    s_cmp_eq_u32 s3, 0
    s_cbranch_scc0 L_ms_6
    s_mov_b32 exec_lo, 0x55555555
    s_mov_b32 exec_hi, 0
    buffer_store_dwordx2 v[72:73], v12, s[8:11], s21 offen sc1
    s_mov_b64 exec, -1
L_ms_6:
L_nomod_1:
    s_waitcnt vmcnt(0)
    v_lshlrev_b32 v80, 16, v16
    v_and_b32 v81, 0xffff0000, v16
    v_lshlrev_b32 v82, 16, v17
    v_and_b32 v83, 0xffff0000, v17
    v_lshlrev_b32 v84, 16, v18
    v_and_b32 v85, 0xffff0000, v18
    v_lshlrev_b32 v86, 16, v19
    v_and_b32 v87, 0xffff0000, v19
    v_lshlrev_b32 v88, 16, v20
    v_and_b32 v89, 0xffff0000, v20
    v_lshlrev_b32 v90, 16, v21
    v_and_b32 v91, 0xffff0000, v21
    v_lshlrev_b32 v92, 16, v22
    v_and_b32 v93, 0xffff0000, v22
    v_lshlrev_b32 v94, 16, v23
    v_and_b32 v95, 0xffff0000, v23
    v_lshlrev_b32 v96, 16, v24
    v_and_b32 v97, 0xffff0000, v24
    v_lshlrev_b32 v98, 16, v25
    v_and_b32 v99, 0xffff0000, v25
    v_lshlrev_b32 v100, 16, v26
    v_and_b32 v101, 0xffff0000, v26
    v_lshlrev_b32 v102, 16, v27
    v_and_b32 v103, 0xffff0000, v27
    v_lshlrev_b32 v104, 16, v28
    v_and_b32 v105, 0xffff0000, v28
    v_lshlrev_b32 v106, 16, v29
    v_and_b32 v107, 0xffff0000, v29
    v_lshlrev_b32 v108, 16, v30
    v_and_b32 v109, 0xffff0000, v30
    v_lshlrev_b32 v110, 16, v31
    v_and_b32 v111, 0xffff0000, v31
    v_add_f32 v10, v80, v81
    v_add_f32 v10, v10, v82
    v_add_f32 v10, v10, v83
    v_add_f32 v10, v10, v84
    v_add_f32 v10, v10, v85
    v_add_f32 v10, v10, v86
    v_add_f32 v10, v10, v87
    v_add_f32 v10, v10, v88
    v_add_f32 v10, v10, v89
    v_add_f32 v10, v10, v90
    v_add_f32 v10, v10, v91
    v_add_f32 v10, v10, v92
    v_add_f32 v10, v10, v93
    v_add_f32 v10, v10, v94
    v_add_f32 v10, v10, v95
    v_add_f32 v10, v10, v96
    v_add_f32 v10, v10, v97
    v_add_f32 v10, v10, v98
    v_add_f32 v10, v10, v99
    v_add_f32 v10, v10, v100
    v_add_f32 v10, v10, v101
    v_add_f32 v10, v10, v102
    v_add_f32 v10, v10, v103
    v_add_f32 v10, v10, v104
    v_add_f32 v10, v10, v105
    v_add_f32 v10, v10, v106
    v_add_f32 v10, v10, v107
    v_add_f32 v10, v10, v108
    v_add_f32 v10, v10, v109
    v_add_f32 v10, v10, v110
    v_add_f32 v10, v10, v111
    v_mov_b32 v11, v10
    s_nop 1
    v_permlane32_swap_b32 v10, v11
    v_add_f32 v10, v10, v11
    v_mov_b32 v11, v10
    s_nop 1
    v_permlane16_swap_b32 v10, v11
    v_add_f32 v10, v10, v11
    s_lshl_b32 s21, s3, 6
    v_lshlrev_b32 v12, 2, v3
    v_add_u32 v13, s21, v12
    ds_write_b32 v13, v10 offset:12544
    s_waitcnt lgkmcnt(0)
    s_barrier
    ds_read_b32 v44, v12 offset:12544
    ds_read_b32 v45, v12 offset:12608
    ds_read_b32 v46, v12 offset:12672
    ds_read_b32 v47, v12 offset:12736
    s_waitcnt lgkmcnt(0)
    v_add_f32 v44, v44, v45
    v_add_f32 v46, v46, v47
    v_add_f32 v44, v44, v46
    v_mul_f32 v44, 0x3b000000, v44
    v_cvt_pk_bf16_f32 v48, v44, v44
    v_lshlrev_b32 v48, 16, v48
    v_sub_f32 v80, v80, v44
    v_sub_f32 v81, v81, v44
    v_sub_f32 v82, v82, v44
    v_sub_f32 v83, v83, v44
    v_sub_f32 v84, v84, v44
    v_sub_f32 v85, v85, v44
    v_sub_f32 v86, v86, v44
    v_sub_f32 v87, v87, v44
    v_sub_f32 v88, v88, v44
    v_sub_f32 v89, v89, v44
    v_sub_f32 v90, v90, v44
    v_sub_f32 v91, v91, v44
    v_sub_f32 v92, v92, v44
    v_sub_f32 v93, v93, v44
    v_sub_f32 v94, v94, v44
    v_sub_f32 v95, v95, v44
    v_sub_f32 v96, v96, v44
    v_sub_f32 v97, v97, v44
    v_sub_f32 v98, v98, v44
    v_sub_f32 v99, v99, v44
    v_sub_f32 v100, v100, v44
    v_sub_f32 v101, v101, v44
    v_sub_f32 v102, v102, v44
    v_sub_f32 v103, v103, v44
    v_sub_f32 v104, v104, v44
    v_sub_f32 v105, v105, v44
    v_sub_f32 v106, v106, v44
    v_sub_f32 v107, v107, v44
    v_sub_f32 v108, v108, v44
    v_sub_f32 v109, v109, v44
    v_sub_f32 v110, v110, v44
    v_sub_f32 v111, v111, v44
    v_mul_f32 v10, v80, v80
    v_fmac_f32 v10, v81, v81
    v_fmac_f32 v10, v82, v82
    v_fmac_f32 v10, v83, v83
    v_fmac_f32 v10, v84, v84
    v_fmac_f32 v10, v85, v85
    v_fmac_f32 v10, v86, v86
    v_fmac_f32 v10, v87, v87
    v_fmac_f32 v10, v88, v88
    v_fmac_f32 v10, v89, v89
    v_fmac_f32 v10, v90, v90
    v_fmac_f32 v10, v91, v91
    v_fmac_f32 v10, v92, v92
    v_fmac_f32 v10, v93, v93
    v_fmac_f32 v10, v94, v94
    v_fmac_f32 v10, v95, v95
    v_fmac_f32 v10, v96, v96
    v_fmac_f32 v10, v97, v97
    v_fmac_f32 v10, v98, v98
    v_fmac_f32 v10, v99, v99
    v_fmac_f32 v10, v100, v100
    v_fmac_f32 v10, v101, v101
    v_fmac_f32 v10, v102, v102
    v_fmac_f32 v10, v103, v103
    v_fmac_f32 v10, v104, v104
    v_fmac_f32 v10, v105, v105
    v_fmac_f32 v10, v106, v106
    v_fmac_f32 v10, v107, v107
    v_fmac_f32 v10, v108, v108
    v_fmac_f32 v10, v109, v109
    v_fmac_f32 v10, v110, v110
    v_fmac_f32 v10, v111, v111
    v_mov_b32 v11, v10
    s_nop 1
    v_permlane32_swap_b32 v10, v11
    v_add_f32 v10, v10, v11
    v_mov_b32 v11, v10
    s_nop 1
    v_permlane16_swap_b32 v10, v11
    v_add_f32 v10, v10, v11
    ds_write_b32 v13, v10 offset:12800
    s_waitcnt lgkmcnt(0)
    s_barrier
    ds_read_b32 v44, v12 offset:12800
    ds_read_b32 v45, v12 offset:12864
    ds_read_b32 v46, v12 offset:12928
    ds_read_b32 v47, v12 offset:12992
    s_waitcnt lgkmcnt(0)
    v_add_f32 v44, v44, v45
    v_add_f32 v46, v46, v47
    v_add_f32 v44, v44, v46
    v_mul_f32 v45, 0x3b000000, v44
    v_cvt_pk_bf16_f32 v45, v45, v45
    v_lshlrev_b32 v45, 16, v45
    v_add_f32 v45, 0x3727c5ac, v45
    v_cvt_pk_bf16_f32 v45, v45, v45
    v_lshlrev_b32 v45, 16, v45
    v_sqrt_f32 v45, v45
    s_nop 0
    v_cvt_pk_bf16_f32 v45, v45, v45
    v_lshlrev_b32 v45, 16, v45
    v_rcp_f32 v45, v45
    v_lshlrev_b32 v10, 16, v16
    v_and_b32 v11, 0xffff0000, v16
    v_sub_f32 v10, v10, v48
    v_sub_f32 v11, v11, v48
    v_cvt_pk_bf16_f32 v10, v10, v11
    v_lshlrev_b32 v12, 16, v10
    v_and_b32 v13, 0xffff0000, v10
    v_mul_f32 v12, v12, v45
    v_mul_f32 v13, v13, v45
    v_cvt_pk_bf16_f32 v10, v12, v13
    v_lshlrev_b32 v80, 16, v10
    v_and_b32 v81, 0xffff0000, v10
    v_lshlrev_b32 v10, 16, v17
    v_and_b32 v11, 0xffff0000, v17
    v_sub_f32 v10, v10, v48
    v_sub_f32 v11, v11, v48
    v_cvt_pk_bf16_f32 v10, v10, v11
    v_lshlrev_b32 v12, 16, v10
    v_and_b32 v13, 0xffff0000, v10
    v_mul_f32 v12, v12, v45
    v_mul_f32 v13, v13, v45
    v_cvt_pk_bf16_f32 v10, v12, v13
    v_lshlrev_b32 v82, 16, v10
    v_and_b32 v83, 0xffff0000, v10
    v_lshlrev_b32 v10, 16, v18
    v_and_b32 v11, 0xffff0000, v18
    v_sub_f32 v10, v10, v48
    v_sub_f32 v11, v11, v48
    v_cvt_pk_bf16_f32 v10, v10, v11
    v_lshlrev_b32 v12, 16, v10
    v_and_b32 v13, 0xffff0000, v10
    v_mul_f32 v12, v12, v45
    v_mul_f32 v13, v13, v45
    v_cvt_pk_bf16_f32 v10, v12, v13
    v_lshlrev_b32 v84, 16, v10
    v_and_b32 v85, 0xffff0000, v10
    v_lshlrev_b32 v10, 16, v19
    v_and_b32 v11, 0xffff0000, v19
    v_sub_f32 v10, v10, v48
    v_sub_f32 v11, v11, v48
    v_cvt_pk_bf16_f32 v10, v10, v11
    v_lshlrev_b32 v12, 16, v10
    v_and_b32 v13, 0xffff0000, v10
    v_mul_f32 v12, v12, v45
    v_mul_f32 v13, v13, v45
    v_cvt_pk_bf16_f32 v10, v12, v13
    v_lshlrev_b32 v86, 16, v10
    v_and_b32 v87, 0xffff0000, v10
    v_lshlrev_b32 v10, 16, v20
    v_and_b32 v11, 0xffff0000, v20
    v_sub_f32 v10, v10, v48
    v_sub_f32 v11, v11, v48
    v_cvt_pk_bf16_f32 v10, v10, v11
    v_lshlrev_b32 v12, 16, v10
    v_and_b32 v13, 0xffff0000, v10
    v_mul_f32 v12, v12, v45
    v_mul_f32 v13, v13, v45
    v_cvt_pk_bf16_f32 v10, v12, v13
    v_lshlrev_b32 v88, 16, v10
    v_and_b32 v89, 0xffff0000, v10
    v_lshlrev_b32 v10, 16, v21
    v_and_b32 v11, 0xffff0000, v21
    v_sub_f32 v10, v10, v48
    v_sub_f32 v11, v11, v48
    v_cvt_pk_bf16_f32 v10, v10, v11
    v_lshlrev_b32 v12, 16, v10
    v_and_b32 v13, 0xffff0000, v10
    v_mul_f32 v12, v12, v45
    v_mul_f32 v13, v13, v45
    v_cvt_pk_bf16_f32 v10, v12, v13
    v_lshlrev_b32 v90, 16, v10
    v_and_b32 v91, 0xffff0000, v10
    v_lshlrev_b32 v10, 16, v22
    v_and_b32 v11, 0xffff0000, v22
    v_sub_f32 v10, v10, v48
    v_sub_f32 v11, v11, v48
    v_cvt_pk_bf16_f32 v10, v10, v11
    v_lshlrev_b32 v12, 16, v10
    v_and_b32 v13, 0xffff0000, v10
    v_mul_f32 v12, v12, v45
    v_mul_f32 v13, v13, v45
    v_cvt_pk_bf16_f32 v10, v12, v13
    v_lshlrev_b32 v92, 16, v10
    v_and_b32 v93, 0xffff0000, v10
    v_lshlrev_b32 v10, 16, v23
    v_and_b32 v11, 0xffff0000, v23
    v_sub_f32 v10, v10, v48
    v_sub_f32 v11, v11, v48
    v_cvt_pk_bf16_f32 v10, v10, v11
    v_lshlrev_b32 v12, 16, v10
    v_and_b32 v13, 0xffff0000, v10
    v_mul_f32 v12, v12, v45
    v_mul_f32 v13, v13, v45
    v_cvt_pk_bf16_f32 v10, v12, v13
    v_lshlrev_b32 v94, 16, v10
    v_and_b32 v95, 0xffff0000, v10
    v_lshlrev_b32 v10, 16, v24
    v_and_b32 v11, 0xffff0000, v24
    v_sub_f32 v10, v10, v48
    v_sub_f32 v11, v11, v48
    v_cvt_pk_bf16_f32 v10, v10, v11
    v_lshlrev_b32 v12, 16, v10
    v_and_b32 v13, 0xffff0000, v10
    v_mul_f32 v12, v12, v45
    v_mul_f32 v13, v13, v45
    v_cvt_pk_bf16_f32 v10, v12, v13
    v_lshlrev_b32 v96, 16, v10
    v_and_b32 v97, 0xffff0000, v10
    v_lshlrev_b32 v10, 16, v25
    v_and_b32 v11, 0xffff0000, v25
    v_sub_f32 v10, v10, v48
    v_sub_f32 v11, v11, v48
    v_cvt_pk_bf16_f32 v10, v10, v11
    v_lshlrev_b32 v12, 16, v10
    v_and_b32 v13, 0xffff0000, v10
    v_mul_f32 v12, v12, v45
    v_mul_f32 v13, v13, v45
    v_cvt_pk_bf16_f32 v10, v12, v13
    v_lshlrev_b32 v98, 16, v10
    v_and_b32 v99, 0xffff0000, v10
    v_lshlrev_b32 v10, 16, v26
    v_and_b32 v11, 0xffff0000, v26
    v_sub_f32 v10, v10, v48
    v_sub_f32 v11, v11, v48
    v_cvt_pk_bf16_f32 v10, v10, v11
    v_lshlrev_b32 v12, 16, v10
    v_and_b32 v13, 0xffff0000, v10
    v_mul_f32 v12, v12, v45
    v_mul_f32 v13, v13, v45
    v_cvt_pk_bf16_f32 v10, v12, v13
    v_lshlrev_b32 v100, 16, v10
    v_and_b32 v101, 0xffff0000, v10
    v_lshlrev_b32 v10, 16, v27
    v_and_b32 v11, 0xffff0000, v27
    v_sub_f32 v10, v10, v48
    v_sub_f32 v11, v11, v48
    v_cvt_pk_bf16_f32 v10, v10, v11
    v_lshlrev_b32 v12, 16, v10
    v_and_b32 v13, 0xffff0000, v10
    v_mul_f32 v12, v12, v45
    v_mul_f32 v13, v13, v45
    v_cvt_pk_bf16_f32 v10, v12, v13
    v_lshlrev_b32 v102, 16, v10
    v_and_b32 v103, 0xffff0000, v10
    v_lshlrev_b32 v10, 16, v28
    v_and_b32 v11, 0xffff0000, v28
    v_sub_f32 v10, v10, v48
    v_sub_f32 v11, v11, v48
    v_cvt_pk_bf16_f32 v10, v10, v11
    v_lshlrev_b32 v12, 16, v10
    v_and_b32 v13, 0xffff0000, v10
    v_mul_f32 v12, v12, v45
    v_mul_f32 v13, v13, v45
    v_cvt_pk_bf16_f32 v10, v12, v13
    v_lshlrev_b32 v104, 16, v10
    v_and_b32 v105, 0xffff0000, v10
    v_lshlrev_b32 v10, 16, v29
    v_and_b32 v11, 0xffff0000, v29
    v_sub_f32 v10, v10, v48
    v_sub_f32 v11, v11, v48
    v_cvt_pk_bf16_f32 v10, v10, v11
    v_lshlrev_b32 v12, 16, v10
    v_and_b32 v13, 0xffff0000, v10
    v_mul_f32 v12, v12, v45
    v_mul_f32 v13, v13, v45
    v_cvt_pk_bf16_f32 v10, v12, v13
    v_lshlrev_b32 v106, 16, v10
    v_and_b32 v107, 0xffff0000, v10
    v_lshlrev_b32 v10, 16, v30
    v_and_b32 v11, 0xffff0000, v30
    v_sub_f32 v10, v10, v48
    v_sub_f32 v11, v11, v48
    v_cvt_pk_bf16_f32 v10, v10, v11
    v_lshlrev_b32 v12, 16, v10
    v_and_b32 v13, 0xffff0000, v10
    v_mul_f32 v12, v12, v45
    v_mul_f32 v13, v13, v45
    v_cvt_pk_bf16_f32 v10, v12, v13
    v_lshlrev_b32 v108, 16, v10
    v_and_b32 v109, 0xffff0000, v10
    v_lshlrev_b32 v10, 16, v31
    v_and_b32 v11, 0xffff0000, v31
    v_sub_f32 v10, v10, v48
    v_sub_f32 v11, v11, v48
    v_cvt_pk_bf16_f32 v10, v10, v11
    v_lshlrev_b32 v12, 16, v10
    v_and_b32 v13, 0xffff0000, v10
    v_mul_f32 v12, v12, v45
    v_mul_f32 v13, v13, v45
    v_cvt_pk_bf16_f32 v10, v12, v13
    v_lshlrev_b32 v110, 16, v10
    v_and_b32 v111, 0xffff0000, v10
    s_cmp_ge_u32 s20, 96
    s_cbranch_scc1 L_hn_7
    v_mov_b32 v11, 13056
    s_cmp_eq_u32 s3, 0
    s_cbranch_scc0 L_nb_8
    s_mov_b64 exec, 1
    s_mov_b32 s23, 0
L_gn_10:
    buffer_load_dword v10, off, s[16:19], 0 offset:8 sc1
    s_add_u32 s23, s23, 1
    s_cmp_gt_u32 s23, 100000
    s_cbranch_scc1 L_fail
    s_waitcnt vmcnt(0)
    v_readfirstlane_b32 s7, v10
    s_nop 0
    s_cmp_lg_u32 s7, 0
    s_cbranch_scc1 L_go_11
    s_sleep 10
    s_branch L_gn_10
L_go_11:
L_nh_9:
    ds_write_b32 v11, v10
    s_mov_b64 exec, -1
    s_waitcnt lgkmcnt(0)
L_nb_8:
    s_barrier
    ds_read_b32 v10, v11
    s_waitcnt lgkmcnt(0)
    v_readfirstlane_b32 s7, v10
L_hn_7:
    v_lshlrev_b32 v10, 5, v2
    s_lshl_b32 s21, s3, 9
    s_add_u32 s21, s21, 0
    s_mov_b32 s23, 0
L_lm_12:
    buffer_load_dwordx4 v[112:115], v10, s[8:11], s21 offen offset:0 sc1
    buffer_load_dwordx4 v[144:147], v10, s[8:11], s21 offen offset:2048 sc1
    buffer_load_dwordx4 v[116:119], v10, s[8:11], s21 offen offset:16 sc1
    buffer_load_dwordx4 v[148:151], v10, s[8:11], s21 offen offset:2064 sc1
    buffer_load_dwordx4 v[120:123], v10, s[8:11], s21 offen offset:128 sc1
    buffer_load_dwordx4 v[152:155], v10, s[8:11], s21 offen offset:2176 sc1
    buffer_load_dwordx4 v[124:127], v10, s[8:11], s21 offen offset:144 sc1
    buffer_load_dwordx4 v[156:159], v10, s[8:11], s21 offen offset:2192 sc1
    buffer_load_dwordx4 v[128:131], v10, s[8:11], s21 offen offset:256 sc1
    buffer_load_dwordx4 v[160:163], v10, s[8:11], s21 offen offset:2304 sc1
    buffer_load_dwordx4 v[132:135], v10, s[8:11], s21 offen offset:272 sc1
    buffer_load_dwordx4 v[164:167], v10, s[8:11], s21 offen offset:2320 sc1
    buffer_load_dwordx4 v[136:139], v10, s[8:11], s21 offen offset:384 sc1
    buffer_load_dwordx4 v[168:171], v10, s[8:11], s21 offen offset:2432 sc1
    buffer_load_dwordx4 v[140:143], v10, s[8:11], s21 offen offset:400 sc1
    buffer_load_dwordx4 v[172:175], v10, s[8:11], s21 offen offset:2448 sc1
    s_add_u32 s23, s23, 1
    s_cmp_gt_u32 s23, 100000
    s_cbranch_scc1 L_fail
    s_waitcnt vmcnt(0)
    v_xor_b32 v11, s7, v113
    v_bitop3_b32 v11, v11, v115, s7 bitop3:0xf6
    v_bitop3_b32 v11, v11, v117, s7 bitop3:0xf6
    v_bitop3_b32 v11, v11, v119, s7 bitop3:0xf6
    v_bitop3_b32 v11, v11, v121, s7 bitop3:0xf6
    v_bitop3_b32 v11, v11, v123, s7 bitop3:0xf6
    v_bitop3_b32 v11, v11, v125, s7 bitop3:0xf6
    v_bitop3_b32 v11, v11, v127, s7 bitop3:0xf6
    v_bitop3_b32 v11, v11, v129, s7 bitop3:0xf6
    v_bitop3_b32 v11, v11, v131, s7 bitop3:0xf6
    v_bitop3_b32 v11, v11, v133, s7 bitop3:0xf6
    v_bitop3_b32 v11, v11, v135, s7 bitop3:0xf6
    v_bitop3_b32 v11, v11, v137, s7 bitop3:0xf6
    v_bitop3_b32 v11, v11, v139, s7 bitop3:0xf6
    v_bitop3_b32 v11, v11, v141, s7 bitop3:0xf6
    v_bitop3_b32 v11, v11, v143, s7 bitop3:0xf6
    v_bitop3_b32 v11, v11, v145, s7 bitop3:0xf6
    v_bitop3_b32 v11, v11, v147, s7 bitop3:0xf6
    v_bitop3_b32 v11, v11, v149, s7 bitop3:0xf6
    v_bitop3_b32 v11, v11, v151, s7 bitop3:0xf6
    v_bitop3_b32 v11, v11, v153, s7 bitop3:0xf6
    v_bitop3_b32 v11, v11, v155, s7 bitop3:0xf6
    v_bitop3_b32 v11, v11, v157, s7 bitop3:0xf6
    v_bitop3_b32 v11, v11, v159, s7 bitop3:0xf6
    v_bitop3_b32 v11, v11, v161, s7 bitop3:0xf6
    v_bitop3_b32 v11, v11, v163, s7 bitop3:0xf6
    v_bitop3_b32 v11, v11, v165, s7 bitop3:0xf6
    v_bitop3_b32 v11, v11, v167, s7 bitop3:0xf6
    v_bitop3_b32 v11, v11, v169, s7 bitop3:0xf6
    v_bitop3_b32 v11, v11, v171, s7 bitop3:0xf6
    v_bitop3_b32 v11, v11, v173, s7 bitop3:0xf6
    v_bitop3_b32 v11, v11, v175, s7 bitop3:0xf6
    v_cmp_ne_u32 vcc, 0, v11
    s_cbranch_vccz L_ln_13
    s_sleep 4
    s_branch L_lm_12
L_ln_13:
    v_lshlrev_b32 v10, 16, v144
    v_and_b32 v11, 0xffff0000, v144
    v_add_f32 v10, 1.0, v10
    v_add_f32 v11, 1.0, v11
    v_cvt_pk_bf16_f32 v10, v10, v11
    v_lshlrev_b32 v12, 16, v10
    v_and_b32 v13, 0xffff0000, v10
    v_mul_f32 v12, v80, v12
    v_mul_f32 v13, v81, v13
    v_cvt_pk_bf16_f32 v10, v12, v13
    v_lshlrev_b32 v12, 16, v10
    v_and_b32 v13, 0xffff0000, v10
    v_lshlrev_b32 v10, 16, v112
    v_and_b32 v11, 0xffff0000, v112
    v_add_f32 v12, v12, v10
    v_add_f32 v13, v13, v11
    v_cvt_pk_bf16_f32 v16, v12, v13
    v_lshlrev_b32 v10, 16, v146
    v_and_b32 v11, 0xffff0000, v146
    v_add_f32 v10, 1.0, v10
    v_add_f32 v11, 1.0, v11
    v_cvt_pk_bf16_f32 v10, v10, v11
    v_lshlrev_b32 v12, 16, v10
    v_and_b32 v13, 0xffff0000, v10
    v_mul_f32 v12, v82, v12
    v_mul_f32 v13, v83, v13
    v_cvt_pk_bf16_f32 v10, v12, v13
    v_lshlrev_b32 v12, 16, v10
    v_and_b32 v13, 0xffff0000, v10
    v_lshlrev_b32 v10, 16, v114
    v_and_b32 v11, 0xffff0000, v114
    v_add_f32 v12, v12, v10
    v_add_f32 v13, v13, v11
    v_cvt_pk_bf16_f32 v17, v12, v13
    v_lshlrev_b32 v10, 16, v148
    v_and_b32 v11, 0xffff0000, v148
    v_add_f32 v10, 1.0, v10
    v_add_f32 v11, 1.0, v11
    v_cvt_pk_bf16_f32 v10, v10, v11
    v_lshlrev_b32 v12, 16, v10
    v_and_b32 v13, 0xffff0000, v10
    v_mul_f32 v12, v84, v12
    v_mul_f32 v13, v85, v13
    v_cvt_pk_bf16_f32 v10, v12, v13
    v_lshlrev_b32 v12, 16, v10
    v_and_b32 v13, 0xffff0000, v10
    v_lshlrev_b32 v10, 16, v116
    v_and_b32 v11, 0xffff0000, v116
    v_add_f32 v12, v12, v10
    v_add_f32 v13, v13, v11
    v_cvt_pk_bf16_f32 v18, v12, v13
    v_lshlrev_b32 v10, 16, v150
    v_and_b32 v11, 0xffff0000, v150
    v_add_f32 v10, 1.0, v10
    v_add_f32 v11, 1.0, v11
    v_cvt_pk_bf16_f32 v10, v10, v11
    v_lshlrev_b32 v12, 16, v10
    v_and_b32 v13, 0xffff0000, v10
    v_mul_f32 v12, v86, v12
    v_mul_f32 v13, v87, v13
    v_cvt_pk_bf16_f32 v10, v12, v13
    v_lshlrev_b32 v12, 16, v10
    v_and_b32 v13, 0xffff0000, v10
    v_lshlrev_b32 v10, 16, v118
    v_and_b32 v11, 0xffff0000, v118
    v_add_f32 v12, v12, v10
    v_add_f32 v13, v13, v11
    v_cvt_pk_bf16_f32 v19, v12, v13
    v_lshlrev_b32 v10, 16, v152
    v_and_b32 v11, 0xffff0000, v152
    v_add_f32 v10, 1.0, v10
    v_add_f32 v11, 1.0, v11
    v_cvt_pk_bf16_f32 v10, v10, v11
    v_lshlrev_b32 v12, 16, v10
    v_and_b32 v13, 0xffff0000, v10
    v_mul_f32 v12, v88, v12
    v_mul_f32 v13, v89, v13
    v_cvt_pk_bf16_f32 v10, v12, v13
    v_lshlrev_b32 v12, 16, v10
    v_and_b32 v13, 0xffff0000, v10
    v_lshlrev_b32 v10, 16, v120
    v_and_b32 v11, 0xffff0000, v120
    v_add_f32 v12, v12, v10
    v_add_f32 v13, v13, v11
    v_cvt_pk_bf16_f32 v20, v12, v13
    v_lshlrev_b32 v10, 16, v154
    v_and_b32 v11, 0xffff0000, v154
    v_add_f32 v10, 1.0, v10
    v_add_f32 v11, 1.0, v11
    v_cvt_pk_bf16_f32 v10, v10, v11
    v_lshlrev_b32 v12, 16, v10
    v_and_b32 v13, 0xffff0000, v10
    v_mul_f32 v12, v90, v12
    v_mul_f32 v13, v91, v13
    v_cvt_pk_bf16_f32 v10, v12, v13
    v_lshlrev_b32 v12, 16, v10
    v_and_b32 v13, 0xffff0000, v10
    v_lshlrev_b32 v10, 16, v122
    v_and_b32 v11, 0xffff0000, v122
    v_add_f32 v12, v12, v10
    v_add_f32 v13, v13, v11
    v_cvt_pk_bf16_f32 v21, v12, v13
    v_lshlrev_b32 v10, 16, v156
    v_and_b32 v11, 0xffff0000, v156
    v_add_f32 v10, 1.0, v10
    v_add_f32 v11, 1.0, v11
    v_cvt_pk_bf16_f32 v10, v10, v11
    v_lshlrev_b32 v12, 16, v10
    v_and_b32 v13, 0xffff0000, v10
    v_mul_f32 v12, v92, v12
    v_mul_f32 v13, v93, v13
    v_cvt_pk_bf16_f32 v10, v12, v13
    v_lshlrev_b32 v12, 16, v10
    v_and_b32 v13, 0xffff0000, v10
    v_lshlrev_b32 v10, 16, v124
    v_and_b32 v11, 0xffff0000, v124
    v_add_f32 v12, v12, v10
    v_add_f32 v13, v13, v11
    v_cvt_pk_bf16_f32 v22, v12, v13
    v_lshlrev_b32 v10, 16, v158
    v_and_b32 v11, 0xffff0000, v158
    v_add_f32 v10, 1.0, v10
    v_add_f32 v11, 1.0, v11
    v_cvt_pk_bf16_f32 v10, v10, v11
    v_lshlrev_b32 v12, 16, v10
    v_and_b32 v13, 0xffff0000, v10
    v_mul_f32 v12, v94, v12
    v_mul_f32 v13, v95, v13
    v_cvt_pk_bf16_f32 v10, v12, v13
    v_lshlrev_b32 v12, 16, v10
    v_and_b32 v13, 0xffff0000, v10
    v_lshlrev_b32 v10, 16, v126
    v_and_b32 v11, 0xffff0000, v126
    v_add_f32 v12, v12, v10
    v_add_f32 v13, v13, v11
    v_cvt_pk_bf16_f32 v23, v12, v13
    v_lshlrev_b32 v10, 16, v160
    v_and_b32 v11, 0xffff0000, v160
    v_add_f32 v10, 1.0, v10
    v_add_f32 v11, 1.0, v11
    v_cvt_pk_bf16_f32 v10, v10, v11
    v_lshlrev_b32 v12, 16, v10
    v_and_b32 v13, 0xffff0000, v10
    v_mul_f32 v12, v96, v12
    v_mul_f32 v13, v97, v13
    v_cvt_pk_bf16_f32 v10, v12, v13
    v_lshlrev_b32 v12, 16, v10
    v_and_b32 v13, 0xffff0000, v10
    v_lshlrev_b32 v10, 16, v128
    v_and_b32 v11, 0xffff0000, v128
    v_add_f32 v12, v12, v10
    v_add_f32 v13, v13, v11
    v_cvt_pk_bf16_f32 v24, v12, v13
    v_lshlrev_b32 v10, 16, v162
    v_and_b32 v11, 0xffff0000, v162
    v_add_f32 v10, 1.0, v10
    v_add_f32 v11, 1.0, v11
    v_cvt_pk_bf16_f32 v10, v10, v11
    v_lshlrev_b32 v12, 16, v10
    v_and_b32 v13, 0xffff0000, v10
    v_mul_f32 v12, v98, v12
    v_mul_f32 v13, v99, v13
    v_cvt_pk_bf16_f32 v10, v12, v13
    v_lshlrev_b32 v12, 16, v10
    v_and_b32 v13, 0xffff0000, v10
    v_lshlrev_b32 v10, 16, v130
    v_and_b32 v11, 0xffff0000, v130
    v_add_f32 v12, v12, v10
    v_add_f32 v13, v13, v11
    v_cvt_pk_bf16_f32 v25, v12, v13
    v_lshlrev_b32 v10, 16, v164
    v_and_b32 v11, 0xffff0000, v164
    v_add_f32 v10, 1.0, v10
    v_add_f32 v11, 1.0, v11
    v_cvt_pk_bf16_f32 v10, v10, v11
    v_lshlrev_b32 v12, 16, v10
    v_and_b32 v13, 0xffff0000, v10
    v_mul_f32 v12, v100, v12
    v_mul_f32 v13, v101, v13
    v_cvt_pk_bf16_f32 v10, v12, v13
    v_lshlrev_b32 v12, 16, v10
    v_and_b32 v13, 0xffff0000, v10
    v_lshlrev_b32 v10, 16, v132
    v_and_b32 v11, 0xffff0000, v132
    v_add_f32 v12, v12, v10
    v_add_f32 v13, v13, v11
    v_cvt_pk_bf16_f32 v26, v12, v13
    v_lshlrev_b32 v10, 16, v166
    v_and_b32 v11, 0xffff0000, v166
    v_add_f32 v10, 1.0, v10
    v_add_f32 v11, 1.0, v11
    v_cvt_pk_bf16_f32 v10, v10, v11
    v_lshlrev_b32 v12, 16, v10
    v_and_b32 v13, 0xffff0000, v10
    v_mul_f32 v12, v102, v12
    v_mul_f32 v13, v103, v13
    v_cvt_pk_bf16_f32 v10, v12, v13
    v_lshlrev_b32 v12, 16, v10
    v_and_b32 v13, 0xffff0000, v10
    v_lshlrev_b32 v10, 16, v134
    v_and_b32 v11, 0xffff0000, v134
    v_add_f32 v12, v12, v10
    v_add_f32 v13, v13, v11
    v_cvt_pk_bf16_f32 v27, v12, v13
    v_lshlrev_b32 v10, 16, v168
    v_and_b32 v11, 0xffff0000, v168
    v_add_f32 v10, 1.0, v10
    v_add_f32 v11, 1.0, v11
    v_cvt_pk_bf16_f32 v10, v10, v11
    v_lshlrev_b32 v12, 16, v10
    v_and_b32 v13, 0xffff0000, v10
    v_mul_f32 v12, v104, v12
    v_mul_f32 v13, v105, v13
    v_cvt_pk_bf16_f32 v10, v12, v13
    v_lshlrev_b32 v12, 16, v10
    v_and_b32 v13, 0xffff0000, v10
    v_lshlrev_b32 v10, 16, v136
    v_and_b32 v11, 0xffff0000, v136
    v_add_f32 v12, v12, v10
    v_add_f32 v13, v13, v11
    v_cvt_pk_bf16_f32 v28, v12, v13
    v_lshlrev_b32 v10, 16, v170
    v_and_b32 v11, 0xffff0000, v170
    v_add_f32 v10, 1.0, v10
    v_add_f32 v11, 1.0, v11
    v_cvt_pk_bf16_f32 v10, v10, v11
    v_lshlrev_b32 v12, 16, v10
    v_and_b32 v13, 0xffff0000, v10
    v_mul_f32 v12, v106, v12
    v_mul_f32 v13, v107, v13
    v_cvt_pk_bf16_f32 v10, v12, v13
    v_lshlrev_b32 v12, 16, v10
    v_and_b32 v13, 0xffff0000, v10
    v_lshlrev_b32 v10, 16, v138
    v_and_b32 v11, 0xffff0000, v138
    v_add_f32 v12, v12, v10
    v_add_f32 v13, v13, v11
    v_cvt_pk_bf16_f32 v29, v12, v13
    v_lshlrev_b32 v10, 16, v172
    v_and_b32 v11, 0xffff0000, v172
    v_add_f32 v10, 1.0, v10
    v_add_f32 v11, 1.0, v11
    v_cvt_pk_bf16_f32 v10, v10, v11
    v_lshlrev_b32 v12, 16, v10
    v_and_b32 v13, 0xffff0000, v10
    v_mul_f32 v12, v108, v12
    v_mul_f32 v13, v109, v13
    v_cvt_pk_bf16_f32 v10, v12, v13
    v_lshlrev_b32 v12, 16, v10
    v_and_b32 v13, 0xffff0000, v10
    v_lshlrev_b32 v10, 16, v140
    v_and_b32 v11, 0xffff0000, v140
    v_add_f32 v12, v12, v10
    v_add_f32 v13, v13, v11
    v_cvt_pk_bf16_f32 v30, v12, v13
    v_lshlrev_b32 v10, 16, v174
    v_and_b32 v11, 0xffff0000, v174
    v_add_f32 v10, 1.0, v10
    v_add_f32 v11, 1.0, v11
    v_cvt_pk_bf16_f32 v10, v10, v11
    v_lshlrev_b32 v12, 16, v10
    v_and_b32 v13, 0xffff0000, v10
    v_mul_f32 v12, v110, v12
    v_mul_f32 v13, v111, v13
    v_cvt_pk_bf16_f32 v10, v12, v13
    v_lshlrev_b32 v12, 16, v10
    v_and_b32 v13, 0xffff0000, v10
    v_lshlrev_b32 v10, 16, v142
    v_and_b32 v11, 0xffff0000, v142
    v_add_f32 v12, v12, v10
    v_add_f32 v13, v13, v11
    v_cvt_pk_bf16_f32 v31, v12, v13
    s_lshl_b32 s21, s20, 14
    s_lshl_b32 s22, s3, 12
    s_add_u32 s21, s21, s22
    s_add_u32 s21, s21, 0x200000
    buffer_store_dwordx4 v[16:19], v4, s[8:11], s21 offen offset:0 sc1
    buffer_store_dwordx4 v[20:23], v4, s[8:11], s21 offen offset:1024 sc1
    buffer_store_dwordx4 v[24:27], v4, s[8:11], s21 offen offset:2048 sc1
    buffer_store_dwordx4 v[28:31], v4, s[8:11], s21 offen offset:3072 sc1
    s_waitcnt vmcnt(0)
    s_barrier
    s_lshl_b32 s21, s20, 2
    s_add_u32 s21, s21, 0x11000
    s_cmp_eq_u32 s3, 0
    s_cbranch_scc0 L_sf_14
    v_mov_b32 v10, s7
    s_mov_b64 exec, 1
    buffer_store_dword v10, off, s[8:11], s21 sc1
    s_mov_b64 exec, -1
L_sf_14:
    v_mov_b32 v40, 0x7f817f81
    v_mov_b32 v41, v40
    v_mov_b32 v42, v40
    v_mov_b32 v43, v40
    s_cmp_ge_u32 s20, 2
    s_cbranch_scc1 L_m0_15
    s_mov_b32 s28, s62
    s_and_b32 s29, s63, 0xffff
    s_mov_b32 s30, 0x2000
    s_mov_b32 s31, 0x20000
    v_and_b32 v10, 7, v1
    v_lshlrev_b32 v10, 10, v10
    v_lshl_add_u32 v10, v2, 5, v10
    v_bfe_u32 v11, v1, 3, 1
    v_lshl_add_u32 v10, v11, 4, v10
    s_lshl_b32 s21, s20, 9
    s_lshl_b32 s22, s3, 7
    s_add_u32 s21, s21, s22
    buffer_load_dwordx4 v[40:43], v10, s[28:31], s21 offen
    s_waitcnt vmcnt(0)
L_m0_15:
    s_lshl_b32 s21, s20, 12
    s_lshl_b32 s22, s3, 10
    s_add_u32 s21, s21, s22
    s_add_u32 s21, s21, 0x1200000
    buffer_store_dwordx4 v[40:43], v4, s[8:11], s21 offen sc1
    s_waitcnt vmcnt(0)
    s_barrier
    s_lshl_b32 s21, s20, 2
    s_add_u32 s21, s21, 0x11400
    s_cmp_eq_u32 s3, 0
    s_cbranch_scc0 L_sf_16
    v_mov_b32 v10, s7
    s_mov_b64 exec, 1
    buffer_store_dword v10, off, s[8:11], s21 sc1
    s_mov_b64 exec, -1
L_sf_16:
    v_mov_b32 v40, 0x7f817f81
    v_mov_b32 v41, v40
    v_mov_b32 v42, v40
    v_mov_b32 v43, v40
    s_lshl_b32 s21, s20, 14
    s_lshl_b32 s22, s3, 12
    s_add_u32 s21, s21, s22
    s_add_u32 s22, s21, 0x600000
    s_add_u32 s21, s21, 0x400000
    buffer_store_dwordx4 v[40:43], v4, s[8:11], s22 offen offset:0 sc1
    buffer_store_dwordx4 v[40:43], v4, s[8:11], s22 offen offset:1024 sc1
    buffer_store_dwordx4 v[40:43], v4, s[8:11], s22 offen offset:2048 sc1
    buffer_store_dwordx4 v[40:43], v4, s[8:11], s22 offen offset:3072 sc1
    s_sub_u32 s21, s20, 32
    s_cmp_lt_u32 s21, 64
    s_cbranch_scc0 L_nomod2_17
    s_mov_b32 s25, s20
    s_mov_b32 s28, s64
    s_and_b32 s29, s65, 0xffff
    s_mov_b32 s30, 0x400
    s_mov_b32 s31, 0x20000
    s_mov_b32 s32, s66
    s_and_b32 s33, s67, 0xffff
    s_mov_b32 s34, 0x300000
    s_mov_b32 s35, 0x20000
    v_lshrrev_b32 v6, 2, v0
    v_lshlrev_b32 v7, 1, v6
    buffer_load_ushort v32, v7, s[28:31], 0 offen offset:0
    buffer_load_ushort v33, v7, s[28:31], 0 offen offset:128
    buffer_load_ushort v34, v7, s[28:31], 0 offen offset:256
    buffer_load_ushort v35, v7, s[28:31], 0 offen offset:384
    buffer_load_ushort v36, v7, s[28:31], 0 offen offset:512
    buffer_load_ushort v37, v7, s[28:31], 0 offen offset:640
    buffer_load_ushort v38, v7, s[28:31], 0 offen offset:768
    buffer_load_ushort v39, v7, s[28:31], 0 offen offset:896
    s_mov_b32 s21, 6144
    v_mul_lo_u32 v8, v6, s21
    v_and_b32 v9, 3, v0
    v_lshl_add_u32 v8, v9, 4, v8
    s_lshl_b32 s21, s25, 6
    buffer_load_dwordx4 v[40:43], v8, s[32:35], s21 offen
    s_add_u32 s21, s21, 393216
    buffer_load_dwordx4 v[44:47], v8, s[32:35], s21 offen
    s_add_u32 s21, s21, 393216
    buffer_load_dwordx4 v[48:51], v8, s[32:35], s21 offen
    s_add_u32 s21, s21, 393216
    buffer_load_dwordx4 v[52:55], v8, s[32:35], s21 offen
    s_add_u32 s21, s21, 393216
    buffer_load_dwordx4 v[56:59], v8, s[32:35], s21 offen
    s_add_u32 s21, s21, 393216
    buffer_load_dwordx4 v[60:63], v8, s[32:35], s21 offen
    s_add_u32 s21, s21, 393216
    buffer_load_dwordx4 v[64:67], v8, s[32:35], s21 offen
    s_add_u32 s21, s21, 393216
    buffer_load_dwordx4 v[68:71], v8, s[32:35], s21 offen
    s_waitcnt vmcnt(8)
    v_lshlrev_b32 v32, 16, v32
    v_mul_f32 v10, s24, v32
    v_exp_f32 v10, v10
    s_nop 0
    v_add_f32 v10, 1.0, v10
    v_rcp_f32 v10, v10
    s_nop 0
    v_mul_f32 v32, v32, v10
    v_cvt_pk_bf16_f32 v32, v32, v32
    v_lshlrev_b32 v32, 16, v32
    v_lshlrev_b32 v33, 16, v33
    v_mul_f32 v10, s24, v33
    v_exp_f32 v10, v10
    s_nop 0
    v_add_f32 v10, 1.0, v10
    v_rcp_f32 v10, v10
    s_nop 0
    v_mul_f32 v33, v33, v10
    v_cvt_pk_bf16_f32 v33, v33, v33
    v_lshlrev_b32 v33, 16, v33
    v_lshlrev_b32 v34, 16, v34
    v_mul_f32 v10, s24, v34
    v_exp_f32 v10, v10
    s_nop 0
    v_add_f32 v10, 1.0, v10
    v_rcp_f32 v10, v10
    s_nop 0
    v_mul_f32 v34, v34, v10
    v_cvt_pk_bf16_f32 v34, v34, v34
    v_lshlrev_b32 v34, 16, v34
    v_lshlrev_b32 v35, 16, v35
    v_mul_f32 v10, s24, v35
    v_exp_f32 v10, v10
    s_nop 0
    v_add_f32 v10, 1.0, v10
    v_rcp_f32 v10, v10
    s_nop 0
    v_mul_f32 v35, v35, v10
    v_cvt_pk_bf16_f32 v35, v35, v35
    v_lshlrev_b32 v35, 16, v35
    v_lshlrev_b32 v36, 16, v36
    v_mul_f32 v10, s24, v36
    v_exp_f32 v10, v10
    s_nop 0
    v_add_f32 v10, 1.0, v10
    v_rcp_f32 v10, v10
    s_nop 0
    v_mul_f32 v36, v36, v10
    v_cvt_pk_bf16_f32 v36, v36, v36
    v_lshlrev_b32 v36, 16, v36
    v_lshlrev_b32 v37, 16, v37
    v_mul_f32 v10, s24, v37
    v_exp_f32 v10, v10
    s_nop 0
    v_add_f32 v10, 1.0, v10
    v_rcp_f32 v10, v10
    s_nop 0
    v_mul_f32 v37, v37, v10
    v_cvt_pk_bf16_f32 v37, v37, v37
    v_lshlrev_b32 v37, 16, v37
    v_lshlrev_b32 v38, 16, v38
    v_mul_f32 v10, s24, v38
    v_exp_f32 v10, v10
    s_nop 0
    v_add_f32 v10, 1.0, v10
    v_rcp_f32 v10, v10
    s_nop 0
    v_mul_f32 v38, v38, v10
    v_cvt_pk_bf16_f32 v38, v38, v38
    v_lshlrev_b32 v38, 16, v38
    v_lshlrev_b32 v39, 16, v39
    v_mul_f32 v10, s24, v39
    v_exp_f32 v10, v10
    s_nop 0
    v_add_f32 v10, 1.0, v10
    v_rcp_f32 v10, v10
    s_nop 0
    v_mul_f32 v39, v39, v10
    v_cvt_pk_bf16_f32 v39, v39, v39
    v_lshlrev_b32 v39, 16, v39
    s_waitcnt vmcnt(7)
    v_lshlrev_b32 v10, 16, v40
    v_and_b32 v11, 0xffff0000, v40
    v_mul_f32 v72, v32, v10
    v_mul_f32 v73, v32, v11
    v_lshlrev_b32 v10, 16, v41
    v_and_b32 v11, 0xffff0000, v41
    v_mul_f32 v74, v32, v10
    v_mul_f32 v75, v32, v11
    v_lshlrev_b32 v10, 16, v42
    v_and_b32 v11, 0xffff0000, v42
    v_mul_f32 v76, v32, v10
    v_mul_f32 v77, v32, v11
    v_lshlrev_b32 v10, 16, v43
    v_and_b32 v11, 0xffff0000, v43
    v_mul_f32 v78, v32, v10
    v_mul_f32 v79, v32, v11
    s_waitcnt vmcnt(6)
    v_lshlrev_b32 v10, 16, v44
    v_and_b32 v11, 0xffff0000, v44
    v_fmac_f32 v72, v33, v10
    v_fmac_f32 v73, v33, v11
    v_lshlrev_b32 v10, 16, v45
    v_and_b32 v11, 0xffff0000, v45
    v_fmac_f32 v74, v33, v10
    v_fmac_f32 v75, v33, v11
    v_lshlrev_b32 v10, 16, v46
    v_and_b32 v11, 0xffff0000, v46
    v_fmac_f32 v76, v33, v10
    v_fmac_f32 v77, v33, v11
    v_lshlrev_b32 v10, 16, v47
    v_and_b32 v11, 0xffff0000, v47
    v_fmac_f32 v78, v33, v10
    v_fmac_f32 v79, v33, v11
    s_waitcnt vmcnt(5)
    v_lshlrev_b32 v10, 16, v48
    v_and_b32 v11, 0xffff0000, v48
    v_fmac_f32 v72, v34, v10
    v_fmac_f32 v73, v34, v11
    v_lshlrev_b32 v10, 16, v49
    v_and_b32 v11, 0xffff0000, v49
    v_fmac_f32 v74, v34, v10
    v_fmac_f32 v75, v34, v11
    v_lshlrev_b32 v10, 16, v50
    v_and_b32 v11, 0xffff0000, v50
    v_fmac_f32 v76, v34, v10
    v_fmac_f32 v77, v34, v11
    v_lshlrev_b32 v10, 16, v51
    v_and_b32 v11, 0xffff0000, v51
    v_fmac_f32 v78, v34, v10
    v_fmac_f32 v79, v34, v11
    s_waitcnt vmcnt(4)
    v_lshlrev_b32 v10, 16, v52
    v_and_b32 v11, 0xffff0000, v52
    v_fmac_f32 v72, v35, v10
    v_fmac_f32 v73, v35, v11
    v_lshlrev_b32 v10, 16, v53
    v_and_b32 v11, 0xffff0000, v53
    v_fmac_f32 v74, v35, v10
    v_fmac_f32 v75, v35, v11
    v_lshlrev_b32 v10, 16, v54
    v_and_b32 v11, 0xffff0000, v54
    v_fmac_f32 v76, v35, v10
    v_fmac_f32 v77, v35, v11
    v_lshlrev_b32 v10, 16, v55
    v_and_b32 v11, 0xffff0000, v55
    v_fmac_f32 v78, v35, v10
    v_fmac_f32 v79, v35, v11
    s_waitcnt vmcnt(3)
    v_lshlrev_b32 v10, 16, v56
    v_and_b32 v11, 0xffff0000, v56
    v_fmac_f32 v72, v36, v10
    v_fmac_f32 v73, v36, v11
    v_lshlrev_b32 v10, 16, v57
    v_and_b32 v11, 0xffff0000, v57
    v_fmac_f32 v74, v36, v10
    v_fmac_f32 v75, v36, v11
    v_lshlrev_b32 v10, 16, v58
    v_and_b32 v11, 0xffff0000, v58
    v_fmac_f32 v76, v36, v10
    v_fmac_f32 v77, v36, v11
    v_lshlrev_b32 v10, 16, v59
    v_and_b32 v11, 0xffff0000, v59
    v_fmac_f32 v78, v36, v10
    v_fmac_f32 v79, v36, v11
    s_waitcnt vmcnt(2)
    v_lshlrev_b32 v10, 16, v60
    v_and_b32 v11, 0xffff0000, v60
    v_fmac_f32 v72, v37, v10
    v_fmac_f32 v73, v37, v11
    v_lshlrev_b32 v10, 16, v61
    v_and_b32 v11, 0xffff0000, v61
    v_fmac_f32 v74, v37, v10
    v_fmac_f32 v75, v37, v11
    v_lshlrev_b32 v10, 16, v62
    v_and_b32 v11, 0xffff0000, v62
    v_fmac_f32 v76, v37, v10
    v_fmac_f32 v77, v37, v11
    v_lshlrev_b32 v10, 16, v63
    v_and_b32 v11, 0xffff0000, v63
    v_fmac_f32 v78, v37, v10
    v_fmac_f32 v79, v37, v11
    s_waitcnt vmcnt(1)
    v_lshlrev_b32 v10, 16, v64
    v_and_b32 v11, 0xffff0000, v64
    v_fmac_f32 v72, v38, v10
    v_fmac_f32 v73, v38, v11
    v_lshlrev_b32 v10, 16, v65
    v_and_b32 v11, 0xffff0000, v65
    v_fmac_f32 v74, v38, v10
    v_fmac_f32 v75, v38, v11
    v_lshlrev_b32 v10, 16, v66
    v_and_b32 v11, 0xffff0000, v66
    v_fmac_f32 v76, v38, v10
    v_fmac_f32 v77, v38, v11
    v_lshlrev_b32 v10, 16, v67
    v_and_b32 v11, 0xffff0000, v67
    v_fmac_f32 v78, v38, v10
    v_fmac_f32 v79, v38, v11
    s_waitcnt vmcnt(0)
    v_lshlrev_b32 v10, 16, v68
    v_and_b32 v11, 0xffff0000, v68
    v_fmac_f32 v72, v39, v10
    v_fmac_f32 v73, v39, v11
    v_lshlrev_b32 v10, 16, v69
    v_and_b32 v11, 0xffff0000, v69
    v_fmac_f32 v74, v39, v10
    v_fmac_f32 v75, v39, v11
    v_lshlrev_b32 v10, 16, v70
    v_and_b32 v11, 0xffff0000, v70
    v_fmac_f32 v76, v39, v10
    v_fmac_f32 v77, v39, v11
    v_lshlrev_b32 v10, 16, v71
    v_and_b32 v11, 0xffff0000, v71
    v_fmac_f32 v78, v39, v10
    v_fmac_f32 v79, v39, v11
    v_lshlrev_b32 v10, 5, v6
    s_mov_b32 s21, 2080
    v_mad_u32_u24 v10, v9, s21, v10
    ds_write_b128 v10, v[72:75] offset:4096
    ds_write_b128 v10, v[76:79] offset:4112
    s_waitcnt lgkmcnt(0)
    s_barrier
    v_and_b32 v10, 31, v0
    v_lshrrev_b32 v11, 5, v0
    v_lshrrev_b32 v12, 3, v10
    v_mul_u32_u24 v12, 2080, v12
    v_and_b32 v13, 7, v10
    v_lshl_add_u32 v12, v13, 2, v12
    v_lshl_add_u32 v12, v11, 8, v12
    ds_read_b32 v72, v12 offset:4096
    ds_read_b32 v73, v12 offset:4128
    ds_read_b32 v74, v12 offset:4160
    ds_read_b32 v75, v12 offset:4192
    ds_read_b32 v76, v12 offset:4224
    ds_read_b32 v77, v12 offset:4256
    ds_read_b32 v78, v12 offset:4288
    ds_read_b32 v79, v12 offset:4320
    s_waitcnt lgkmcnt(0)
    v_add_f32 v72, v72, v73
    v_add_f32 v72, v72, v74
    v_add_f32 v72, v72, v75
    v_add_f32 v72, v72, v76
    v_add_f32 v72, v72, v77
    v_add_f32 v72, v72, v78
    v_add_f32 v72, v72, v79
    v_lshlrev_b32 v12, 2, v0
    ds_write_b32 v12, v72
    s_waitcnt lgkmcnt(0)
    s_barrier
    v_lshlrev_b32 v12, 2, v10
    ds_read_b32 v72, v12 offset:0
    ds_read_b32 v73, v12 offset:128
    ds_read_b32 v74, v12 offset:256
    ds_read_b32 v75, v12 offset:384
    ds_read_b32 v76, v12 offset:512
    ds_read_b32 v77, v12 offset:640
    ds_read_b32 v78, v12 offset:768
    ds_read_b32 v79, v12 offset:896
    s_waitcnt lgkmcnt(0)
    v_add_f32 v72, v72, v73
    v_add_f32 v72, v72, v74
    v_add_f32 v72, v72, v75
    v_add_f32 v72, v72, v76
    v_add_f32 v72, v72, v77
    v_add_f32 v72, v72, v78
    v_add_f32 v72, v72, v79
    s_nop 1
    v_mov_b32_dpp v73, v72 quad_perm:[1,0,3,2] row_mask:0xf bank_mask:0xf
    v_cvt_pk_bf16_f32 v72, v72, v73
    v_mov_b32 v73, s7
    v_lshlrev_b32 v12, 2, v10
    s_lshl_b32 s21, s25, 7
    s_add_u32 s21, s21, 0
    s_cmp_eq_u32 s3, 0
    s_cbranch_scc0 L_ms_18
    s_mov_b32 exec_lo, 0x55555555
    s_mov_b32 exec_hi, 0
    buffer_store_dwordx2 v[72:73], v12, s[8:11], s21 offen sc1
    s_mov_b64 exec, -1
L_ms_18:
L_nomod2_17:
    s_waitcnt vmcnt(0)
    s_barrier
    s_lshl_b32 s21, s20, 2
    s_add_u32 s21, s21, 0x11800
    s_cmp_eq_u32 s3, 0
    s_cbranch_scc0 L_sf_19
    v_mov_b32 v10, s7
    s_mov_b64 exec, 1
    buffer_store_dword v10, off, s[8:11], s21 sc1
    s_mov_b64 exec, -1
L_sf_19:
    s_cmp_lt_u32 s5, 6
    s_cbranch_scc1 L_role_att
    s_load_dwordx4 s[60:63], s[0:1], 64
    s_load_dwordx2 s[64:65], s[0:1], 96
    v_and_b32 v100, 63, v0
    v_lshrrev_b32 v101, 4, v100
    v_and_b32 v102, 15, v100
    v_lshrrev_b32 v103, 2, v102
    v_and_b32 v104, 3, v102
    v_lshlrev_b32 v0, 4, v100
    s_mov_b32 s20, 3584
    v_or_b32 v105, 0, v101
    v_lshlrev_b32 v105, 1, v105
    v_xor_b32 v105, v105, v102
    v_lshlrev_b32 v105, 4, v105
    v_mad_u32_u24 v108, v101, s20, v105
    v_or_b32 v105, 4, v101
    v_lshlrev_b32 v105, 1, v105
    v_xor_b32 v105, v105, v102
    v_lshlrev_b32 v105, 4, v105
    v_mad_u32_u24 v109, v101, s20, v105
    v_lshl_add_u32 v105, v101, 3, v103
    v_and_b32 v106, 1, v101
    v_lshl_add_u32 v106, v106, 2, v103
    s_lshl_b32 s20, s3, 1
    v_xor_b32 v106, s20, v106
    v_lshlrev_b32 v106, 5, v106
    v_lshl_add_u32 v106, v105, 8, v106
    v_lshl_add_u32 v110, v104, 3, v106
    v_xor_b32 v111, 32, v110
    s_and_b32 s21, s3, 1
    s_lshl_b32 s21, s21, 3
    v_xor_b32 v105, 0, v100
    v_xor_b32 v105, s21, v105
    v_lshlrev_b32 v114, 4, v105
    v_xor_b32 v105, 2, v100
    v_xor_b32 v105, s21, v105
    v_lshlrev_b32 v115, 4, v105
    v_xor_b32 v105, 4, v100
    v_xor_b32 v105, s21, v105
    v_lshlrev_b32 v116, 4, v105
    v_xor_b32 v105, 6, v100
    v_xor_b32 v105, s21, v105
    v_lshlrev_b32 v117, 4, v105
    v_lshl_add_u32 v105, v101, 2, v103
    v_and_b32 v106, 7, v105
    v_lshlrev_b32 v106, 5, v106
    v_lshl_add_u32 v106, v105, 10, v106
    v_lshl_add_u32 v106, v104, 3, v106
    s_lshl_b32 s21, s3, 8
    v_add_u32 v118, s21, v106
    v_lshrrev_b32 v105, 2, v102
    v_lshlrev_b32 v1, 10, v105
    v_and_b32 v105, 1, v101
    v_lshl_add_u32 v1, v105, 9, v1
    v_bfe_u32 v105, v102, 1, 1
    v_lshl_add_u32 v1, v105, 8, v1
    v_and_b32 v105, 1, v102
    v_lshl_add_u32 v1, v105, 3, v1
    s_lshl_b32 s20, s3, 12
    s_lshr_b32 s21, s4, 4
    s_lshl_b32 s21, s21, 14
    s_add_u32 s20, s20, s21
    s_and_b32 s21, s4, 15
    s_lshl_b32 s21, s21, 4
    s_add_u32 s20, s20, s21
    v_add_u32 v1, s20, v1
    s_lshl_b32 s20, s3, 10
    s_add_u32 s20, s20, 16384
    v_add_u32 v7, s20, v0
    s_lshl_b32 s20, s3, 12
    v_add_u32 v5, s20, v0
    v_and_b32 v6, 1, v100
    v_xor_b32 v6, 1, v6
    v_lshlrev_b32 v105, 4, v101
    v_lshl_add_u32 v2, v102, 14, v105
    v_lshlrev_b32 v105, 4, v102
    v_lshl_add_u32 v4, v101, 10, v105
    v_lshrrev_b32 v105, 2, v102
    v_lshlrev_b32 v3, 6, v105
    v_and_b32 v105, 1, v101
    v_lshl_add_u32 v3, v105, 5, v3
    v_and_b32 v105, 3, v102
    v_lshl_add_u32 v3, v105, 3, v3
    s_lshl_b32 s21, s3, 8
    v_add_u32 v3, s21, v3
    v_and_b32 v105, 7, v100
    v_and_b32 v106, 1, v100
    v_lshlrev_b32 v106, 4, v106
    v_mov_b32 v107, 0x3f80
    v_lshlrev_b32 v107, v106, v107
    v_lshrrev_b32 v105, 1, v105
    v_cmp_eq_u32 vcc, 0, v105
    s_nop 1
    v_cndmask_b32 v12, 0, v107, vcc
    v_cmp_eq_u32 vcc, 1, v105
    s_nop 1
    v_cndmask_b32 v13, 0, v107, vcc
    v_cmp_eq_u32 vcc, 2, v105
    s_nop 1
    v_cndmask_b32 v14, 0, v107, vcc
    v_cmp_eq_u32 vcc, 3, v105
    s_nop 1
    v_cndmask_b32 v15, 0, v107, vcc
    s_sub_u32 s25, s5, 6
    s_lshl_b32 s26, s25, 21
    s_add_u32 s26, s26, 0xe00000
    s_add_u32 s33, s26, 0x100000
    s_cmp_eq_u32 s3, 0
    s_cbranch_scc0 L_gb_21
    s_mov_b32 s22, 0
    v_mbcnt_lo_u32_b32 v32, -1, 0
    v_lshlrev_b32 v32, 2, v32
    v_and_b32 v32, 127, v32
    s_mov_b32 s20, 0x12400
L_ga_20:
    buffer_load_dword v33, v32, s[8:11], s20 offen sc1
    s_add_u32 s22, s22, 1
    s_cmp_gt_u32 s22, 100000
    s_cbranch_scc1 L_fail
    s_waitcnt vmcnt(0)
    v_subrev_u32 v33, s7, v33
    v_cmp_lt_u32 vcc, 0, v33
    s_cbranch_vccz L_gc_22
    s_sleep 20
    s_branch L_ga_20
L_gc_22:
L_gb_21:
    s_barrier
    v_mov_b32 v32, 1
    v_mov_b32 v33, 0
    v_mov_b32 v34, 0
    v_mov_b32 v35, 0
    s_lshl_b32 s23, s4, 14
    s_add_u32 s23, s23, s26
    s_lshl_b32 s21, s3, 12
    s_add_u32 s23, s23, s21
    buffer_store_dwordx4 v[32:35], v0, s[8:11], s23 offen offset:0
    buffer_store_dwordx4 v[32:35], v0, s[8:11], s23 offen offset:1024
    buffer_store_dwordx4 v[32:35], v0, s[8:11], s23 offen offset:2048
    buffer_store_dwordx4 v[32:35], v0, s[8:11], s23 offen offset:3072
    s_add_u32 s23, s23, 0x80000
    buffer_store_dwordx4 v[32:35], v0, s[8:11], s23 offen offset:0
    buffer_store_dwordx4 v[32:35], v0, s[8:11], s23 offen offset:1024
    buffer_store_dwordx4 v[32:35], v0, s[8:11], s23 offen offset:2048
    buffer_store_dwordx4 v[32:35], v0, s[8:11], s23 offen offset:3072
    s_add_u32 s23, s23, 0x80000
    buffer_store_dwordx2 v[32:33], v1, s[8:11], s33 offen
    s_add_u32 s23, s33, 0x8000
    buffer_store_dwordx2 v[32:33], v1, s[8:11], s23 offen
    s_waitcnt vmcnt(0) lgkmcnt(0)
    s_barrier
    s_lshl_b32 s20, s5, 5
    s_add_u32 s20, s20, s4
    s_lshl_b32 s20, s20, 2
    s_add_u32 s20, s20, 0x12000
    s_cmp_eq_u32 s3, 0
    s_cbranch_scc0 L_sf_23
    v_mov_b32 v32, s7
    s_mov_b64 exec, 1
    buffer_store_dword v32, off, s[8:11], s20 sc1
    s_mov_b64 exec, -1
L_sf_23:
    s_cmp_ge_u32 s4, 28
    s_cbranch_scc1 L_fnw_24
    s_lshr_b32 s30, s4, 1
    s_lshl_b32 s30, s30, 17
    s_mov_b32 s12, s60
    s_and_b32 s13, s61, 0xffff
    s_mov_b32 s14, 0x1c0000
    s_mov_b32 s15, 0x20000
    s_mul_i32 s23, s3, 57344
    s_lshr_b32 s20, s4, 1
    s_lshl_b32 s20, s20, 8
    s_add_u32 s23, s23, s20
    s_add_u32 s23, s23, 0
    s_lshl_b32 s24, s3, 12
    s_add_u32 s24, s24, 32768
    s_mov_b32 m0, s24
    s_add_u32 s24, s24, 1024
    buffer_load_dwordx4 v108, s[12:15], s23 offen  lds
    s_add_u32 s23, s23, 14336
    s_mov_b32 m0, s24
    s_add_u32 s24, s24, 1024
    buffer_load_dwordx4 v108, s[12:15], s23 offen  lds
    s_add_u32 s23, s23, 14336
    s_mov_b32 m0, s24
    s_add_u32 s24, s24, 1024
    buffer_load_dwordx4 v109, s[12:15], s23 offen  lds
    s_add_u32 s23, s23, 14336
    s_mov_b32 m0, s24
    s_nop 0
    buffer_load_dwordx4 v109, s[12:15], s23 offen  lds
    s_mul_i32 s23, s3, 57344
    s_lshr_b32 s20, s4, 1
    s_lshl_b32 s20, s20, 8
    s_add_u32 s23, s23, s20
    s_add_u32 s23, s23, 229376
    s_lshl_b32 s24, s3, 12
    s_add_u32 s24, s24, 49152
    s_mov_b32 m0, s24
    s_add_u32 s24, s24, 1024
    buffer_load_dwordx4 v108, s[12:15], s23 offen  lds
    s_add_u32 s23, s23, 14336
    s_mov_b32 m0, s24
    s_add_u32 s24, s24, 1024
    buffer_load_dwordx4 v108, s[12:15], s23 offen  lds
    s_add_u32 s23, s23, 14336
    s_mov_b32 m0, s24
    s_add_u32 s24, s24, 1024
    buffer_load_dwordx4 v109, s[12:15], s23 offen  lds
    s_add_u32 s23, s23, 14336
    s_mov_b32 m0, s24
    s_nop 0
    buffer_load_dwordx4 v109, s[12:15], s23 offen  lds
    s_mul_i32 s23, s3, 57344
    s_lshr_b32 s20, s4, 1
    s_lshl_b32 s20, s20, 8
    s_add_u32 s23, s23, s20
    s_add_u32 s23, s23, 458752
    s_lshl_b32 s24, s3, 12
    s_add_u32 s24, s24, 65536
    s_mov_b32 m0, s24
    s_add_u32 s24, s24, 1024
    buffer_load_dwordx4 v108, s[12:15], s23 offen  lds
    s_add_u32 s23, s23, 14336
    s_mov_b32 m0, s24
    s_add_u32 s24, s24, 1024
    buffer_load_dwordx4 v108, s[12:15], s23 offen  lds
    s_add_u32 s23, s23, 14336
    s_mov_b32 m0, s24
    s_add_u32 s24, s24, 1024
    buffer_load_dwordx4 v109, s[12:15], s23 offen  lds
    s_add_u32 s23, s23, 14336
    s_mov_b32 m0, s24
    s_nop 0
    buffer_load_dwordx4 v109, s[12:15], s23 offen  lds
    s_mul_i32 s23, s3, 57344
    s_lshr_b32 s20, s4, 1
    s_lshl_b32 s20, s20, 8
    s_add_u32 s23, s23, s20
    s_add_u32 s23, s23, 688128
    s_lshl_b32 s24, s3, 12
    s_add_u32 s24, s24, 81920
    s_mov_b32 m0, s24
    s_add_u32 s24, s24, 1024
    buffer_load_dwordx4 v108, s[12:15], s23 offen  lds
    s_add_u32 s23, s23, 14336
    s_mov_b32 m0, s24
    s_add_u32 s24, s24, 1024
    buffer_load_dwordx4 v108, s[12:15], s23 offen  lds
    s_add_u32 s23, s23, 14336
    s_mov_b32 m0, s24
    s_add_u32 s24, s24, 1024
    buffer_load_dwordx4 v109, s[12:15], s23 offen  lds
    s_add_u32 s23, s23, 14336
    s_mov_b32 m0, s24
    s_nop 0
    buffer_load_dwordx4 v109, s[12:15], s23 offen  lds
    s_mul_i32 s23, s3, 57344
    s_lshr_b32 s20, s4, 1
    s_lshl_b32 s20, s20, 8
    s_add_u32 s23, s23, s20
    s_add_u32 s23, s23, 917504
    s_lshl_b32 s24, s3, 12
    s_add_u32 s24, s24, 98304
    s_mov_b32 m0, s24
    s_add_u32 s24, s24, 1024
    buffer_load_dwordx4 v108, s[12:15], s23 offen  lds
    s_add_u32 s23, s23, 14336
    s_mov_b32 m0, s24
    s_add_u32 s24, s24, 1024
    buffer_load_dwordx4 v108, s[12:15], s23 offen  lds
    s_add_u32 s23, s23, 14336
    s_mov_b32 m0, s24
    s_add_u32 s24, s24, 1024
    buffer_load_dwordx4 v109, s[12:15], s23 offen  lds
    s_add_u32 s23, s23, 14336
    s_mov_b32 m0, s24
    s_nop 0
    buffer_load_dwordx4 v109, s[12:15], s23 offen  lds
    s_mul_i32 s23, s3, 57344
    s_lshr_b32 s20, s4, 1
    s_lshl_b32 s20, s20, 8
    s_add_u32 s23, s23, s20
    s_add_u32 s23, s23, 1146880
    s_lshl_b32 s24, s3, 12
    s_add_u32 s24, s24, 114688
    s_mov_b32 m0, s24
    s_add_u32 s24, s24, 1024
    buffer_load_dwordx4 v108, s[12:15], s23 offen  lds
    s_add_u32 s23, s23, 14336
    s_mov_b32 m0, s24
    s_add_u32 s24, s24, 1024
    buffer_load_dwordx4 v108, s[12:15], s23 offen  lds
    s_add_u32 s23, s23, 14336
    s_mov_b32 m0, s24
    s_add_u32 s24, s24, 1024
    buffer_load_dwordx4 v109, s[12:15], s23 offen  lds
    s_add_u32 s23, s23, 14336
    s_mov_b32 m0, s24
    s_nop 0
    buffer_load_dwordx4 v109, s[12:15], s23 offen  lds
    s_mul_i32 s23, s3, 57344
    s_lshr_b32 s20, s4, 1
    s_lshl_b32 s20, s20, 8
    s_add_u32 s23, s23, s20
    s_add_u32 s23, s23, 1376256
    s_lshl_b32 s24, s3, 12
    s_add_u32 s24, s24, 131072
    s_mov_b32 m0, s24
    s_add_u32 s24, s24, 1024
    buffer_load_dwordx4 v108, s[12:15], s23 offen  lds
    s_add_u32 s23, s23, 14336
    s_mov_b32 m0, s24
    s_add_u32 s24, s24, 1024
    buffer_load_dwordx4 v108, s[12:15], s23 offen  lds
    s_add_u32 s23, s23, 14336
    s_mov_b32 m0, s24
    s_add_u32 s24, s24, 1024
    buffer_load_dwordx4 v109, s[12:15], s23 offen  lds
    s_add_u32 s23, s23, 14336
    s_mov_b32 m0, s24
    s_nop 0
    buffer_load_dwordx4 v109, s[12:15], s23 offen  lds
    s_mul_i32 s23, s3, 57344
    s_lshr_b32 s20, s4, 1
    s_lshl_b32 s20, s20, 8
    s_add_u32 s23, s23, s20
    s_add_u32 s23, s23, 1605632
    s_lshl_b32 s24, s3, 12
    s_add_u32 s24, s24, 147456
    s_mov_b32 m0, s24
    s_add_u32 s24, s24, 1024
    buffer_load_dwordx4 v108, s[12:15], s23 offen  lds
    s_add_u32 s23, s23, 14336
    s_mov_b32 m0, s24
    s_add_u32 s24, s24, 1024
    buffer_load_dwordx4 v108, s[12:15], s23 offen  lds
    s_add_u32 s23, s23, 14336
    s_mov_b32 m0, s24
    s_add_u32 s24, s24, 1024
    buffer_load_dwordx4 v109, s[12:15], s23 offen  lds
    s_add_u32 s23, s23, 14336
    s_mov_b32 m0, s24
    s_nop 0
    buffer_load_dwordx4 v109, s[12:15], s23 offen  lds
    s_waitcnt vmcnt(28) lgkmcnt(0)
    s_barrier
    v_add_u32 v119, 32768, v110
    ds_read_b64_tr_b16 a[0:1], v119 offset:0
    ds_read_b64_tr_b16 a[2:3], v119 offset:1024
    ds_read_b64_tr_b16 a[8:9], v119 offset:8192
    ds_read_b64_tr_b16 a[10:11], v119 offset:9216
    v_add_u32 v119, 32768, v111
    ds_read_b64_tr_b16 a[4:5], v119 offset:0
    ds_read_b64_tr_b16 a[6:7], v119 offset:1024
    ds_read_b64_tr_b16 a[12:13], v119 offset:8192
    ds_read_b64_tr_b16 a[14:15], v119 offset:9216
    s_waitcnt vmcnt(24) lgkmcnt(0)
    s_barrier
    s_mov_b32 s12, s62
    s_and_b32 s13, s63, 0xffff
    s_mov_b32 s14, 0x1c0000
    s_mov_b32 s15, 0x20000
    s_lshl_b32 s23, s3, 12
    s_add_u32 s23, s23, s30
    s_add_u32 s23, s23, 0
    s_lshl_b32 s24, s3, 12
    s_add_u32 s24, s24, 32768
    s_mov_b32 m0, s24
    s_add_u32 s24, s24, 1024
    buffer_load_dwordx4 v114, s[12:15], s23 offen  lds
    s_add_u32 s23, s23, 1024
    s_mov_b32 m0, s24
    s_add_u32 s24, s24, 1024
    buffer_load_dwordx4 v115, s[12:15], s23 offen  lds
    s_add_u32 s23, s23, 1024
    s_mov_b32 m0, s24
    s_add_u32 s24, s24, 1024
    buffer_load_dwordx4 v116, s[12:15], s23 offen  lds
    s_add_u32 s23, s23, 1024
    s_mov_b32 m0, s24
    s_nop 0
    buffer_load_dwordx4 v117, s[12:15], s23 offen  lds
    v_add_u32 v119, 49152, v110
    ds_read_b64_tr_b16 a[16:17], v119 offset:0
    ds_read_b64_tr_b16 a[18:19], v119 offset:1024
    ds_read_b64_tr_b16 a[24:25], v119 offset:8192
    ds_read_b64_tr_b16 a[26:27], v119 offset:9216
    v_add_u32 v119, 49152, v111
    ds_read_b64_tr_b16 a[20:21], v119 offset:0
    ds_read_b64_tr_b16 a[22:23], v119 offset:1024
    ds_read_b64_tr_b16 a[28:29], v119 offset:8192
    ds_read_b64_tr_b16 a[30:31], v119 offset:9216
    s_waitcnt vmcnt(24) lgkmcnt(0)
    s_barrier
    s_lshl_b32 s23, s3, 12
    s_add_u32 s23, s23, s30
    s_add_u32 s23, s23, 16384
    s_lshl_b32 s24, s3, 12
    s_add_u32 s24, s24, 49152
    s_mov_b32 m0, s24
    s_add_u32 s24, s24, 1024
    buffer_load_dwordx4 v114, s[12:15], s23 offen  lds
    s_add_u32 s23, s23, 1024
    s_mov_b32 m0, s24
    s_add_u32 s24, s24, 1024
    buffer_load_dwordx4 v115, s[12:15], s23 offen  lds
    s_add_u32 s23, s23, 1024
    s_mov_b32 m0, s24
    s_add_u32 s24, s24, 1024
    buffer_load_dwordx4 v116, s[12:15], s23 offen  lds
    s_add_u32 s23, s23, 1024
    s_mov_b32 m0, s24
    s_nop 0
    buffer_load_dwordx4 v117, s[12:15], s23 offen  lds
    v_add_u32 v119, 65536, v110
    ds_read_b64_tr_b16 a[32:33], v119 offset:0
    ds_read_b64_tr_b16 a[34:35], v119 offset:1024
    ds_read_b64_tr_b16 a[40:41], v119 offset:8192
    ds_read_b64_tr_b16 a[42:43], v119 offset:9216
    v_add_u32 v119, 65536, v111
    ds_read_b64_tr_b16 a[36:37], v119 offset:0
    ds_read_b64_tr_b16 a[38:39], v119 offset:1024
    ds_read_b64_tr_b16 a[44:45], v119 offset:8192
    ds_read_b64_tr_b16 a[46:47], v119 offset:9216
    s_waitcnt vmcnt(24) lgkmcnt(0)
    s_barrier
    s_lshl_b32 s23, s3, 12
    s_add_u32 s23, s23, s30
    s_add_u32 s23, s23, 32768
    s_lshl_b32 s24, s3, 12
    s_add_u32 s24, s24, 65536
    s_mov_b32 m0, s24
    s_add_u32 s24, s24, 1024
    buffer_load_dwordx4 v114, s[12:15], s23 offen  lds
    s_add_u32 s23, s23, 1024
    s_mov_b32 m0, s24
    s_add_u32 s24, s24, 1024
    buffer_load_dwordx4 v115, s[12:15], s23 offen  lds
    s_add_u32 s23, s23, 1024
    s_mov_b32 m0, s24
    s_add_u32 s24, s24, 1024
    buffer_load_dwordx4 v116, s[12:15], s23 offen  lds
    s_add_u32 s23, s23, 1024
    s_mov_b32 m0, s24
    s_nop 0
    buffer_load_dwordx4 v117, s[12:15], s23 offen  lds
    v_add_u32 v119, 81920, v110
    ds_read_b64_tr_b16 a[48:49], v119 offset:0
    ds_read_b64_tr_b16 a[50:51], v119 offset:1024
    ds_read_b64_tr_b16 a[56:57], v119 offset:8192
    ds_read_b64_tr_b16 a[58:59], v119 offset:9216
    v_add_u32 v119, 81920, v111
    ds_read_b64_tr_b16 a[52:53], v119 offset:0
    ds_read_b64_tr_b16 a[54:55], v119 offset:1024
    ds_read_b64_tr_b16 a[60:61], v119 offset:8192
    ds_read_b64_tr_b16 a[62:63], v119 offset:9216
    s_waitcnt vmcnt(24) lgkmcnt(0)
    s_barrier
    s_lshl_b32 s23, s3, 12
    s_add_u32 s23, s23, s30
    s_add_u32 s23, s23, 49152
    s_lshl_b32 s24, s3, 12
    s_add_u32 s24, s24, 81920
    s_mov_b32 m0, s24
    s_add_u32 s24, s24, 1024
    buffer_load_dwordx4 v114, s[12:15], s23 offen  lds
    s_add_u32 s23, s23, 1024
    s_mov_b32 m0, s24
    s_add_u32 s24, s24, 1024
    buffer_load_dwordx4 v115, s[12:15], s23 offen  lds
    s_add_u32 s23, s23, 1024
    s_mov_b32 m0, s24
    s_add_u32 s24, s24, 1024
    buffer_load_dwordx4 v116, s[12:15], s23 offen  lds
    s_add_u32 s23, s23, 1024
    s_mov_b32 m0, s24
    s_nop 0
    buffer_load_dwordx4 v117, s[12:15], s23 offen  lds
    v_add_u32 v119, 98304, v110
    ds_read_b64_tr_b16 a[64:65], v119 offset:0
    ds_read_b64_tr_b16 a[66:67], v119 offset:1024
    ds_read_b64_tr_b16 a[72:73], v119 offset:8192
    ds_read_b64_tr_b16 a[74:75], v119 offset:9216
    v_add_u32 v119, 98304, v111
    ds_read_b64_tr_b16 a[68:69], v119 offset:0
    ds_read_b64_tr_b16 a[70:71], v119 offset:1024
    ds_read_b64_tr_b16 a[76:77], v119 offset:8192
    ds_read_b64_tr_b16 a[78:79], v119 offset:9216
    s_waitcnt vmcnt(24) lgkmcnt(0)
    s_barrier
    s_lshl_b32 s23, s3, 12
    s_add_u32 s23, s23, s30
    s_add_u32 s23, s23, 65536
    s_lshl_b32 s24, s3, 12
    s_add_u32 s24, s24, 98304
    s_mov_b32 m0, s24
    s_add_u32 s24, s24, 1024
    buffer_load_dwordx4 v114, s[12:15], s23 offen  lds
    s_add_u32 s23, s23, 1024
    s_mov_b32 m0, s24
    s_add_u32 s24, s24, 1024
    buffer_load_dwordx4 v115, s[12:15], s23 offen  lds
    s_add_u32 s23, s23, 1024
    s_mov_b32 m0, s24
    s_add_u32 s24, s24, 1024
    buffer_load_dwordx4 v116, s[12:15], s23 offen  lds
    s_add_u32 s23, s23, 1024
    s_mov_b32 m0, s24
    s_nop 0
    buffer_load_dwordx4 v117, s[12:15], s23 offen  lds
    v_add_u32 v119, 114688, v110
    ds_read_b64_tr_b16 a[80:81], v119 offset:0
    ds_read_b64_tr_b16 a[82:83], v119 offset:1024
    ds_read_b64_tr_b16 a[88:89], v119 offset:8192
    ds_read_b64_tr_b16 a[90:91], v119 offset:9216
    v_add_u32 v119, 114688, v111
    ds_read_b64_tr_b16 a[84:85], v119 offset:0
    ds_read_b64_tr_b16 a[86:87], v119 offset:1024
    ds_read_b64_tr_b16 a[92:93], v119 offset:8192
    ds_read_b64_tr_b16 a[94:95], v119 offset:9216
    s_waitcnt vmcnt(24) lgkmcnt(0)
    s_barrier
    s_lshl_b32 s23, s3, 12
    s_add_u32 s23, s23, s30
    s_add_u32 s23, s23, 81920
    s_lshl_b32 s24, s3, 12
    s_add_u32 s24, s24, 114688
    s_mov_b32 m0, s24
    s_add_u32 s24, s24, 1024
    buffer_load_dwordx4 v114, s[12:15], s23 offen  lds
    s_add_u32 s23, s23, 1024
    s_mov_b32 m0, s24
    s_add_u32 s24, s24, 1024
    buffer_load_dwordx4 v115, s[12:15], s23 offen  lds
    s_add_u32 s23, s23, 1024
    s_mov_b32 m0, s24
    s_add_u32 s24, s24, 1024
    buffer_load_dwordx4 v116, s[12:15], s23 offen  lds
    s_add_u32 s23, s23, 1024
    s_mov_b32 m0, s24
    s_nop 0
    buffer_load_dwordx4 v117, s[12:15], s23 offen  lds
    v_add_u32 v119, 131072, v110
    ds_read_b64_tr_b16 a[96:97], v119 offset:0
    ds_read_b64_tr_b16 a[98:99], v119 offset:1024
    ds_read_b64_tr_b16 a[104:105], v119 offset:8192
    ds_read_b64_tr_b16 a[106:107], v119 offset:9216
    v_add_u32 v119, 131072, v111
    ds_read_b64_tr_b16 a[100:101], v119 offset:0
    ds_read_b64_tr_b16 a[102:103], v119 offset:1024
    ds_read_b64_tr_b16 a[108:109], v119 offset:8192
    ds_read_b64_tr_b16 a[110:111], v119 offset:9216
    s_waitcnt vmcnt(24) lgkmcnt(0)
    s_barrier
    s_lshl_b32 s23, s3, 12
    s_add_u32 s23, s23, s30
    s_add_u32 s23, s23, 98304
    s_lshl_b32 s24, s3, 12
    s_add_u32 s24, s24, 131072
    s_mov_b32 m0, s24
    s_add_u32 s24, s24, 1024
    buffer_load_dwordx4 v114, s[12:15], s23 offen  lds
    s_add_u32 s23, s23, 1024
    s_mov_b32 m0, s24
    s_add_u32 s24, s24, 1024
    buffer_load_dwordx4 v115, s[12:15], s23 offen  lds
    s_add_u32 s23, s23, 1024
    s_mov_b32 m0, s24
    s_add_u32 s24, s24, 1024
    buffer_load_dwordx4 v116, s[12:15], s23 offen  lds
    s_add_u32 s23, s23, 1024
    s_mov_b32 m0, s24
    s_nop 0
    buffer_load_dwordx4 v117, s[12:15], s23 offen  lds
    v_add_u32 v119, 147456, v110
    ds_read_b64_tr_b16 a[112:113], v119 offset:0
    ds_read_b64_tr_b16 a[114:115], v119 offset:1024
    ds_read_b64_tr_b16 a[120:121], v119 offset:8192
    ds_read_b64_tr_b16 a[122:123], v119 offset:9216
    v_add_u32 v119, 147456, v111
    ds_read_b64_tr_b16 a[116:117], v119 offset:0
    ds_read_b64_tr_b16 a[118:119], v119 offset:1024
    ds_read_b64_tr_b16 a[124:125], v119 offset:8192
    ds_read_b64_tr_b16 a[126:127], v119 offset:9216
    s_waitcnt vmcnt(24) lgkmcnt(0)
    s_barrier
    s_lshl_b32 s23, s3, 12
    s_add_u32 s23, s23, s30
    s_add_u32 s23, s23, 114688
    s_lshl_b32 s24, s3, 12
    s_add_u32 s24, s24, 147456
    s_mov_b32 m0, s24
    s_add_u32 s24, s24, 1024
    buffer_load_dwordx4 v114, s[12:15], s23 offen  lds
    s_add_u32 s23, s23, 1024
    s_mov_b32 m0, s24
    s_add_u32 s24, s24, 1024
    buffer_load_dwordx4 v115, s[12:15], s23 offen  lds
    s_add_u32 s23, s23, 1024
    s_mov_b32 m0, s24
    s_add_u32 s24, s24, 1024
    buffer_load_dwordx4 v116, s[12:15], s23 offen  lds
    s_add_u32 s23, s23, 1024
    s_mov_b32 m0, s24
    s_nop 0
    buffer_load_dwordx4 v117, s[12:15], s23 offen  lds
    v_xor_b32 v119, 0, v118
    v_add_u32 v119, 32768, v119
    ds_read_b64_tr_b16 a[128:129], v119
    v_xor_b32 v119, 32, v118
    v_add_u32 v119, 32768, v119
    ds_read_b64_tr_b16 a[144:145], v119
    v_xor_b32 v119, 64, v118
    v_add_u32 v119, 32768, v119
    ds_read_b64_tr_b16 a[160:161], v119
    v_xor_b32 v119, 96, v118
    v_add_u32 v119, 32768, v119
    ds_read_b64_tr_b16 a[176:177], v119
    v_xor_b32 v119, 128, v118
    v_add_u32 v119, 32768, v119
    ds_read_b64_tr_b16 a[192:193], v119
    v_xor_b32 v119, 160, v118
    v_add_u32 v119, 32768, v119
    ds_read_b64_tr_b16 a[208:209], v119
    v_xor_b32 v119, 192, v118
    v_add_u32 v119, 32768, v119
    ds_read_b64_tr_b16 a[224:225], v119
    v_xor_b32 v119, 224, v118
    v_add_u32 v119, 32768, v119
    ds_read_b64_tr_b16 a[240:241], v119
    s_waitcnt vmcnt(24) lgkmcnt(0)
    s_barrier
    v_xor_b32 v119, 0, v118
    v_add_u32 v119, 49152, v119
    ds_read_b64_tr_b16 a[130:131], v119
    v_xor_b32 v119, 32, v118
    v_add_u32 v119, 49152, v119
    ds_read_b64_tr_b16 a[146:147], v119
    v_xor_b32 v119, 64, v118
    v_add_u32 v119, 49152, v119
    ds_read_b64_tr_b16 a[162:163], v119
    v_xor_b32 v119, 96, v118
    v_add_u32 v119, 49152, v119
    ds_read_b64_tr_b16 a[178:179], v119
    v_xor_b32 v119, 128, v118
    v_add_u32 v119, 49152, v119
    ds_read_b64_tr_b16 a[194:195], v119
    v_xor_b32 v119, 160, v118
    v_add_u32 v119, 49152, v119
    ds_read_b64_tr_b16 a[210:211], v119
    v_xor_b32 v119, 192, v118
    v_add_u32 v119, 49152, v119
    ds_read_b64_tr_b16 a[226:227], v119
    v_xor_b32 v119, 224, v118
    v_add_u32 v119, 49152, v119
    ds_read_b64_tr_b16 a[242:243], v119
    s_waitcnt vmcnt(20) lgkmcnt(0)
    s_barrier
    v_xor_b32 v119, 0, v118
    v_add_u32 v119, 65536, v119
    ds_read_b64_tr_b16 a[132:133], v119
    v_xor_b32 v119, 32, v118
    v_add_u32 v119, 65536, v119
    ds_read_b64_tr_b16 a[148:149], v119
    v_xor_b32 v119, 64, v118
    v_add_u32 v119, 65536, v119
    ds_read_b64_tr_b16 a[164:165], v119
    v_xor_b32 v119, 96, v118
    v_add_u32 v119, 65536, v119
    ds_read_b64_tr_b16 a[180:181], v119
    v_xor_b32 v119, 128, v118
    v_add_u32 v119, 65536, v119
    ds_read_b64_tr_b16 a[196:197], v119
    v_xor_b32 v119, 160, v118
    v_add_u32 v119, 65536, v119
    ds_read_b64_tr_b16 a[212:213], v119
    v_xor_b32 v119, 192, v118
    v_add_u32 v119, 65536, v119
    ds_read_b64_tr_b16 a[228:229], v119
    v_xor_b32 v119, 224, v118
    v_add_u32 v119, 65536, v119
    ds_read_b64_tr_b16 a[244:245], v119
    s_waitcnt vmcnt(16) lgkmcnt(0)
    s_barrier
    v_xor_b32 v119, 0, v118
    v_add_u32 v119, 81920, v119
    ds_read_b64_tr_b16 a[134:135], v119
    v_xor_b32 v119, 32, v118
    v_add_u32 v119, 81920, v119
    ds_read_b64_tr_b16 a[150:151], v119
    v_xor_b32 v119, 64, v118
    v_add_u32 v119, 81920, v119
    ds_read_b64_tr_b16 a[166:167], v119
    v_xor_b32 v119, 96, v118
    v_add_u32 v119, 81920, v119
    ds_read_b64_tr_b16 a[182:183], v119
    v_xor_b32 v119, 128, v118
    v_add_u32 v119, 81920, v119
    ds_read_b64_tr_b16 a[198:199], v119
    v_xor_b32 v119, 160, v118
    v_add_u32 v119, 81920, v119
    ds_read_b64_tr_b16 a[214:215], v119
    v_xor_b32 v119, 192, v118
    v_add_u32 v119, 81920, v119
    ds_read_b64_tr_b16 a[230:231], v119
    v_xor_b32 v119, 224, v118
    v_add_u32 v119, 81920, v119
    ds_read_b64_tr_b16 a[246:247], v119
    s_waitcnt vmcnt(12) lgkmcnt(0)
    s_barrier
    v_xor_b32 v119, 0, v118
    v_add_u32 v119, 98304, v119
    ds_read_b64_tr_b16 a[136:137], v119
    v_xor_b32 v119, 32, v118
    v_add_u32 v119, 98304, v119
    ds_read_b64_tr_b16 a[152:153], v119
    v_xor_b32 v119, 64, v118
    v_add_u32 v119, 98304, v119
    ds_read_b64_tr_b16 a[168:169], v119
    v_xor_b32 v119, 96, v118
    v_add_u32 v119, 98304, v119
    ds_read_b64_tr_b16 a[184:185], v119
    v_xor_b32 v119, 128, v118
    v_add_u32 v119, 98304, v119
    ds_read_b64_tr_b16 a[200:201], v119
    v_xor_b32 v119, 160, v118
    v_add_u32 v119, 98304, v119
    ds_read_b64_tr_b16 a[216:217], v119
    v_xor_b32 v119, 192, v118
    v_add_u32 v119, 98304, v119
    ds_read_b64_tr_b16 a[232:233], v119
    v_xor_b32 v119, 224, v118
    v_add_u32 v119, 98304, v119
    ds_read_b64_tr_b16 a[248:249], v119
    s_waitcnt vmcnt(8) lgkmcnt(0)
    s_barrier
    v_xor_b32 v119, 0, v118
    v_add_u32 v119, 114688, v119
    ds_read_b64_tr_b16 a[138:139], v119
    v_xor_b32 v119, 32, v118
    v_add_u32 v119, 114688, v119
    ds_read_b64_tr_b16 a[154:155], v119
    v_xor_b32 v119, 64, v118
    v_add_u32 v119, 114688, v119
    ds_read_b64_tr_b16 a[170:171], v119
    v_xor_b32 v119, 96, v118
    v_add_u32 v119, 114688, v119
    ds_read_b64_tr_b16 a[186:187], v119
    v_xor_b32 v119, 128, v118
    v_add_u32 v119, 114688, v119
    ds_read_b64_tr_b16 a[202:203], v119
    v_xor_b32 v119, 160, v118
    v_add_u32 v119, 114688, v119
    ds_read_b64_tr_b16 a[218:219], v119
    v_xor_b32 v119, 192, v118
    v_add_u32 v119, 114688, v119
    ds_read_b64_tr_b16 a[234:235], v119
    v_xor_b32 v119, 224, v118
    v_add_u32 v119, 114688, v119
    ds_read_b64_tr_b16 a[250:251], v119
    s_waitcnt vmcnt(4) lgkmcnt(0)
    s_barrier
    v_xor_b32 v119, 0, v118
    v_add_u32 v119, 131072, v119
    ds_read_b64_tr_b16 a[140:141], v119
    v_xor_b32 v119, 32, v118
    v_add_u32 v119, 131072, v119
    ds_read_b64_tr_b16 a[156:157], v119
    v_xor_b32 v119, 64, v118
    v_add_u32 v119, 131072, v119
    ds_read_b64_tr_b16 a[172:173], v119
    v_xor_b32 v119, 96, v118
    v_add_u32 v119, 131072, v119
    ds_read_b64_tr_b16 a[188:189], v119
    v_xor_b32 v119, 128, v118
    v_add_u32 v119, 131072, v119
    ds_read_b64_tr_b16 a[204:205], v119
    v_xor_b32 v119, 160, v118
    v_add_u32 v119, 131072, v119
    ds_read_b64_tr_b16 a[220:221], v119
    v_xor_b32 v119, 192, v118
    v_add_u32 v119, 131072, v119
    ds_read_b64_tr_b16 a[236:237], v119
    v_xor_b32 v119, 224, v118
    v_add_u32 v119, 131072, v119
    ds_read_b64_tr_b16 a[252:253], v119
    s_waitcnt vmcnt(0) lgkmcnt(0)
    s_barrier
    v_xor_b32 v119, 0, v118
    v_add_u32 v119, 147456, v119
    ds_read_b64_tr_b16 a[142:143], v119
    v_xor_b32 v119, 32, v118
    v_add_u32 v119, 147456, v119
    ds_read_b64_tr_b16 a[158:159], v119
    v_xor_b32 v119, 64, v118
    v_add_u32 v119, 147456, v119
    ds_read_b64_tr_b16 a[174:175], v119
    v_xor_b32 v119, 96, v118
    v_add_u32 v119, 147456, v119
    ds_read_b64_tr_b16 a[190:191], v119
    v_xor_b32 v119, 128, v118
    v_add_u32 v119, 147456, v119
    ds_read_b64_tr_b16 a[206:207], v119
    v_xor_b32 v119, 160, v118
    v_add_u32 v119, 147456, v119
    ds_read_b64_tr_b16 a[222:223], v119
    v_xor_b32 v119, 192, v118
    v_add_u32 v119, 147456, v119
    ds_read_b64_tr_b16 a[238:239], v119
    v_xor_b32 v119, 224, v118
    v_add_u32 v119, 147456, v119
    ds_read_b64_tr_b16 a[254:255], v119
    s_waitcnt lgkmcnt(0)
    s_barrier
L_fnw_24:
    v_lshlrev_b32 v36, 1, v3
    s_mov_b32 s21, 10240
    s_mov_b32 s22, 0
L_m4_25:
    buffer_load_dwordx4 v[32:35], v36, s[8:11], s21 offen sc1
    s_add_u32 s22, s22, 1
    s_cmp_gt_u32 s22, 100000
    s_cbranch_scc1 L_fail
    s_waitcnt vmcnt(0)
    v_bitop3_b32 v33, v33, v35, s7 bitop3:0x7e
    v_cmp_ne_u32 vcc, 0, v33
    s_cbranch_vccnz L_m4_25
    v_lshlrev_b32 v8, 16, v32
    v_and_b32 v9, 0xffff0000, v32
    v_lshlrev_b32 v10, 16, v34
    v_and_b32 v11, 0xffff0000, v34
    v_lshlrev_b32 v36, 1, v3
    s_mov_b32 s21, 6144
    s_mov_b32 s22, 0
L_m4_26:
    buffer_load_dwordx4 v[32:35], v36, s[8:11], s21 offen sc1
    s_add_u32 s22, s22, 1
    s_cmp_gt_u32 s22, 100000
    s_cbranch_scc1 L_fail
    s_waitcnt vmcnt(0)
    v_bitop3_b32 v33, v33, v35, s7 bitop3:0x7e
    v_cmp_ne_u32 vcc, 0, v33
    s_cbranch_vccnz L_m4_26
    v_lshlrev_b32 v20, 16, v32
    v_and_b32 v21, 0xffff0000, v32
    v_lshlrev_b32 v22, 16, v34
    v_and_b32 v23, 0xffff0000, v34
    v_lshlrev_b32 v36, 1, v3
    s_mov_b32 s21, 8192
    s_mov_b32 s22, 0
L_m4_27:
    buffer_load_dwordx4 v[32:35], v36, s[8:11], s21 offen sc1
    s_add_u32 s22, s22, 1
    s_cmp_gt_u32 s22, 100000
    s_cbranch_scc1 L_fail
    s_waitcnt vmcnt(0)
    v_bitop3_b32 v33, v33, v35, s7 bitop3:0x7e
    v_cmp_ne_u32 vcc, 0, v33
    s_cbranch_vccnz L_m4_27
    v_lshlrev_b32 v16, 16, v32
    v_and_b32 v17, 0xffff0000, v32
    v_lshlrev_b32 v18, 16, v34
    v_and_b32 v19, 0xffff0000, v34
    v_add_f32 v16, 1.0, v16
    v_add_f32 v17, 1.0, v17
    v_add_f32 v18, 1.0, v18
    v_add_f32 v19, 1.0, v19
    s_cmp_eq_u32 s3, 0
    s_cbranch_scc0 L_wg_29
    s_mov_b32 s22, 0
    v_mbcnt_lo_u32_b32 v32, -1, 0
    v_mbcnt_hi_u32_b32 v32, -1, v32
    v_lshlrev_b32 v32, 2, v32
    v_and_b32 v33, 127, v32
L_wf_28:
    v_mov_b32 v34, s7
    v_mov_b32 v35, s7
    v_mov_b32 v36, s7
    s_mov_b32 s20, 0x11800
    buffer_load_dword v34, v32, s[8:11], s20 offen sc1
    buffer_load_dword v35, v32, s[8:11], s20 offen offset:256 sc1
    s_lshl_b32 s20, s5, 7
    s_add_u32 s20, s20, 0x12000
    buffer_load_dword v36, v33, s[8:11], s20 offen sc1
    s_add_u32 s22, s22, 1
    s_cmp_gt_u32 s22, 100000
    s_cbranch_scc1 L_fail
    s_waitcnt vmcnt(0)
    v_bitop3_b32 v34, v34, v35, s7 bitop3:0x7e
    v_bitop3_b32 v34, v34, v36, s7 bitop3:0xf6
    v_cmp_ne_u32 vcc, 0, v34
    s_cbranch_vccz L_wh_30
    s_sleep 6
    s_branch L_wf_28
L_wh_30:
L_wg_29:
    s_barrier
    s_mov_b32 s12, s64
    s_and_b32 s13, s65, 0xffff
    s_mov_b32 s14, 0x200000
    s_mov_b32 s15, 0x20000
    s_mov_b32 s28, 0x7f817f81
    s_mov_b32 s31, 0xbfb8aa3b
L_ff_31:
    s_lshl_b32 s30, s25, 5
    s_add_u32 s30, s30, s4
    s_lshl_b32 s30, s30, 10
    s_bfe_u32 s27, s25, 0x10002
    s_bfe_u32 s20, s25, 0x10001
    s_lshl_b32 s21, s20, 19
    s_add_u32 s29, s21, s26
    s_lshl_b32 s20, s20, 15
    s_add_u32 s32, s20, s33
    s_add_u32 s20, s30, 0x600000
    s_mov_b32 s22, 0
L_ffx_34:
    buffer_load_dwordx2 v[24:25], v3, s[8:11], s20 offen sc1
    s_add_u32 s22, s22, 1
    s_cmp_gt_u32 s22, 100000
    s_cbranch_scc1 L_fail
    s_waitcnt vmcnt(0)
    v_cmp_eq_u32 vcc, s28, v24
    s_cbranch_vccz L_ffk_35
    s_cmp_ge_u32 s25, 60
    s_cbranch_scc1 L_ffx_34
    s_sleep 2
    s_branch L_ffx_34
L_ffk_35:
    v_lshlrev_b32 v28, 16, v24
    v_and_b32 v29, 0xffff0000, v24
    v_lshlrev_b32 v30, 16, v25
    v_and_b32 v31, 0xffff0000, v25
    v_add_f32 v32, v28, v29
    v_add_f32 v33, v30, v31
    v_add_f32 v32, v32, v33
    s_nop 1
    v_add_f32_dpp v32, v32, v32 row_ror:8 row_mask:0xf bank_mask:0xf
    s_nop 1
    v_add_f32_dpp v32, v32, v32 row_ror:4 row_mask:0xf bank_mask:0xf
    s_nop 1
    v_add_f32_dpp v32, v32, v32 row_ror:2 row_mask:0xf bank_mask:0xf
    s_nop 1
    v_add_f32_dpp v32, v32, v32 row_ror:1 row_mask:0xf bank_mask:0xf
    v_mov_b32 v34, v32
    s_nop 1
    v_permlane16_swap_b32 v32, v34
    v_add_f32 v32, v32, v34
    v_mul_f32 v32, 0x3c000000, v32
    v_sub_f32 v36, v28, v32
    v_sub_f32 v37, v29, v32
    v_sub_f32 v38, v30, v32
    v_sub_f32 v39, v31, v32
    v_mul_f32 v33, v36, v36
    v_fmac_f32 v33, v37, v37
    v_fmac_f32 v33, v38, v38
    v_fmac_f32 v33, v39, v39
    s_nop 1
    v_add_f32_dpp v33, v33, v33 row_ror:8 row_mask:0xf bank_mask:0xf
    s_nop 1
    v_add_f32_dpp v33, v33, v33 row_ror:4 row_mask:0xf bank_mask:0xf
    s_nop 1
    v_add_f32_dpp v33, v33, v33 row_ror:2 row_mask:0xf bank_mask:0xf
    s_nop 1
    v_add_f32_dpp v33, v33, v33 row_ror:1 row_mask:0xf bank_mask:0xf
    v_mov_b32 v34, v33
    s_nop 1
    v_permlane16_swap_b32 v33, v34
    v_add_f32 v33, v33, v34
    s_lshl_b32 s21, s3, 3
    v_mov_b32 v34, s21
    ds_write_b64 v34, v[32:33] offset:20480
    v_mov_b32 v34, 0
    s_waitcnt lgkmcnt(0)
    s_barrier
    ds_read_b128 v[36:39], v34 offset:20480
    ds_read_b128 v[40:43], v34 offset:20496
    s_waitcnt lgkmcnt(0)
    v_add_f32 v32, v36, v38
    v_add_f32 v33, v40, v42
    v_add_f32 v32, v32, v33
    v_mul_f32 v32, 0x3e800000, v32
    v_add_f32 v33, v37, v39
    v_add_f32 v34, v41, v43
    v_add_f32 v33, v33, v34
    v_sub_f32 v36, v36, v32
    v_sub_f32 v38, v38, v32
    v_sub_f32 v40, v40, v32
    v_sub_f32 v42, v42, v32
    v_mul_f32 v34, v36, v36
    v_fmac_f32 v34, v38, v38
    v_fmac_f32 v34, v40, v40
    v_fmac_f32 v34, v42, v42
    v_fmac_f32 v33, 0x43000000, v34
    v_mov_b32 v34, 0x3727c5ac
    v_fmac_f32 v34, 0x3b000000, v33
    v_rsq_f32 v34, v34
    v_sub_f32 v36, v28, v32
    v_sub_f32 v37, v29, v32
    v_sub_f32 v38, v30, v32
    v_sub_f32 v39, v31, v32
    v_mul_f32 v36, v36, v34
    v_mul_f32 v37, v37, v34
    v_mul_f32 v38, v38, v34
    v_mul_f32 v39, v39, v34
    v_fma_f32 v36, v36, v16, v20
    v_fma_f32 v37, v37, v17, v21
    v_fma_f32 v38, v38, v18, v22
    v_fma_f32 v39, v39, v19, v23
    v_cvt_pk_bf16_f32 v36, v36, v37
    v_cvt_pk_bf16_f32 v37, v38, v39
    v_bfi_b32 v36, v6, s27, v36
    buffer_store_dwordx2 v[36:37], v1, s[8:11], s32 offen
    s_cmp_ge_u32 s4, 28
    s_cbranch_scc1 L_ffz_33
    s_and_b32 s20, s4, 1
    s_lshl_b32 s20, s20, 14
    s_add_u32 s32, s32, s20
    s_lshl_b32 s24, s3, 12
    s_add_u32 s32, s32, s24
    s_mov_b32 s22, 0
    s_mov_b32 m0, s24
    s_nop 15
    s_nop 15
    s_nop 15
    s_nop 15
L_ffq_36:
    buffer_load_dwordx4 v0, s[8:11], s32 offen offset:0 sc1 lds
    buffer_load_dwordx4 v0, s[8:11], s32 offen offset:1024 sc1 lds
    buffer_load_dwordx4 v0, s[8:11], s32 offen offset:2048 sc1 lds
    buffer_load_dwordx4 v0, s[8:11], s32 offen offset:3072 sc1 lds
    s_add_u32 s22, s22, 1
    s_cmp_gt_u32 s22, 100000
    s_cbranch_scc1 L_fail
    s_waitcnt vmcnt(0)
    ds_read2st64_b32 v[32:33], v5 offset0:0 offset1:4
    ds_read2st64_b32 v[34:35], v5 offset0:8 offset1:12
    s_waitcnt lgkmcnt(0)
    v_bitop3_b32 v32, v32, v33, s27 bitop3:0x7e
    v_bitop3_b32 v34, v34, v35, s27 bitop3:0x7e
    v_or_b32 v32, v32, v34
    v_and_b32 v32, 1, v32
    v_cmp_ne_u32 vcc, 0, v32
    s_cbranch_vccnz L_ffq_36
    s_barrier
    ds_read_b128 v[32:35], v0 offset:0
    ds_read_b128 v[36:39], v0 offset:1024
    ds_read_b128 v[40:43], v0 offset:2048
    ds_read_b128 v[44:47], v0 offset:3072
    s_waitcnt lgkmcnt(3)
    v_mfma_f32_16x16x32_bf16 v[96:99], a[0:3], v[32:35], 0
    ds_read_b128 v[48:51], v0 offset:4096
    v_mfma_f32_16x16x32_bf16 v[100:103], a[4:7], v[32:35], 0
    s_waitcnt lgkmcnt(3)
    v_mfma_f32_16x16x32_bf16 v[96:99], a[8:11], v[36:39], v[96:99]
    ds_read_b128 v[52:55], v0 offset:5120
    v_mfma_f32_16x16x32_bf16 v[100:103], a[12:15], v[36:39], v[100:103]
    s_waitcnt lgkmcnt(3)
    v_mfma_f32_16x16x32_bf16 v[96:99], a[16:19], v[40:43], v[96:99]
    ds_read_b128 v[56:59], v0 offset:6144
    v_mfma_f32_16x16x32_bf16 v[100:103], a[20:23], v[40:43], v[100:103]
    s_waitcnt lgkmcnt(3)
    v_mfma_f32_16x16x32_bf16 v[96:99], a[24:27], v[44:47], v[96:99]
    ds_read_b128 v[60:63], v0 offset:7168
    v_mfma_f32_16x16x32_bf16 v[100:103], a[28:31], v[44:47], v[100:103]
    s_waitcnt lgkmcnt(3)
    v_mfma_f32_16x16x32_bf16 v[96:99], a[32:35], v[48:51], v[96:99]
    ds_read_b128 v[64:67], v0 offset:8192
    v_mfma_f32_16x16x32_bf16 v[100:103], a[36:39], v[48:51], v[100:103]
    s_waitcnt lgkmcnt(3)
    v_mfma_f32_16x16x32_bf16 v[96:99], a[40:43], v[52:55], v[96:99]
    ds_read_b128 v[68:71], v0 offset:9216
    v_mfma_f32_16x16x32_bf16 v[100:103], a[44:47], v[52:55], v[100:103]
    s_waitcnt lgkmcnt(3)
    v_mfma_f32_16x16x32_bf16 v[96:99], a[48:51], v[56:59], v[96:99]
    ds_read_b128 v[72:75], v0 offset:10240
    v_mfma_f32_16x16x32_bf16 v[100:103], a[52:55], v[56:59], v[100:103]
    s_waitcnt lgkmcnt(3)
    v_mfma_f32_16x16x32_bf16 v[96:99], a[56:59], v[60:63], v[96:99]
    ds_read_b128 v[76:79], v0 offset:11264
    v_mfma_f32_16x16x32_bf16 v[100:103], a[60:63], v[60:63], v[100:103]
    s_waitcnt lgkmcnt(3)
    v_mfma_f32_16x16x32_bf16 v[96:99], a[64:67], v[64:67], v[96:99]
    ds_read_b128 v[80:83], v0 offset:12288
    v_mfma_f32_16x16x32_bf16 v[100:103], a[68:71], v[64:67], v[100:103]
    s_waitcnt lgkmcnt(3)
    v_mfma_f32_16x16x32_bf16 v[96:99], a[72:75], v[68:71], v[96:99]
    ds_read_b128 v[84:87], v0 offset:13312
    v_mfma_f32_16x16x32_bf16 v[100:103], a[76:79], v[68:71], v[100:103]
    s_waitcnt lgkmcnt(3)
    v_mfma_f32_16x16x32_bf16 v[96:99], a[80:83], v[72:75], v[96:99]
    ds_read_b128 v[88:91], v0 offset:14336
    v_mfma_f32_16x16x32_bf16 v[100:103], a[84:87], v[72:75], v[100:103]
    s_waitcnt lgkmcnt(3)
    v_mfma_f32_16x16x32_bf16 v[96:99], a[88:91], v[76:79], v[96:99]
    ds_read_b128 v[92:95], v0 offset:15360
    v_mfma_f32_16x16x32_bf16 v[100:103], a[92:95], v[76:79], v[100:103]
    s_waitcnt lgkmcnt(3)
    v_mfma_f32_16x16x32_bf16 v[96:99], a[96:99], v[80:83], v[96:99]
    v_mfma_f32_16x16x32_bf16 v[100:103], a[100:103], v[80:83], v[100:103]
    s_waitcnt lgkmcnt(2)
    v_mfma_f32_16x16x32_bf16 v[96:99], a[104:107], v[84:87], v[96:99]
    v_mfma_f32_16x16x32_bf16 v[100:103], a[108:111], v[84:87], v[100:103]
    s_waitcnt lgkmcnt(1)
    v_mfma_f32_16x16x32_bf16 v[96:99], a[112:115], v[88:91], v[96:99]
    v_mfma_f32_16x16x32_bf16 v[100:103], a[116:119], v[88:91], v[100:103]
    s_waitcnt lgkmcnt(0)
    v_mfma_f32_16x16x32_bf16 v[96:99], a[120:123], v[92:95], v[96:99]
    v_mfma_f32_16x16x32_bf16 v[100:103], a[124:127], v[92:95], v[100:103]
    s_lshr_b32 s20, s4, 1
    s_lshl_b32 s20, s20, 10
    s_lshl_b32 s21, s3, 8
    s_add_u32 s20, s20, s21
    s_add_u32 s20, s20, s29
    s_and_b32 s21, s4, 1
    s_lshl_b32 s21, s21, 18
    s_add_u32 s20, s20, s21
    v_cvt_pk_bf16_f32 v104, v96, v97
    v_lshlrev_b32 v96, 16, v104
    v_and_b32 v97, 0xffff0000, v104
    v_cvt_pk_bf16_f32 v104, v98, v99
    v_lshlrev_b32 v98, 16, v104
    v_and_b32 v99, 0xffff0000, v104
    v_cvt_pk_bf16_f32 v104, v100, v101
    v_lshlrev_b32 v100, 16, v104
    v_and_b32 v101, 0xffff0000, v104
    v_cvt_pk_bf16_f32 v104, v102, v103
    v_lshlrev_b32 v102, 16, v104
    v_and_b32 v103, 0xffff0000, v104
    v_mul_f32 v104, s31, v96
    v_mul_f32 v105, s31, v97
    v_mul_f32 v106, s31, v98
    v_mul_f32 v107, s31, v99
    v_mul_f32 v108, s31, v100
    v_mul_f32 v109, s31, v101
    v_mul_f32 v110, s31, v102
    v_mul_f32 v111, s31, v103
    v_exp_f32 v104, v104
    v_exp_f32 v105, v105
    v_exp_f32 v106, v106
    v_exp_f32 v107, v107
    v_exp_f32 v108, v108
    v_exp_f32 v109, v109
    v_exp_f32 v110, v110
    v_exp_f32 v111, v111
    v_add_f32 v104, 1.0, v104
    v_add_f32 v105, 1.0, v105
    v_add_f32 v106, 1.0, v106
    v_add_f32 v107, 1.0, v107
    v_add_f32 v108, 1.0, v108
    v_add_f32 v109, 1.0, v109
    v_add_f32 v110, 1.0, v110
    v_add_f32 v111, 1.0, v111
    v_rcp_f32 v104, v104
    v_rcp_f32 v105, v105
    v_rcp_f32 v106, v106
    v_rcp_f32 v107, v107
    v_rcp_f32 v108, v108
    v_rcp_f32 v109, v109
    v_rcp_f32 v110, v110
    v_rcp_f32 v111, v111
    v_mul_f32 v96, v96, v104
    v_mul_f32 v97, v97, v105
    v_mul_f32 v98, v98, v106
    v_mul_f32 v99, v99, v107
    v_mul_f32 v100, v100, v108
    v_mul_f32 v101, v101, v109
    v_mul_f32 v102, v102, v110
    v_mul_f32 v103, v103, v111
    v_cvt_pk_bf16_f32 v96, v96, v97
    v_cvt_pk_bf16_f32 v97, v98, v99
    v_cvt_pk_bf16_f32 v98, v100, v101
    v_cvt_pk_bf16_f32 v99, v102, v103
    ds_write_b128 v7, v[96:99]
    s_waitcnt lgkmcnt(0)
    s_barrier
    ds_read_b128 v[32:35], v0 offset:16384
    ds_read_b128 v[36:39], v0 offset:17408
    ds_read_b128 v[40:43], v0 offset:18432
    ds_read_b128 v[44:47], v0 offset:19456
    s_waitcnt lgkmcnt(3)
    v_mfma_f32_16x16x32_bf16 v[64:67], a[128:131], v[32:35], 0
    v_mfma_f32_16x16x32_bf16 v[68:71], a[144:147], v[32:35], 0
    s_waitcnt lgkmcnt(2)
    v_mfma_f32_16x16x32_bf16 v[64:67], a[132:135], v[36:39], v[64:67]
    v_mfma_f32_16x16x32_bf16 v[68:71], a[148:151], v[36:39], v[68:71]
    s_waitcnt lgkmcnt(1)
    v_mfma_f32_16x16x32_bf16 v[64:67], a[136:139], v[40:43], v[64:67]
    v_mfma_f32_16x16x32_bf16 v[68:71], a[152:155], v[40:43], v[68:71]
    s_waitcnt lgkmcnt(0)
    v_mfma_f32_16x16x32_bf16 v[64:67], a[140:143], v[44:47], v[64:67]
    v_mfma_f32_16x16x32_bf16 v[68:71], a[156:159], v[44:47], v[68:71]
    v_mfma_f32_16x16x32_bf16 v[72:75], a[160:163], v[32:35], 0
    v_mfma_f32_16x16x32_bf16 v[76:79], a[176:179], v[32:35], 0
    v_mfma_f32_16x16x32_bf16 v[72:75], a[164:167], v[36:39], v[72:75]
    v_cvt_pk_bf16_f32 v48, v64, v65
    v_mfma_f32_16x16x32_bf16 v[76:79], a[180:183], v[36:39], v[76:79]
    v_cvt_pk_bf16_f32 v49, v66, v67
    v_mfma_f32_16x16x32_bf16 v[72:75], a[168:171], v[40:43], v[72:75]
    v_cvt_pk_bf16_f32 v50, v68, v69
    v_mfma_f32_16x16x32_bf16 v[76:79], a[184:187], v[40:43], v[76:79]
    v_cvt_pk_bf16_f32 v51, v70, v71
    v_mfma_f32_16x16x32_bf16 v[72:75], a[172:175], v[44:47], v[72:75]
    v_bfi_b32 v48, 1, s27, v48
    v_mfma_f32_16x16x32_bf16 v[76:79], a[188:191], v[44:47], v[76:79]
    buffer_store_dwordx4 v[48:51], v2, s[8:11], s20 offen offset:0
    v_mfma_f32_16x16x32_bf16 v[64:67], a[192:195], v[32:35], 0
    v_mfma_f32_16x16x32_bf16 v[68:71], a[208:211], v[32:35], 0
    v_mfma_f32_16x16x32_bf16 v[64:67], a[196:199], v[36:39], v[64:67]
    v_cvt_pk_bf16_f32 v52, v72, v73
    v_mfma_f32_16x16x32_bf16 v[68:71], a[212:215], v[36:39], v[68:71]
    v_cvt_pk_bf16_f32 v53, v74, v75
    v_mfma_f32_16x16x32_bf16 v[64:67], a[200:203], v[40:43], v[64:67]
    v_cvt_pk_bf16_f32 v54, v76, v77
    v_mfma_f32_16x16x32_bf16 v[68:71], a[216:219], v[40:43], v[68:71]
    v_cvt_pk_bf16_f32 v55, v78, v79
    v_mfma_f32_16x16x32_bf16 v[64:67], a[204:207], v[44:47], v[64:67]
    v_bfi_b32 v52, 1, s27, v52
    v_mfma_f32_16x16x32_bf16 v[68:71], a[220:223], v[44:47], v[68:71]
    buffer_store_dwordx4 v[52:55], v2, s[8:11], s20 offen offset:64
    v_mfma_f32_16x16x32_bf16 v[72:75], a[224:227], v[32:35], 0
    v_mfma_f32_16x16x32_bf16 v[76:79], a[240:243], v[32:35], 0
    v_mfma_f32_16x16x32_bf16 v[72:75], a[228:231], v[36:39], v[72:75]
    v_cvt_pk_bf16_f32 v56, v64, v65
    v_mfma_f32_16x16x32_bf16 v[76:79], a[244:247], v[36:39], v[76:79]
    v_cvt_pk_bf16_f32 v57, v66, v67
    v_mfma_f32_16x16x32_bf16 v[72:75], a[232:235], v[40:43], v[72:75]
    v_cvt_pk_bf16_f32 v58, v68, v69
    v_mfma_f32_16x16x32_bf16 v[76:79], a[248:251], v[40:43], v[76:79]
    v_cvt_pk_bf16_f32 v59, v70, v71
    v_mfma_f32_16x16x32_bf16 v[72:75], a[236:239], v[44:47], v[72:75]
    v_bfi_b32 v56, 1, s27, v56
    v_mfma_f32_16x16x32_bf16 v[76:79], a[252:255], v[44:47], v[76:79]
    buffer_store_dwordx4 v[56:59], v2, s[8:11], s20 offen offset:128
    s_nop 3
    v_cvt_pk_bf16_f32 v60, v72, v73
    v_cvt_pk_bf16_f32 v61, v74, v75
    s_nop 0
    v_cvt_pk_bf16_f32 v62, v76, v77
    v_cvt_pk_bf16_f32 v63, v78, v79
    v_bfi_b32 v60, 1, s27, v60
    buffer_store_dwordx4 v[60:63], v2, s[8:11], s20 offen offset:192
L_ffr_32:
    s_lshl_b32 s20, s4, 14
    s_lshl_b32 s21, s3, 8
    s_add_u32 s20, s20, s21
    s_add_u32 s29, s29, s20
    s_nop 15
    s_nop 15
    s_nop 15
    s_nop 15
    s_nop 15
    s_mov_b32 s22, 0
L_rp_37:
    s_mov_b32 s20, s29
    buffer_load_dwordx4 v[64:67], v4, s[8:11], s20 offen sc1
    s_add_u32 s20, s20, 4096
    buffer_load_dwordx4 v[68:71], v4, s[8:11], s20 offen sc1
    s_add_u32 s20, s20, 4096
    buffer_load_dwordx4 v[72:75], v4, s[8:11], s20 offen sc1
    s_add_u32 s20, s20, 4096
    buffer_load_dwordx4 v[76:79], v4, s[8:11], s20 offen sc1
    s_add_u32 s22, s22, 1
    s_cmp_gt_u32 s22, 100000
    s_cbranch_scc1 L_fail
    s_waitcnt vmcnt(3)
    v_mfma_f32_16x16x32_bf16 v[96:99], v[12:15], v[64:67], 0
    v_xor_b32 v100, s27, v64
    s_waitcnt vmcnt(2)
    v_mfma_f32_16x16x32_bf16 v[96:99], v[12:15], v[68:71], v[96:99]
    v_bitop3_b32 v100, v100, v68, s27 bitop3:0xf6
    s_waitcnt vmcnt(1)
    v_mfma_f32_16x16x32_bf16 v[96:99], v[12:15], v[72:75], v[96:99]
    v_bitop3_b32 v100, v100, v72, s27 bitop3:0xf6
    s_waitcnt vmcnt(0)
    v_mfma_f32_16x16x32_bf16 v[96:99], v[12:15], v[76:79], v[96:99]
    v_bitop3_b32 v100, v100, v76, s27 bitop3:0xf6
    v_and_b32 v100, 1, v100
    v_cmp_ne_u32 vcc, 0, v100
    s_cbranch_vccnz L_rp_37
    s_nop 3
    v_cvt_pk_bf16_f32 v96, v96, v97
    v_cvt_pk_bf16_f32 v97, v98, v99
    v_lshlrev_b32 v98, 16, v97
    v_and_b32 v99, 0xffff0000, v97
    v_and_b32 v97, 0xffff0000, v96
    v_lshlrev_b32 v96, 16, v96
    v_mul_f32 v96, v8, v96
    v_mul_f32 v97, v9, v97
    v_mul_f32 v98, v10, v98
    v_mul_f32 v99, v11, v99
    v_cvt_pk_bf16_f32 v96, v96, v97
    v_cvt_pk_bf16_f32 v97, v98, v99
    v_lshlrev_b32 v98, 16, v97
    v_and_b32 v99, 0xffff0000, v97
    v_and_b32 v97, 0xffff0000, v96
    v_lshlrev_b32 v96, 16, v96
    v_add_f32 v96, v28, v96
    v_add_f32 v97, v29, v97
    v_add_f32 v98, v30, v98
    v_add_f32 v99, v31, v99
    v_cvt_pk_bf16_f32 v96, v96, v97
    v_cvt_pk_bf16_f32 v97, v98, v99
    buffer_store_dwordx2 v[96:97], v3, s[12:15], s30 offen sc1
    s_add_u32 s25, s25, 2
    s_cmp_lt_u32 s25, 64
    s_cbranch_scc1 L_ff_31
    s_branch L_done
L_ffz_33:
    s_lshr_b32 s20, s4, 1
    s_lshl_b32 s20, s20, 10
    s_lshl_b32 s21, s3, 8
    s_add_u32 s20, s20, s21
    s_add_u32 s20, s20, s29
    s_and_b32 s21, s4, 1
    s_lshl_b32 s21, s21, 18
    s_add_u32 s20, s20, s21
    v_mov_b32 v48, s27
    v_mov_b32 v49, 0
    v_mov_b32 v50, 0
    v_mov_b32 v51, 0
    buffer_store_dwordx4 v[48:51], v2, s[8:11], s20 offen offset:0
    buffer_store_dwordx4 v[48:51], v2, s[8:11], s20 offen offset:64
    buffer_store_dwordx4 v[48:51], v2, s[8:11], s20 offen offset:128
    buffer_store_dwordx4 v[48:51], v2, s[8:11], s20 offen offset:192
    s_branch L_ffr_32
L_role_att:
    s_load_dwordx4 s[60:63], s[0:1], 24
    s_load_dwordx2 s[64:65], s[0:1], 40
    s_load_dwordx2 s[66:67], s[0:1], 0
    v_and_b32 v100, 63, v0
    v_lshrrev_b32 v101, 4, v100
    v_and_b32 v102, 15, v100
    v_lshrrev_b32 v103, 2, v102
    v_and_b32 v104, 3, v102
    v_lshlrev_b32 v0, 4, v100
    v_and_b32 v105, 1, v101
    v_or_b32 v105, 0, v105
    v_lshlrev_b32 v105, 1, v105
    v_xor_b32 v105, v105, v102
    v_lshlrev_b32 v105, 4, v105
    v_lshl_add_u32 v108, v101, 13, v105
    v_and_b32 v105, 1, v101
    v_or_b32 v105, 2, v105
    v_lshlrev_b32 v105, 1, v105
    v_xor_b32 v105, v105, v102
    v_lshlrev_b32 v105, 4, v105
    v_lshl_add_u32 v109, v101, 13, v105
    v_and_b32 v105, 1, v101
    v_or_b32 v105, 4, v105
    v_lshlrev_b32 v105, 1, v105
    v_xor_b32 v105, v105, v102
    v_lshlrev_b32 v105, 4, v105
    v_lshl_add_u32 v110, v101, 13, v105
    v_and_b32 v105, 1, v101
    v_or_b32 v105, 6, v105
    v_lshlrev_b32 v105, 1, v105
    v_xor_b32 v105, v105, v102
    v_lshlrev_b32 v105, 4, v105
    v_lshl_add_u32 v111, v101, 13, v105
    v_lshrrev_b32 v105, 1, v101
    v_lshlrev_b32 v105, 4, v105
    v_lshrrev_b32 v106, 1, v103
    v_lshl_add_u32 v105, v106, 3, v105
    v_and_b32 v107, 1, v101
    v_lshl_add_u32 v105, v107, 2, v105
    v_and_b32 v119, 1, v103
    v_add_u32 v105, v105, v119
    v_lshl_add_u32 v119, v107, 1, v119
    v_lshl_add_u32 v119, v106, 2, v119
    s_lshl_b32 s20, s3, 1
    v_xor_b32 v119, s20, v119
    v_lshlrev_b32 v119, 5, v119
    v_lshl_add_u32 v119, v105, 8, v119
    v_lshl_add_u32 v112, v104, 3, v119
    v_xor_b32 v113, 32, v112
    s_and_b32 s21, s3, 1
    s_lshl_b32 s21, s21, 3
    v_xor_b32 v105, 0, v100
    v_xor_b32 v105, s21, v105
    v_lshlrev_b32 v114, 4, v105
    v_xor_b32 v105, 2, v100
    v_xor_b32 v105, s21, v105
    v_lshlrev_b32 v115, 4, v105
    v_xor_b32 v105, 4, v100
    v_xor_b32 v105, s21, v105
    v_lshlrev_b32 v116, 4, v105
    v_xor_b32 v105, 6, v100
    v_xor_b32 v105, s21, v105
    v_lshlrev_b32 v117, 4, v105
    v_lshl_add_u32 v105, v101, 2, v103
    v_and_b32 v106, 7, v105
    v_lshlrev_b32 v106, 5, v106
    v_lshl_add_u32 v106, v105, 10, v106
    v_lshl_add_u32 v106, v104, 3, v106
    s_lshl_b32 s21, s3, 8
    v_add_u32 v118, s21, v106
    v_and_b32 v105, 8, v100
    v_cmp_eq_u32 vcc, 0, v105
    v_mov_b32 v106, 0xeeeeeeee
    v_mov_b32 v107, 0x44444444
    v_cndmask_b32 v1, v106, v107, vcc
    v_xor_b32 v106, v101, v103
    v_lshlrev_b32 v105, 5, v102
    v_lshl_add_u32 v105, v106, 3, v105
    s_lshl_b32 s20, s3, 10
    s_add_u32 s21, s20, 8192
    v_add_u32 v3, s21, v105
    v_lshl_add_u32 v105, v101, 2, v103
    v_xor_b32 v106, v104, v101
    v_lshlrev_b32 v106, 3, v106
    v_lshl_add_u32 v2, v105, 5, v106
    v_mov_b32 v4, 0x3f003f00
    v_mov_b32 v5, 0x3f003f00
    v_mov_b32 v6, 0x3f803f80
    v_mov_b32 v7, 0x3f803f80
    v_mov_b32 v8, 0x3f803f80
    v_mov_b32 v9, 0x3f803f80
    s_and_b32 s20, s3, 1
    s_lshl_b32 s20, s20, 12
    s_lshr_b32 s21, s3, 1
    s_lshl_b32 s21, s21, 11
    s_add_u32 s20, s20, s21
    s_add_u32 s20, s20, 16384
    v_add_u32 v10, s20, v0
    s_add_u32 s21, s21, 12288
    v_add_u32 v14, s21, v0
    s_lshl_b32 s37, s3, 11
    v_add_u32 v13, s37, v0
    v_lshlrev_b32 v105, 4, v101
    v_lshl_add_u32 v11, v102, 15, v105
    v_lshlrev_b32 v105, 4, v102
    v_lshl_add_u32 v15, v101, 10, v105
    v_lshrrev_b32 v105, 2, v102
    v_lshlrev_b32 v12, 6, v105
    v_and_b32 v105, 1, v101
    v_lshl_add_u32 v12, v105, 5, v12
    v_and_b32 v105, 3, v102
    v_lshl_add_u32 v12, v105, 3, v12
    s_lshl_b32 s21, s3, 8
    v_add_u32 v12, s21, v12
    v_and_b32 v105, 7, v100
    v_and_b32 v106, 1, v100
    v_lshlrev_b32 v106, 4, v106
    v_mov_b32 v107, 0x3f80
    v_lshlrev_b32 v107, v106, v107
    v_lshrrev_b32 v105, 1, v105
    v_cmp_eq_u32 vcc, 0, v105
    s_nop 1
    v_cndmask_b32 v28, 0, v107, vcc
    v_cmp_eq_u32 vcc, 1, v105
    s_nop 1
    v_cndmask_b32 v29, 0, v107, vcc
    v_cmp_eq_u32 vcc, 2, v105
    s_nop 1
    v_cndmask_b32 v30, 0, v107, vcc
    v_cmp_eq_u32 vcc, 3, v105
    s_nop 1
    v_cndmask_b32 v31, 0, v107, vcc
    s_and_b32 s20, s3, 1
    v_lshl_add_u32 v105, v101, 2, 0
    v_cmp_le_u32 vcc, v105, v102
    s_cmp_eq_u32 s20, 0
    s_cselect_b64 s[40:41], vcc, -1
    s_cselect_b64 s[48:49], 0, vcc
    v_lshl_add_u32 v105, v101, 2, 1
    v_cmp_le_u32 vcc, v105, v102
    s_cmp_eq_u32 s20, 0
    s_cselect_b64 s[42:43], vcc, -1
    s_cselect_b64 s[50:51], 0, vcc
    v_lshl_add_u32 v105, v101, 2, 2
    v_cmp_le_u32 vcc, v105, v102
    s_cmp_eq_u32 s20, 0
    s_cselect_b64 s[44:45], vcc, -1
    s_cselect_b64 s[52:53], 0, vcc
    v_lshl_add_u32 v105, v101, 2, 3
    v_cmp_le_u32 vcc, v105, v102
    s_cmp_eq_u32 s20, 0
    s_cselect_b64 s[46:47], vcc, -1
    s_cselect_b64 s[54:55], 0, vcc
    s_cmp_eq_u32 s5, 3
    s_cbranch_scc0 L_hn_38
    s_sleep 100
    v_mov_b32 v33, 28672
    s_cmp_eq_u32 s3, 0
    s_cbranch_scc0 L_nb_39
    s_mov_b64 exec, 1
    s_mov_b32 s22, 0
L_gn_41:
    buffer_load_dword v32, off, s[16:19], 0 offset:8 sc1
    s_add_u32 s22, s22, 1
    s_cmp_gt_u32 s22, 100000
    s_cbranch_scc1 L_fail
    s_waitcnt vmcnt(0)
    v_readfirstlane_b32 s7, v32
    s_nop 0
    s_cmp_lg_u32 s7, 0
    s_cbranch_scc1 L_go_42
    s_sleep 10
    s_branch L_gn_41
L_go_42:
L_nh_40:
    ds_write_b32 v33, v32
    s_mov_b64 exec, -1
    s_waitcnt lgkmcnt(0)
L_nb_39:
    s_barrier
    ds_read_b32 v32, v33
    s_waitcnt lgkmcnt(0)
    v_readfirstlane_b32 s7, v32
L_hn_38:
    s_sub_u32 s25, s5, 3
    s_lshl_b32 s28, s25, 21
    s_add_u32 s28, s28, 0x1400000
    s_cmp_eq_u32 s3, 0
    s_cbranch_scc0 L_gb_44
    s_mov_b32 s22, 0
    v_mbcnt_lo_u32_b32 v32, -1, 0
    v_lshlrev_b32 v32, 2, v32
    v_and_b32 v32, 127, v32
    s_mov_b32 s20, 0x12400
L_ga_43:
    buffer_load_dword v33, v32, s[8:11], s20 offen sc1
    s_add_u32 s22, s22, 1
    s_cmp_gt_u32 s22, 100000
    s_cbranch_scc1 L_fail
    s_waitcnt vmcnt(0)
    v_subrev_u32 v33, s7, v33
    v_cmp_lt_u32 vcc, 0, v33
    s_cbranch_vccz L_gc_45
    s_sleep 20
    s_branch L_ga_43
L_gc_45:
L_gb_44:
    s_barrier
    v_mov_b32 v32, 1
    v_mov_b32 v33, 0
    v_mov_b32 v34, 0
    v_mov_b32 v35, 0
    s_lshl_b32 s23, s4, 15
    s_add_u32 s23, s23, s28
    s_lshl_b32 s21, s3, 13
    s_add_u32 s23, s23, s21
    buffer_store_dwordx4 v[32:35], v0, s[8:11], s23 offen offset:0
    buffer_store_dwordx4 v[32:35], v0, s[8:11], s23 offen offset:1024
    buffer_store_dwordx4 v[32:35], v0, s[8:11], s23 offen offset:2048
    buffer_store_dwordx4 v[32:35], v0, s[8:11], s23 offen offset:3072
    s_add_u32 s23, s23, 4096
    buffer_store_dwordx4 v[32:35], v0, s[8:11], s23 offen offset:0
    buffer_store_dwordx4 v[32:35], v0, s[8:11], s23 offen offset:1024
    buffer_store_dwordx4 v[32:35], v0, s[8:11], s23 offen offset:2048
    buffer_store_dwordx4 v[32:35], v0, s[8:11], s23 offen offset:3072
    s_add_u32 s23, s23, 1044480
    buffer_store_dwordx4 v[32:35], v0, s[8:11], s23 offen offset:0
    buffer_store_dwordx4 v[32:35], v0, s[8:11], s23 offen offset:1024
    buffer_store_dwordx4 v[32:35], v0, s[8:11], s23 offen offset:2048
    buffer_store_dwordx4 v[32:35], v0, s[8:11], s23 offen offset:3072
    s_add_u32 s23, s23, 4096
    buffer_store_dwordx4 v[32:35], v0, s[8:11], s23 offen offset:0
    buffer_store_dwordx4 v[32:35], v0, s[8:11], s23 offen offset:1024
    buffer_store_dwordx4 v[32:35], v0, s[8:11], s23 offen offset:2048
    buffer_store_dwordx4 v[32:35], v0, s[8:11], s23 offen offset:3072
    s_add_u32 s23, s23, 1044480
    s_waitcnt lgkmcnt(0)
    s_lshl_b32 s35, s4, 17
    s_mov_b32 s12, s60
    s_and_b32 s13, s61, 0xffff
    s_mov_b32 s14, 0x400000
    s_mov_b32 s15, 0x20000
    s_lshl_b32 s23, s3, 17
    s_lshl_b32 s20, s4, 8
    s_add_u32 s23, s23, s20
    s_add_u32 s23, s23, 0x0
    s_lshl_b32 s24, s3, 12
    s_add_u32 s24, s24, 32768
    s_mov_b32 m0, s24
    s_add_u32 s24, s24, 1024
    buffer_load_dwordx4 v108, s[12:15], s23 offen  lds
    s_add_u32 s23, s23, 32768
    s_mov_b32 m0, s24
    s_add_u32 s24, s24, 1024
    buffer_load_dwordx4 v109, s[12:15], s23 offen  lds
    s_add_u32 s23, s23, 32768
    s_mov_b32 m0, s24
    s_add_u32 s24, s24, 1024
    buffer_load_dwordx4 v110, s[12:15], s23 offen  lds
    s_add_u32 s23, s23, 32768
    s_mov_b32 m0, s24
    s_nop 0
    buffer_load_dwordx4 v111, s[12:15], s23 offen  lds
    s_lshl_b32 s23, s3, 17
    s_lshl_b32 s20, s4, 8
    s_add_u32 s23, s23, s20
    s_add_u32 s23, s23, 0x80000
    s_lshl_b32 s24, s3, 12
    s_add_u32 s24, s24, 49152
    s_mov_b32 m0, s24
    s_add_u32 s24, s24, 1024
    buffer_load_dwordx4 v108, s[12:15], s23 offen  lds
    s_add_u32 s23, s23, 32768
    s_mov_b32 m0, s24
    s_add_u32 s24, s24, 1024
    buffer_load_dwordx4 v109, s[12:15], s23 offen  lds
    s_add_u32 s23, s23, 32768
    s_mov_b32 m0, s24
    s_add_u32 s24, s24, 1024
    buffer_load_dwordx4 v110, s[12:15], s23 offen  lds
    s_add_u32 s23, s23, 32768
    s_mov_b32 m0, s24
    s_nop 0
    buffer_load_dwordx4 v111, s[12:15], s23 offen  lds
    s_lshl_b32 s23, s3, 17
    s_lshl_b32 s20, s4, 8
    s_add_u32 s23, s23, s20
    s_add_u32 s23, s23, 0x100000
    s_lshl_b32 s24, s3, 12
    s_add_u32 s24, s24, 65536
    s_mov_b32 m0, s24
    s_add_u32 s24, s24, 1024
    buffer_load_dwordx4 v108, s[12:15], s23 offen  lds
    s_add_u32 s23, s23, 32768
    s_mov_b32 m0, s24
    s_add_u32 s24, s24, 1024
    buffer_load_dwordx4 v109, s[12:15], s23 offen  lds
    s_add_u32 s23, s23, 32768
    s_mov_b32 m0, s24
    s_add_u32 s24, s24, 1024
    buffer_load_dwordx4 v110, s[12:15], s23 offen  lds
    s_add_u32 s23, s23, 32768
    s_mov_b32 m0, s24
    s_nop 0
    buffer_load_dwordx4 v111, s[12:15], s23 offen  lds
    s_lshl_b32 s23, s3, 17
    s_lshl_b32 s20, s4, 8
    s_add_u32 s23, s23, s20
    s_add_u32 s23, s23, 0x180000
    s_lshl_b32 s24, s3, 12
    s_add_u32 s24, s24, 81920
    s_mov_b32 m0, s24
    s_add_u32 s24, s24, 1024
    buffer_load_dwordx4 v108, s[12:15], s23 offen  lds
    s_add_u32 s23, s23, 32768
    s_mov_b32 m0, s24
    s_add_u32 s24, s24, 1024
    buffer_load_dwordx4 v109, s[12:15], s23 offen  lds
    s_add_u32 s23, s23, 32768
    s_mov_b32 m0, s24
    s_add_u32 s24, s24, 1024
    buffer_load_dwordx4 v110, s[12:15], s23 offen  lds
    s_add_u32 s23, s23, 32768
    s_mov_b32 m0, s24
    s_nop 0
    buffer_load_dwordx4 v111, s[12:15], s23 offen  lds
    s_lshl_b32 s23, s3, 17
    s_lshl_b32 s20, s4, 8
    s_add_u32 s23, s23, s20
    s_add_u32 s23, s23, 0x200000
    s_lshl_b32 s24, s3, 12
    s_add_u32 s24, s24, 98304
    s_mov_b32 m0, s24
    s_add_u32 s24, s24, 1024
    buffer_load_dwordx4 v108, s[12:15], s23 offen  lds
    s_add_u32 s23, s23, 32768
    s_mov_b32 m0, s24
    s_add_u32 s24, s24, 1024
    buffer_load_dwordx4 v109, s[12:15], s23 offen  lds
    s_add_u32 s23, s23, 32768
    s_mov_b32 m0, s24
    s_add_u32 s24, s24, 1024
    buffer_load_dwordx4 v110, s[12:15], s23 offen  lds
    s_add_u32 s23, s23, 32768
    s_mov_b32 m0, s24
    s_nop 0
    buffer_load_dwordx4 v111, s[12:15], s23 offen  lds
    s_lshl_b32 s23, s3, 17
    s_lshl_b32 s20, s4, 8
    s_add_u32 s23, s23, s20
    s_add_u32 s23, s23, 0x280000
    s_lshl_b32 s24, s3, 12
    s_add_u32 s24, s24, 114688
    s_mov_b32 m0, s24
    s_add_u32 s24, s24, 1024
    buffer_load_dwordx4 v108, s[12:15], s23 offen  lds
    s_add_u32 s23, s23, 32768
    s_mov_b32 m0, s24
    s_add_u32 s24, s24, 1024
    buffer_load_dwordx4 v109, s[12:15], s23 offen  lds
    s_add_u32 s23, s23, 32768
    s_mov_b32 m0, s24
    s_add_u32 s24, s24, 1024
    buffer_load_dwordx4 v110, s[12:15], s23 offen  lds
    s_add_u32 s23, s23, 32768
    s_mov_b32 m0, s24
    s_nop 0
    buffer_load_dwordx4 v111, s[12:15], s23 offen  lds
    s_lshl_b32 s23, s3, 17
    s_lshl_b32 s20, s4, 8
    s_add_u32 s23, s23, s20
    s_add_u32 s23, s23, 0x300000
    s_lshl_b32 s24, s3, 12
    s_add_u32 s24, s24, 131072
    s_mov_b32 m0, s24
    s_add_u32 s24, s24, 1024
    buffer_load_dwordx4 v108, s[12:15], s23 offen  lds
    s_add_u32 s23, s23, 32768
    s_mov_b32 m0, s24
    s_add_u32 s24, s24, 1024
    buffer_load_dwordx4 v109, s[12:15], s23 offen  lds
    s_add_u32 s23, s23, 32768
    s_mov_b32 m0, s24
    s_add_u32 s24, s24, 1024
    buffer_load_dwordx4 v110, s[12:15], s23 offen  lds
    s_add_u32 s23, s23, 32768
    s_mov_b32 m0, s24
    s_nop 0
    buffer_load_dwordx4 v111, s[12:15], s23 offen  lds
    s_lshl_b32 s23, s3, 17
    s_lshl_b32 s20, s4, 8
    s_add_u32 s23, s23, s20
    s_add_u32 s23, s23, 0x380000
    s_lshl_b32 s24, s3, 12
    s_add_u32 s24, s24, 147456
    s_mov_b32 m0, s24
    s_add_u32 s24, s24, 1024
    buffer_load_dwordx4 v108, s[12:15], s23 offen  lds
    s_add_u32 s23, s23, 32768
    s_mov_b32 m0, s24
    s_add_u32 s24, s24, 1024
    buffer_load_dwordx4 v109, s[12:15], s23 offen  lds
    s_add_u32 s23, s23, 32768
    s_mov_b32 m0, s24
    s_add_u32 s24, s24, 1024
    buffer_load_dwordx4 v110, s[12:15], s23 offen  lds
    s_add_u32 s23, s23, 32768
    s_mov_b32 m0, s24
    s_nop 0
    buffer_load_dwordx4 v111, s[12:15], s23 offen  lds
    s_waitcnt vmcnt(28) lgkmcnt(0)
    s_barrier
    s_lshl_b32 s20, s5, 5
    s_add_u32 s20, s20, s4
    s_lshl_b32 s20, s20, 2
    s_add_u32 s20, s20, 0x12000
    s_cmp_eq_u32 s3, 0
    s_cbranch_scc0 L_sf_46
    v_mov_b32 v32, s7
    s_mov_b64 exec, 1
    buffer_store_dword v32, off, s[8:11], s20 sc1
    s_mov_b64 exec, -1
L_sf_46:
    v_add_u32 v119, 32768, v112
    ds_read_b64_tr_b16 a[0:1], v119 offset:0
    ds_read_b64_tr_b16 a[2:3], v119 offset:512
    ds_read_b64_tr_b16 a[4:5], v119 offset:8192
    ds_read_b64_tr_b16 a[6:7], v119 offset:8704
    v_add_u32 v119, 32768, v113
    ds_read_b64_tr_b16 a[8:9], v119 offset:0
    ds_read_b64_tr_b16 a[10:11], v119 offset:512
    ds_read_b64_tr_b16 a[12:13], v119 offset:8192
    ds_read_b64_tr_b16 a[14:15], v119 offset:8704
    s_waitcnt vmcnt(24) lgkmcnt(0)
    s_barrier
    s_mov_b32 s12, s62
    s_and_b32 s13, s63, 0xffff
    s_mov_b32 s14, 0x400000
    s_mov_b32 s15, 0x20000
    s_lshl_b32 s23, s3, 17
    s_lshl_b32 s20, s4, 8
    s_add_u32 s23, s23, s20
    s_add_u32 s23, s23, 0x0
    s_lshl_b32 s24, s3, 12
    s_add_u32 s24, s24, 32768
    s_mov_b32 m0, s24
    s_add_u32 s24, s24, 1024
    buffer_load_dwordx4 v108, s[12:15], s23 offen  lds
    s_add_u32 s23, s23, 32768
    s_mov_b32 m0, s24
    s_add_u32 s24, s24, 1024
    buffer_load_dwordx4 v109, s[12:15], s23 offen  lds
    s_add_u32 s23, s23, 32768
    s_mov_b32 m0, s24
    s_add_u32 s24, s24, 1024
    buffer_load_dwordx4 v110, s[12:15], s23 offen  lds
    s_add_u32 s23, s23, 32768
    s_mov_b32 m0, s24
    s_nop 0
    buffer_load_dwordx4 v111, s[12:15], s23 offen  lds
    v_add_u32 v119, 49152, v112
    ds_read_b64_tr_b16 a[16:17], v119 offset:0
    ds_read_b64_tr_b16 a[18:19], v119 offset:512
    ds_read_b64_tr_b16 a[20:21], v119 offset:8192
    ds_read_b64_tr_b16 a[22:23], v119 offset:8704
    v_add_u32 v119, 49152, v113
    ds_read_b64_tr_b16 a[24:25], v119 offset:0
    ds_read_b64_tr_b16 a[26:27], v119 offset:512
    ds_read_b64_tr_b16 a[28:29], v119 offset:8192
    ds_read_b64_tr_b16 a[30:31], v119 offset:8704
    s_waitcnt vmcnt(24) lgkmcnt(0)
    s_barrier
    s_lshl_b32 s23, s3, 17
    s_lshl_b32 s20, s4, 8
    s_add_u32 s23, s23, s20
    s_add_u32 s23, s23, 0x80000
    s_lshl_b32 s24, s3, 12
    s_add_u32 s24, s24, 49152
    s_mov_b32 m0, s24
    s_add_u32 s24, s24, 1024
    buffer_load_dwordx4 v108, s[12:15], s23 offen  lds
    s_add_u32 s23, s23, 32768
    s_mov_b32 m0, s24
    s_add_u32 s24, s24, 1024
    buffer_load_dwordx4 v109, s[12:15], s23 offen  lds
    s_add_u32 s23, s23, 32768
    s_mov_b32 m0, s24
    s_add_u32 s24, s24, 1024
    buffer_load_dwordx4 v110, s[12:15], s23 offen  lds
    s_add_u32 s23, s23, 32768
    s_mov_b32 m0, s24
    s_nop 0
    buffer_load_dwordx4 v111, s[12:15], s23 offen  lds
    v_add_u32 v119, 65536, v112
    ds_read_b64_tr_b16 a[32:33], v119 offset:0
    ds_read_b64_tr_b16 a[34:35], v119 offset:512
    ds_read_b64_tr_b16 a[36:37], v119 offset:8192
    ds_read_b64_tr_b16 a[38:39], v119 offset:8704
    v_add_u32 v119, 65536, v113
    ds_read_b64_tr_b16 a[40:41], v119 offset:0
    ds_read_b64_tr_b16 a[42:43], v119 offset:512
    ds_read_b64_tr_b16 a[44:45], v119 offset:8192
    ds_read_b64_tr_b16 a[46:47], v119 offset:8704
    s_waitcnt vmcnt(24) lgkmcnt(0)
    s_barrier
    s_lshl_b32 s23, s3, 17
    s_lshl_b32 s20, s4, 8
    s_add_u32 s23, s23, s20
    s_add_u32 s23, s23, 0x100000
    s_lshl_b32 s24, s3, 12
    s_add_u32 s24, s24, 65536
    s_mov_b32 m0, s24
    s_add_u32 s24, s24, 1024
    buffer_load_dwordx4 v108, s[12:15], s23 offen  lds
    s_add_u32 s23, s23, 32768
    s_mov_b32 m0, s24
    s_add_u32 s24, s24, 1024
    buffer_load_dwordx4 v109, s[12:15], s23 offen  lds
    s_add_u32 s23, s23, 32768
    s_mov_b32 m0, s24
    s_add_u32 s24, s24, 1024
    buffer_load_dwordx4 v110, s[12:15], s23 offen  lds
    s_add_u32 s23, s23, 32768
    s_mov_b32 m0, s24
    s_nop 0
    buffer_load_dwordx4 v111, s[12:15], s23 offen  lds
    v_add_u32 v119, 81920, v112
    ds_read_b64_tr_b16 a[48:49], v119 offset:0
    ds_read_b64_tr_b16 a[50:51], v119 offset:512
    ds_read_b64_tr_b16 a[52:53], v119 offset:8192
    ds_read_b64_tr_b16 a[54:55], v119 offset:8704
    v_add_u32 v119, 81920, v113
    ds_read_b64_tr_b16 a[56:57], v119 offset:0
    ds_read_b64_tr_b16 a[58:59], v119 offset:512
    ds_read_b64_tr_b16 a[60:61], v119 offset:8192
    ds_read_b64_tr_b16 a[62:63], v119 offset:8704
    s_waitcnt vmcnt(24) lgkmcnt(0)
    s_barrier
    s_lshl_b32 s23, s3, 17
    s_lshl_b32 s20, s4, 8
    s_add_u32 s23, s23, s20
    s_add_u32 s23, s23, 0x180000
    s_lshl_b32 s24, s3, 12
    s_add_u32 s24, s24, 81920
    s_mov_b32 m0, s24
    s_add_u32 s24, s24, 1024
    buffer_load_dwordx4 v108, s[12:15], s23 offen  lds
    s_add_u32 s23, s23, 32768
    s_mov_b32 m0, s24
    s_add_u32 s24, s24, 1024
    buffer_load_dwordx4 v109, s[12:15], s23 offen  lds
    s_add_u32 s23, s23, 32768
    s_mov_b32 m0, s24
    s_add_u32 s24, s24, 1024
    buffer_load_dwordx4 v110, s[12:15], s23 offen  lds
    s_add_u32 s23, s23, 32768
    s_mov_b32 m0, s24
    s_nop 0
    buffer_load_dwordx4 v111, s[12:15], s23 offen  lds
    v_add_u32 v119, 98304, v112
    ds_read_b64_tr_b16 a[64:65], v119 offset:0
    ds_read_b64_tr_b16 a[66:67], v119 offset:512
    ds_read_b64_tr_b16 a[68:69], v119 offset:8192
    ds_read_b64_tr_b16 a[70:71], v119 offset:8704
    v_add_u32 v119, 98304, v113
    ds_read_b64_tr_b16 a[72:73], v119 offset:0
    ds_read_b64_tr_b16 a[74:75], v119 offset:512
    ds_read_b64_tr_b16 a[76:77], v119 offset:8192
    ds_read_b64_tr_b16 a[78:79], v119 offset:8704
    s_waitcnt vmcnt(24) lgkmcnt(0)
    s_barrier
    s_lshl_b32 s23, s3, 17
    s_lshl_b32 s20, s4, 8
    s_add_u32 s23, s23, s20
    s_add_u32 s23, s23, 0x200000
    s_lshl_b32 s24, s3, 12
    s_add_u32 s24, s24, 98304
    s_mov_b32 m0, s24
    s_add_u32 s24, s24, 1024
    buffer_load_dwordx4 v108, s[12:15], s23 offen  lds
    s_add_u32 s23, s23, 32768
    s_mov_b32 m0, s24
    s_add_u32 s24, s24, 1024
    buffer_load_dwordx4 v109, s[12:15], s23 offen  lds
    s_add_u32 s23, s23, 32768
    s_mov_b32 m0, s24
    s_add_u32 s24, s24, 1024
    buffer_load_dwordx4 v110, s[12:15], s23 offen  lds
    s_add_u32 s23, s23, 32768
    s_mov_b32 m0, s24
    s_nop 0
    buffer_load_dwordx4 v111, s[12:15], s23 offen  lds
    v_add_u32 v119, 114688, v112
    ds_read_b64_tr_b16 a[80:81], v119 offset:0
    ds_read_b64_tr_b16 a[82:83], v119 offset:512
    ds_read_b64_tr_b16 a[84:85], v119 offset:8192
    ds_read_b64_tr_b16 a[86:87], v119 offset:8704
    v_add_u32 v119, 114688, v113
    ds_read_b64_tr_b16 a[88:89], v119 offset:0
    ds_read_b64_tr_b16 a[90:91], v119 offset:512
    ds_read_b64_tr_b16 a[92:93], v119 offset:8192
    ds_read_b64_tr_b16 a[94:95], v119 offset:8704
    s_waitcnt vmcnt(24) lgkmcnt(0)
    s_barrier
    s_lshl_b32 s23, s3, 17
    s_lshl_b32 s20, s4, 8
    s_add_u32 s23, s23, s20
    s_add_u32 s23, s23, 0x280000
    s_lshl_b32 s24, s3, 12
    s_add_u32 s24, s24, 114688
    s_mov_b32 m0, s24
    s_add_u32 s24, s24, 1024
    buffer_load_dwordx4 v108, s[12:15], s23 offen  lds
    s_add_u32 s23, s23, 32768
    s_mov_b32 m0, s24
    s_add_u32 s24, s24, 1024
    buffer_load_dwordx4 v109, s[12:15], s23 offen  lds
    s_add_u32 s23, s23, 32768
    s_mov_b32 m0, s24
    s_add_u32 s24, s24, 1024
    buffer_load_dwordx4 v110, s[12:15], s23 offen  lds
    s_add_u32 s23, s23, 32768
    s_mov_b32 m0, s24
    s_nop 0
    buffer_load_dwordx4 v111, s[12:15], s23 offen  lds
    v_add_u32 v119, 131072, v112
    ds_read_b64_tr_b16 a[96:97], v119 offset:0
    ds_read_b64_tr_b16 a[98:99], v119 offset:512
    ds_read_b64_tr_b16 a[100:101], v119 offset:8192
    ds_read_b64_tr_b16 a[102:103], v119 offset:8704
    v_add_u32 v119, 131072, v113
    ds_read_b64_tr_b16 a[104:105], v119 offset:0
    ds_read_b64_tr_b16 a[106:107], v119 offset:512
    ds_read_b64_tr_b16 a[108:109], v119 offset:8192
    ds_read_b64_tr_b16 a[110:111], v119 offset:8704
    s_waitcnt vmcnt(24) lgkmcnt(0)
    s_barrier
    s_lshl_b32 s23, s3, 17
    s_lshl_b32 s20, s4, 8
    s_add_u32 s23, s23, s20
    s_add_u32 s23, s23, 0x300000
    s_lshl_b32 s24, s3, 12
    s_add_u32 s24, s24, 131072
    s_mov_b32 m0, s24
    s_add_u32 s24, s24, 1024
    buffer_load_dwordx4 v108, s[12:15], s23 offen  lds
    s_add_u32 s23, s23, 32768
    s_mov_b32 m0, s24
    s_add_u32 s24, s24, 1024
    buffer_load_dwordx4 v109, s[12:15], s23 offen  lds
    s_add_u32 s23, s23, 32768
    s_mov_b32 m0, s24
    s_add_u32 s24, s24, 1024
    buffer_load_dwordx4 v110, s[12:15], s23 offen  lds
    s_add_u32 s23, s23, 32768
    s_mov_b32 m0, s24
    s_nop 0
    buffer_load_dwordx4 v111, s[12:15], s23 offen  lds
    v_add_u32 v119, 147456, v112
    ds_read_b64_tr_b16 a[112:113], v119 offset:0
    ds_read_b64_tr_b16 a[114:115], v119 offset:512
    ds_read_b64_tr_b16 a[116:117], v119 offset:8192
    ds_read_b64_tr_b16 a[118:119], v119 offset:8704
    v_add_u32 v119, 147456, v113
    ds_read_b64_tr_b16 a[120:121], v119 offset:0
    ds_read_b64_tr_b16 a[122:123], v119 offset:512
    ds_read_b64_tr_b16 a[124:125], v119 offset:8192
    ds_read_b64_tr_b16 a[126:127], v119 offset:8704
    s_waitcnt vmcnt(24) lgkmcnt(0)
    s_barrier
    s_lshl_b32 s23, s3, 17
    s_lshl_b32 s20, s4, 8
    s_add_u32 s23, s23, s20
    s_add_u32 s23, s23, 0x380000
    s_lshl_b32 s24, s3, 12
    s_add_u32 s24, s24, 147456
    s_mov_b32 m0, s24
    s_add_u32 s24, s24, 1024
    buffer_load_dwordx4 v108, s[12:15], s23 offen  lds
    s_add_u32 s23, s23, 32768
    s_mov_b32 m0, s24
    s_add_u32 s24, s24, 1024
    buffer_load_dwordx4 v109, s[12:15], s23 offen  lds
    s_add_u32 s23, s23, 32768
    s_mov_b32 m0, s24
    s_add_u32 s24, s24, 1024
    buffer_load_dwordx4 v110, s[12:15], s23 offen  lds
    s_add_u32 s23, s23, 32768
    s_mov_b32 m0, s24
    s_nop 0
    buffer_load_dwordx4 v111, s[12:15], s23 offen  lds
    v_add_u32 v119, 32768, v112
    ds_read_b64_tr_b16 a[128:129], v119 offset:0
    ds_read_b64_tr_b16 a[130:131], v119 offset:512
    ds_read_b64_tr_b16 a[132:133], v119 offset:8192
    ds_read_b64_tr_b16 a[134:135], v119 offset:8704
    v_add_u32 v119, 32768, v113
    ds_read_b64_tr_b16 a[136:137], v119 offset:0
    ds_read_b64_tr_b16 a[138:139], v119 offset:512
    ds_read_b64_tr_b16 a[140:141], v119 offset:8192
    ds_read_b64_tr_b16 a[142:143], v119 offset:8704
    s_waitcnt vmcnt(24) lgkmcnt(0)
    s_barrier
    s_mov_b32 s12, s64
    s_and_b32 s13, s65, 0xffff
    s_mov_b32 s14, 0x400000
    s_mov_b32 s15, 0x20000
    s_lshl_b32 s23, s3, 12
    s_add_u32 s23, s23, s35
    s_add_u32 s23, s23, 0
    s_lshl_b32 s24, s3, 12
    s_add_u32 s24, s24, 32768
    s_mov_b32 m0, s24
    s_add_u32 s24, s24, 1024
    buffer_load_dwordx4 v114, s[12:15], s23 offen  lds
    s_add_u32 s23, s23, 1024
    s_mov_b32 m0, s24
    s_add_u32 s24, s24, 1024
    buffer_load_dwordx4 v115, s[12:15], s23 offen  lds
    s_add_u32 s23, s23, 1024
    s_mov_b32 m0, s24
    s_add_u32 s24, s24, 1024
    buffer_load_dwordx4 v116, s[12:15], s23 offen  lds
    s_add_u32 s23, s23, 1024
    s_mov_b32 m0, s24
    s_nop 0
    buffer_load_dwordx4 v117, s[12:15], s23 offen  lds
    v_add_u32 v119, 49152, v112
    ds_read_b64_tr_b16 a[144:145], v119 offset:0
    ds_read_b64_tr_b16 a[146:147], v119 offset:512
    ds_read_b64_tr_b16 a[148:149], v119 offset:8192
    ds_read_b64_tr_b16 a[150:151], v119 offset:8704
    v_add_u32 v119, 49152, v113
    ds_read_b64_tr_b16 a[152:153], v119 offset:0
    ds_read_b64_tr_b16 a[154:155], v119 offset:512
    ds_read_b64_tr_b16 a[156:157], v119 offset:8192
    ds_read_b64_tr_b16 a[158:159], v119 offset:8704
    s_waitcnt vmcnt(24) lgkmcnt(0)
    s_barrier
    s_lshl_b32 s23, s3, 12
    s_add_u32 s23, s23, s35
    s_add_u32 s23, s23, 16384
    s_lshl_b32 s24, s3, 12
    s_add_u32 s24, s24, 49152
    s_mov_b32 m0, s24
    s_add_u32 s24, s24, 1024
    buffer_load_dwordx4 v114, s[12:15], s23 offen  lds
    s_add_u32 s23, s23, 1024
    s_mov_b32 m0, s24
    s_add_u32 s24, s24, 1024
    buffer_load_dwordx4 v115, s[12:15], s23 offen  lds
    s_add_u32 s23, s23, 1024
    s_mov_b32 m0, s24
    s_add_u32 s24, s24, 1024
    buffer_load_dwordx4 v116, s[12:15], s23 offen  lds
    s_add_u32 s23, s23, 1024
    s_mov_b32 m0, s24
    s_nop 0
    buffer_load_dwordx4 v117, s[12:15], s23 offen  lds
    v_add_u32 v119, 65536, v112
    ds_read_b64_tr_b16 a[160:161], v119 offset:0
    ds_read_b64_tr_b16 a[162:163], v119 offset:512
    ds_read_b64_tr_b16 a[164:165], v119 offset:8192
    ds_read_b64_tr_b16 a[166:167], v119 offset:8704
    v_add_u32 v119, 65536, v113
    ds_read_b64_tr_b16 a[168:169], v119 offset:0
    ds_read_b64_tr_b16 a[170:171], v119 offset:512
    ds_read_b64_tr_b16 a[172:173], v119 offset:8192
    ds_read_b64_tr_b16 a[174:175], v119 offset:8704
    s_waitcnt vmcnt(24) lgkmcnt(0)
    s_barrier
    s_lshl_b32 s23, s3, 12
    s_add_u32 s23, s23, s35
    s_add_u32 s23, s23, 32768
    s_lshl_b32 s24, s3, 12
    s_add_u32 s24, s24, 65536
    s_mov_b32 m0, s24
    s_add_u32 s24, s24, 1024
    buffer_load_dwordx4 v114, s[12:15], s23 offen  lds
    s_add_u32 s23, s23, 1024
    s_mov_b32 m0, s24
    s_add_u32 s24, s24, 1024
    buffer_load_dwordx4 v115, s[12:15], s23 offen  lds
    s_add_u32 s23, s23, 1024
    s_mov_b32 m0, s24
    s_add_u32 s24, s24, 1024
    buffer_load_dwordx4 v116, s[12:15], s23 offen  lds
    s_add_u32 s23, s23, 1024
    s_mov_b32 m0, s24
    s_nop 0
    buffer_load_dwordx4 v117, s[12:15], s23 offen  lds
    v_add_u32 v119, 81920, v112
    ds_read_b64_tr_b16 a[176:177], v119 offset:0
    ds_read_b64_tr_b16 a[178:179], v119 offset:512
    ds_read_b64_tr_b16 a[180:181], v119 offset:8192
    ds_read_b64_tr_b16 a[182:183], v119 offset:8704
    v_add_u32 v119, 81920, v113
    ds_read_b64_tr_b16 a[184:185], v119 offset:0
    ds_read_b64_tr_b16 a[186:187], v119 offset:512
    ds_read_b64_tr_b16 a[188:189], v119 offset:8192
    ds_read_b64_tr_b16 a[190:191], v119 offset:8704
    s_waitcnt vmcnt(24) lgkmcnt(0)
    s_barrier
    s_lshl_b32 s23, s3, 12
    s_add_u32 s23, s23, s35
    s_add_u32 s23, s23, 49152
    s_lshl_b32 s24, s3, 12
    s_add_u32 s24, s24, 81920
    s_mov_b32 m0, s24
    s_add_u32 s24, s24, 1024
    buffer_load_dwordx4 v114, s[12:15], s23 offen  lds
    s_add_u32 s23, s23, 1024
    s_mov_b32 m0, s24
    s_add_u32 s24, s24, 1024
    buffer_load_dwordx4 v115, s[12:15], s23 offen  lds
    s_add_u32 s23, s23, 1024
    s_mov_b32 m0, s24
    s_add_u32 s24, s24, 1024
    buffer_load_dwordx4 v116, s[12:15], s23 offen  lds
    s_add_u32 s23, s23, 1024
    s_mov_b32 m0, s24
    s_nop 0
    buffer_load_dwordx4 v117, s[12:15], s23 offen  lds
    v_add_u32 v119, 98304, v112
    ds_read_b64_tr_b16 a[192:193], v119 offset:0
    ds_read_b64_tr_b16 a[194:195], v119 offset:512
    ds_read_b64_tr_b16 a[196:197], v119 offset:8192
    ds_read_b64_tr_b16 a[198:199], v119 offset:8704
    v_add_u32 v119, 98304, v113
    ds_read_b64_tr_b16 a[200:201], v119 offset:0
    ds_read_b64_tr_b16 a[202:203], v119 offset:512
    ds_read_b64_tr_b16 a[204:205], v119 offset:8192
    ds_read_b64_tr_b16 a[206:207], v119 offset:8704
    s_waitcnt vmcnt(24) lgkmcnt(0)
    s_barrier
    s_lshl_b32 s23, s3, 12
    s_add_u32 s23, s23, s35
    s_add_u32 s23, s23, 65536
    s_lshl_b32 s24, s3, 12
    s_add_u32 s24, s24, 98304
    s_mov_b32 m0, s24
    s_add_u32 s24, s24, 1024
    buffer_load_dwordx4 v114, s[12:15], s23 offen  lds
    s_add_u32 s23, s23, 1024
    s_mov_b32 m0, s24
    s_add_u32 s24, s24, 1024
    buffer_load_dwordx4 v115, s[12:15], s23 offen  lds
    s_add_u32 s23, s23, 1024
    s_mov_b32 m0, s24
    s_add_u32 s24, s24, 1024
    buffer_load_dwordx4 v116, s[12:15], s23 offen  lds
    s_add_u32 s23, s23, 1024
    s_mov_b32 m0, s24
    s_nop 0
    buffer_load_dwordx4 v117, s[12:15], s23 offen  lds
    v_add_u32 v119, 114688, v112
    ds_read_b64_tr_b16 a[208:209], v119 offset:0
    ds_read_b64_tr_b16 a[210:211], v119 offset:512
    ds_read_b64_tr_b16 a[212:213], v119 offset:8192
    ds_read_b64_tr_b16 a[214:215], v119 offset:8704
    v_add_u32 v119, 114688, v113
    ds_read_b64_tr_b16 a[216:217], v119 offset:0
    ds_read_b64_tr_b16 a[218:219], v119 offset:512
    ds_read_b64_tr_b16 a[220:221], v119 offset:8192
    ds_read_b64_tr_b16 a[222:223], v119 offset:8704
    s_waitcnt vmcnt(24) lgkmcnt(0)
    s_barrier
    s_lshl_b32 s23, s3, 12
    s_add_u32 s23, s23, s35
    s_add_u32 s23, s23, 81920
    s_lshl_b32 s24, s3, 12
    s_add_u32 s24, s24, 114688
    s_mov_b32 m0, s24
    s_add_u32 s24, s24, 1024
    buffer_load_dwordx4 v114, s[12:15], s23 offen  lds
    s_add_u32 s23, s23, 1024
    s_mov_b32 m0, s24
    s_add_u32 s24, s24, 1024
    buffer_load_dwordx4 v115, s[12:15], s23 offen  lds
    s_add_u32 s23, s23, 1024
    s_mov_b32 m0, s24
    s_add_u32 s24, s24, 1024
    buffer_load_dwordx4 v116, s[12:15], s23 offen  lds
    s_add_u32 s23, s23, 1024
    s_mov_b32 m0, s24
    s_nop 0
    buffer_load_dwordx4 v117, s[12:15], s23 offen  lds
    v_add_u32 v119, 131072, v112
    ds_read_b64_tr_b16 a[224:225], v119 offset:0
    ds_read_b64_tr_b16 a[226:227], v119 offset:512
    ds_read_b64_tr_b16 a[228:229], v119 offset:8192
    ds_read_b64_tr_b16 a[230:231], v119 offset:8704
    v_add_u32 v119, 131072, v113
    ds_read_b64_tr_b16 a[232:233], v119 offset:0
    ds_read_b64_tr_b16 a[234:235], v119 offset:512
    ds_read_b64_tr_b16 a[236:237], v119 offset:8192
    ds_read_b64_tr_b16 a[238:239], v119 offset:8704
    s_waitcnt vmcnt(24) lgkmcnt(0)
    s_barrier
    s_lshl_b32 s23, s3, 12
    s_add_u32 s23, s23, s35
    s_add_u32 s23, s23, 98304
    s_lshl_b32 s24, s3, 12
    s_add_u32 s24, s24, 131072
    s_mov_b32 m0, s24
    s_add_u32 s24, s24, 1024
    buffer_load_dwordx4 v114, s[12:15], s23 offen  lds
    s_add_u32 s23, s23, 1024
    s_mov_b32 m0, s24
    s_add_u32 s24, s24, 1024
    buffer_load_dwordx4 v115, s[12:15], s23 offen  lds
    s_add_u32 s23, s23, 1024
    s_mov_b32 m0, s24
    s_add_u32 s24, s24, 1024
    buffer_load_dwordx4 v116, s[12:15], s23 offen  lds
    s_add_u32 s23, s23, 1024
    s_mov_b32 m0, s24
    s_nop 0
    buffer_load_dwordx4 v117, s[12:15], s23 offen  lds
    v_add_u32 v119, 147456, v112
    ds_read_b64_tr_b16 a[240:241], v119 offset:0
    ds_read_b64_tr_b16 a[242:243], v119 offset:512
    ds_read_b64_tr_b16 a[244:245], v119 offset:8192
    ds_read_b64_tr_b16 a[246:247], v119 offset:8704
    v_add_u32 v119, 147456, v113
    ds_read_b64_tr_b16 a[248:249], v119 offset:0
    ds_read_b64_tr_b16 a[250:251], v119 offset:512
    ds_read_b64_tr_b16 a[252:253], v119 offset:8192
    ds_read_b64_tr_b16 a[254:255], v119 offset:8704
    s_waitcnt vmcnt(24) lgkmcnt(0)
    s_barrier
    s_lshl_b32 s23, s3, 12
    s_add_u32 s23, s23, s35
    s_add_u32 s23, s23, 114688
    s_lshl_b32 s24, s3, 12
    s_add_u32 s24, s24, 147456
    s_mov_b32 m0, s24
    s_add_u32 s24, s24, 1024
    buffer_load_dwordx4 v114, s[12:15], s23 offen  lds
    s_add_u32 s23, s23, 1024
    s_mov_b32 m0, s24
    s_add_u32 s24, s24, 1024
    buffer_load_dwordx4 v115, s[12:15], s23 offen  lds
    s_add_u32 s23, s23, 1024
    s_mov_b32 m0, s24
    s_add_u32 s24, s24, 1024
    buffer_load_dwordx4 v116, s[12:15], s23 offen  lds
    s_add_u32 s23, s23, 1024
    s_mov_b32 m0, s24
    s_nop 0
    buffer_load_dwordx4 v117, s[12:15], s23 offen  lds
    v_xor_b32 v119, 0, v118
    v_add_u32 v119, 32768, v119
    ds_read_b64_tr_b16 v[128:129], v119
    v_xor_b32 v119, 32, v118
    v_add_u32 v119, 32768, v119
    ds_read_b64_tr_b16 v[144:145], v119
    v_xor_b32 v119, 64, v118
    v_add_u32 v119, 32768, v119
    ds_read_b64_tr_b16 v[160:161], v119
    v_xor_b32 v119, 96, v118
    v_add_u32 v119, 32768, v119
    ds_read_b64_tr_b16 v[176:177], v119
    v_xor_b32 v119, 128, v118
    v_add_u32 v119, 32768, v119
    ds_read_b64_tr_b16 v[192:193], v119
    v_xor_b32 v119, 160, v118
    v_add_u32 v119, 32768, v119
    ds_read_b64_tr_b16 v[208:209], v119
    v_xor_b32 v119, 192, v118
    v_add_u32 v119, 32768, v119
    ds_read_b64_tr_b16 v[224:225], v119
    v_xor_b32 v119, 224, v118
    v_add_u32 v119, 32768, v119
    ds_read_b64_tr_b16 v[240:241], v119
    s_waitcnt vmcnt(24) lgkmcnt(0)
    s_barrier
    v_xor_b32 v119, 0, v118
    v_add_u32 v119, 49152, v119
    ds_read_b64_tr_b16 v[130:131], v119
    v_xor_b32 v119, 32, v118
    v_add_u32 v119, 49152, v119
    ds_read_b64_tr_b16 v[146:147], v119
    v_xor_b32 v119, 64, v118
    v_add_u32 v119, 49152, v119
    ds_read_b64_tr_b16 v[162:163], v119
    v_xor_b32 v119, 96, v118
    v_add_u32 v119, 49152, v119
    ds_read_b64_tr_b16 v[178:179], v119
    v_xor_b32 v119, 128, v118
    v_add_u32 v119, 49152, v119
    ds_read_b64_tr_b16 v[194:195], v119
    v_xor_b32 v119, 160, v118
    v_add_u32 v119, 49152, v119
    ds_read_b64_tr_b16 v[210:211], v119
    v_xor_b32 v119, 192, v118
    v_add_u32 v119, 49152, v119
    ds_read_b64_tr_b16 v[226:227], v119
    v_xor_b32 v119, 224, v118
    v_add_u32 v119, 49152, v119
    ds_read_b64_tr_b16 v[242:243], v119
    s_waitcnt vmcnt(20) lgkmcnt(0)
    s_barrier
    v_xor_b32 v119, 0, v118
    v_add_u32 v119, 65536, v119
    ds_read_b64_tr_b16 v[132:133], v119
    v_xor_b32 v119, 32, v118
    v_add_u32 v119, 65536, v119
    ds_read_b64_tr_b16 v[148:149], v119
    v_xor_b32 v119, 64, v118
    v_add_u32 v119, 65536, v119
    ds_read_b64_tr_b16 v[164:165], v119
    v_xor_b32 v119, 96, v118
    v_add_u32 v119, 65536, v119
    ds_read_b64_tr_b16 v[180:181], v119
    v_xor_b32 v119, 128, v118
    v_add_u32 v119, 65536, v119
    ds_read_b64_tr_b16 v[196:197], v119
    v_xor_b32 v119, 160, v118
    v_add_u32 v119, 65536, v119
    ds_read_b64_tr_b16 v[212:213], v119
    v_xor_b32 v119, 192, v118
    v_add_u32 v119, 65536, v119
    ds_read_b64_tr_b16 v[228:229], v119
    v_xor_b32 v119, 224, v118
    v_add_u32 v119, 65536, v119
    ds_read_b64_tr_b16 v[244:245], v119
    s_waitcnt vmcnt(16) lgkmcnt(0)
    s_barrier
    v_xor_b32 v119, 0, v118
    v_add_u32 v119, 81920, v119
    ds_read_b64_tr_b16 v[134:135], v119
    v_xor_b32 v119, 32, v118
    v_add_u32 v119, 81920, v119
    ds_read_b64_tr_b16 v[150:151], v119
    v_xor_b32 v119, 64, v118
    v_add_u32 v119, 81920, v119
    ds_read_b64_tr_b16 v[166:167], v119
    v_xor_b32 v119, 96, v118
    v_add_u32 v119, 81920, v119
    ds_read_b64_tr_b16 v[182:183], v119
    v_xor_b32 v119, 128, v118
    v_add_u32 v119, 81920, v119
    ds_read_b64_tr_b16 v[198:199], v119
    v_xor_b32 v119, 160, v118
    v_add_u32 v119, 81920, v119
    ds_read_b64_tr_b16 v[214:215], v119
    v_xor_b32 v119, 192, v118
    v_add_u32 v119, 81920, v119
    ds_read_b64_tr_b16 v[230:231], v119
    v_xor_b32 v119, 224, v118
    v_add_u32 v119, 81920, v119
    ds_read_b64_tr_b16 v[246:247], v119
    s_waitcnt vmcnt(12) lgkmcnt(0)
    s_barrier
    v_xor_b32 v119, 0, v118
    v_add_u32 v119, 98304, v119
    ds_read_b64_tr_b16 v[136:137], v119
    v_xor_b32 v119, 32, v118
    v_add_u32 v119, 98304, v119
    ds_read_b64_tr_b16 v[152:153], v119
    v_xor_b32 v119, 64, v118
    v_add_u32 v119, 98304, v119
    ds_read_b64_tr_b16 v[168:169], v119
    v_xor_b32 v119, 96, v118
    v_add_u32 v119, 98304, v119
    ds_read_b64_tr_b16 v[184:185], v119
    v_xor_b32 v119, 128, v118
    v_add_u32 v119, 98304, v119
    ds_read_b64_tr_b16 v[200:201], v119
    v_xor_b32 v119, 160, v118
    v_add_u32 v119, 98304, v119
    ds_read_b64_tr_b16 v[216:217], v119
    v_xor_b32 v119, 192, v118
    v_add_u32 v119, 98304, v119
    ds_read_b64_tr_b16 v[232:233], v119
    v_xor_b32 v119, 224, v118
    v_add_u32 v119, 98304, v119
    ds_read_b64_tr_b16 v[248:249], v119
    s_waitcnt vmcnt(8) lgkmcnt(0)
    s_barrier
    v_xor_b32 v119, 0, v118
    v_add_u32 v119, 114688, v119
    ds_read_b64_tr_b16 v[138:139], v119
    v_xor_b32 v119, 32, v118
    v_add_u32 v119, 114688, v119
    ds_read_b64_tr_b16 v[154:155], v119
    v_xor_b32 v119, 64, v118
    v_add_u32 v119, 114688, v119
    ds_read_b64_tr_b16 v[170:171], v119
    v_xor_b32 v119, 96, v118
    v_add_u32 v119, 114688, v119
    ds_read_b64_tr_b16 v[186:187], v119
    v_xor_b32 v119, 128, v118
    v_add_u32 v119, 114688, v119
    ds_read_b64_tr_b16 v[202:203], v119
    v_xor_b32 v119, 160, v118
    v_add_u32 v119, 114688, v119
    ds_read_b64_tr_b16 v[218:219], v119
    v_xor_b32 v119, 192, v118
    v_add_u32 v119, 114688, v119
    ds_read_b64_tr_b16 v[234:235], v119
    v_xor_b32 v119, 224, v118
    v_add_u32 v119, 114688, v119
    ds_read_b64_tr_b16 v[250:251], v119
    s_waitcnt vmcnt(4) lgkmcnt(0)
    s_barrier
    v_xor_b32 v119, 0, v118
    v_add_u32 v119, 131072, v119
    ds_read_b64_tr_b16 v[140:141], v119
    v_xor_b32 v119, 32, v118
    v_add_u32 v119, 131072, v119
    ds_read_b64_tr_b16 v[156:157], v119
    v_xor_b32 v119, 64, v118
    v_add_u32 v119, 131072, v119
    ds_read_b64_tr_b16 v[172:173], v119
    v_xor_b32 v119, 96, v118
    v_add_u32 v119, 131072, v119
    ds_read_b64_tr_b16 v[188:189], v119
    v_xor_b32 v119, 128, v118
    v_add_u32 v119, 131072, v119
    ds_read_b64_tr_b16 v[204:205], v119
    v_xor_b32 v119, 160, v118
    v_add_u32 v119, 131072, v119
    ds_read_b64_tr_b16 v[220:221], v119
    v_xor_b32 v119, 192, v118
    v_add_u32 v119, 131072, v119
    ds_read_b64_tr_b16 v[236:237], v119
    v_xor_b32 v119, 224, v118
    v_add_u32 v119, 131072, v119
    ds_read_b64_tr_b16 v[252:253], v119
    s_waitcnt vmcnt(0) lgkmcnt(0)
    s_barrier
    v_xor_b32 v119, 0, v118
    v_add_u32 v119, 147456, v119
    ds_read_b64_tr_b16 v[142:143], v119
    v_xor_b32 v119, 32, v118
    v_add_u32 v119, 147456, v119
    ds_read_b64_tr_b16 v[158:159], v119
    v_xor_b32 v119, 64, v118
    v_add_u32 v119, 147456, v119
    ds_read_b64_tr_b16 v[174:175], v119
    v_xor_b32 v119, 96, v118
    v_add_u32 v119, 147456, v119
    ds_read_b64_tr_b16 v[190:191], v119
    v_xor_b32 v119, 128, v118
    v_add_u32 v119, 147456, v119
    ds_read_b64_tr_b16 v[206:207], v119
    v_xor_b32 v119, 160, v118
    v_add_u32 v119, 147456, v119
    ds_read_b64_tr_b16 v[222:223], v119
    v_xor_b32 v119, 192, v118
    v_add_u32 v119, 147456, v119
    ds_read_b64_tr_b16 v[238:239], v119
    v_xor_b32 v119, 224, v118
    v_add_u32 v119, 147456, v119
    ds_read_b64_tr_b16 v[254:255], v119
    s_waitcnt lgkmcnt(0)
    s_barrier
    v_lshlrev_b32 v36, 1, v12
    s_mov_b32 s21, 4096
    s_mov_b32 s22, 0
L_m4_47:
    buffer_load_dwordx4 v[32:35], v36, s[8:11], s21 offen sc1
    s_add_u32 s22, s22, 1
    s_cmp_gt_u32 s22, 100000
    s_cbranch_scc1 L_fail
    s_waitcnt vmcnt(0)
    v_bitop3_b32 v33, v33, v35, s7 bitop3:0x7e
    v_cmp_ne_u32 vcc, 0, v33
    s_cbranch_vccnz L_m4_47
    v_lshlrev_b32 v16, 16, v32
    v_and_b32 v17, 0xffff0000, v32
    v_lshlrev_b32 v18, 16, v34
    v_and_b32 v19, 0xffff0000, v34
    s_cmp_eq_u32 s3, 0
    s_cbranch_scc0 L_wg_49
    s_mov_b32 s22, 0
    v_mbcnt_lo_u32_b32 v32, -1, 0
    v_mbcnt_hi_u32_b32 v32, -1, v32
    v_lshlrev_b32 v32, 2, v32
    v_and_b32 v33, 127, v32
L_wf_48:
    v_mov_b32 v34, s7
    v_mov_b32 v35, s7
    v_mov_b32 v36, s7
    s_mov_b32 s20, 0x11800
    buffer_load_dword v34, v32, s[8:11], s20 offen sc1
    buffer_load_dword v35, v32, s[8:11], s20 offen offset:256 sc1
    s_lshl_b32 s20, s5, 7
    s_add_u32 s20, s20, 0x12000
    buffer_load_dword v36, v33, s[8:11], s20 offen sc1
    s_add_u32 s22, s22, 1
    s_cmp_gt_u32 s22, 100000
    s_cbranch_scc1 L_fail
    s_waitcnt vmcnt(0)
    v_bitop3_b32 v34, v34, v35, s7 bitop3:0x7e
    v_bitop3_b32 v34, v34, v36, s7 bitop3:0xf6
    v_cmp_ne_u32 vcc, 0, v34
    s_cbranch_vccz L_wh_50
    s_sleep 6
    s_branch L_wf_48
L_wh_50:
L_wg_49:
    s_barrier
    s_mov_b32 s12, s66
    s_and_b32 s13, s67, 0xffff
    s_mov_b32 s14, 0x200000
    s_mov_b32 s15, 0x20000
    s_mov_b32 s31, 0x3e0293ee
    s_mov_b32 s32, 0x5d800000
    s_mov_b32 s33, 0x7f817f81
    s_mov_b32 s36, 0xf149f2ca
    s_lshl_b32 s30, s4, 7
    s_add_u32 s30, s30, 0x10000
    s_mov_b32 s56, s25
    s_mov_b32 s38, 0x8000
    s_mov_b32 s57, 0x10000
    s_mov_b32 s39, 0
    s_mov_b32 s22, 0
L_atf_54:
    s_mov_b64 exec, 3
    buffer_load_dword v122, v0, s[8:11], s30 offen sc1
    s_add_u32 s22, s22, 1
    s_cmp_gt_u32 s22, 100000
    s_cbranch_scc1 L_fail
    s_add_u32 s20, s7, s56
    s_add_u32 s20, s20, 1
    s_sub_u32 s21, 63, s56
    s_waitcnt vmcnt(0)
    v_subrev_u32 v122, s20, v122
    v_cmp_lt_u32 vcc, s21, v122
    s_mov_b64 exec, -1
    s_cbranch_vccnz L_atf_54
    s_lshl_b32 s26, s4, 15
    s_lshl_b32 s20, s56, 20
    s_add_u32 s26, s26, s20
    s_add_u32 s26, s26, 0x2000000
    s_mul_i32 s20, s3, 6144
    s_add_u32 s26, s26, s20
    s_add_u32 s20, s20, s38
    s_xor_b32 s38, s38, 0x18000
    s_mov_b32 m0, s20
    s_nop 0
    buffer_load_dwordx4 v0, s[8:11], s26 offen offset:0 sc1 lds
    buffer_load_dwordx4 v0, s[8:11], s26 offen offset:1024 sc1 lds
    buffer_load_dwordx4 v0, s[8:11], s26 offen offset:2048 sc1 lds
    s_add_u32 s20, s20, 3072
    s_add_u32 s26, s26, 3072
    s_mov_b32 m0, s20
    s_nop 0
    buffer_load_dwordx4 v0, s[8:11], s26 offen offset:0 sc1 lds
    buffer_load_dwordx4 v0, s[8:11], s26 offen offset:1024 sc1 lds
    buffer_load_dwordx4 v0, s[8:11], s26 offen offset:2048 sc1 lds
    s_add_u32 s56, s56, 3
    s_mov_b32 s22, 0
L_atf_55:
    s_mov_b64 exec, 3
    buffer_load_dword v122, v0, s[8:11], s30 offen sc1
    s_add_u32 s22, s22, 1
    s_cmp_gt_u32 s22, 100000
    s_cbranch_scc1 L_fail
    s_add_u32 s20, s7, s56
    s_add_u32 s20, s20, 1
    s_sub_u32 s21, 63, s56
    s_waitcnt vmcnt(0)
    v_subrev_u32 v122, s20, v122
    v_cmp_lt_u32 vcc, s21, v122
    s_mov_b64 exec, -1
    s_cbranch_vccnz L_atf_55
    s_lshl_b32 s26, s4, 15
    s_lshl_b32 s20, s56, 20
    s_add_u32 s26, s26, s20
    s_add_u32 s26, s26, 0x2000000
    s_mul_i32 s20, s3, 6144
    s_add_u32 s26, s26, s20
    s_add_u32 s20, s20, s38
    s_xor_b32 s38, s38, 0x18000
    s_mov_b32 m0, s20
    s_nop 0
    buffer_load_dwordx4 v0, s[8:11], s26 offen offset:0 sc1 lds
    buffer_load_dwordx4 v0, s[8:11], s26 offen offset:1024 sc1 lds
    buffer_load_dwordx4 v0, s[8:11], s26 offen offset:2048 sc1 lds
    s_add_u32 s20, s20, 3072
    s_add_u32 s26, s26, 3072
    s_mov_b32 m0, s20
    s_nop 0
    buffer_load_dwordx4 v0, s[8:11], s26 offen offset:0 sc1 lds
    buffer_load_dwordx4 v0, s[8:11], s26 offen offset:1024 sc1 lds
    buffer_load_dwordx4 v0, s[8:11], s26 offen offset:2048 sc1 lds
    s_add_u32 s56, s56, 3
    s_waitcnt vmcnt(6)
    s_barrier
    s_xor_b32 s57, s57, 0x18000
    s_and_b32 s20, s3, 1
    s_lshl_b32 s20, s20, 12
    s_add_u32 s20, s20, s57
    v_add_u32 v126, s20, v0
    v_add_u32 v127, s57, v0
    s_lshr_b32 s20, s3, 1
    s_lshl_b32 s20, s20, 12
    s_add_u32 s20, s20, s57
    s_add_u32 s20, s20, 16384
    v_add_u32 v123, s20, v0
    ds_read_b128 v[32:35], v126 offset:0
    ds_read_b128 v[64:67], v127 offset:8192
    ds_read_b128 v[36:39], v126 offset:1024
    ds_read_b128 v[68:71], v127 offset:9216
    ds_read_b128 v[40:43], v126 offset:2048
    ds_read_b128 v[72:75], v127 offset:10240
    ds_read_b128 v[44:47], v126 offset:3072
    ds_read_b128 v[76:79], v127 offset:11264
    s_waitcnt lgkmcnt(6)
    v_mfma_f32_16x16x32_bf16 v[96:99], v[64:67], v[32:35], 0
    ds_read_b128 v[80:83], v127 offset:12288
    s_waitcnt lgkmcnt(5)
    v_mfma_f32_16x16x32_bf16 v[96:99], v[68:71], v[36:39], v[96:99]
    ds_read_b128 v[84:87], v127 offset:13312
    s_waitcnt lgkmcnt(4)
    v_mfma_f32_16x16x32_bf16 v[96:99], v[72:75], v[40:43], v[96:99]
    ds_read_b128 v[88:91], v127 offset:14336
    s_waitcnt lgkmcnt(3)
    v_mfma_f32_16x16x32_bf16 v[96:99], v[76:79], v[44:47], v[96:99]
    ds_read_b128 v[92:95], v127 offset:15360
    s_waitcnt lgkmcnt(3)
    v_mfma_f32_16x16x32_bf16 v[100:103], v[80:83], v[32:35], 0
    s_waitcnt lgkmcnt(2)
    v_mfma_f32_16x16x32_bf16 v[100:103], v[84:87], v[36:39], v[100:103]
    s_waitcnt lgkmcnt(1)
    v_mfma_f32_16x16x32_bf16 v[100:103], v[88:91], v[40:43], v[100:103]
    s_waitcnt lgkmcnt(0)
    v_mfma_f32_16x16x32_bf16 v[100:103], v[92:95], v[44:47], v[100:103]
    ds_read_b128 v[64:67], v123 offset:0
    ds_read_b128 v[68:71], v123 offset:1024
    ds_read_b128 v[72:75], v123 offset:2048
    ds_read_b128 v[76:79], v123 offset:3072
    v_exp_f32 v104, v96
    v_exp_f32 v105, v97
    v_exp_f32 v106, v98
    v_exp_f32 v107, v99
    v_exp_f32 v108, v100
    v_exp_f32 v109, v101
    v_exp_f32 v110, v102
    v_exp_f32 v111, v103
    v_cndmask_b32 v104, 0, v104, s[40:41]
    v_cndmask_b32 v105, 0, v105, s[42:43]
    v_cndmask_b32 v106, 0, v106, s[44:45]
    v_cndmask_b32 v107, 0, v107, s[46:47]
    v_cndmask_b32 v108, 0, v108, s[48:49]
    v_cndmask_b32 v109, 0, v109, s[50:51]
    v_cndmask_b32 v110, 0, v110, s[52:53]
    v_cndmask_b32 v111, 0, v111, s[54:55]
    v_cvt_pk_bf16_f32 v112, v104, v105
    v_cvt_pk_bf16_f32 v113, v106, v107
    v_cvt_pk_bf16_f32 v114, v108, v109
    v_cvt_pk_bf16_f32 v115, v110, v111
    s_waitcnt lgkmcnt(0)
    s_nop 0
    v_mfma_f32_16x16x32_bf16 v[116:119], v[6:9], v[112:115], 0
    v_mfma_f32_16x16x32_bf16 v[48:51], v[64:67], v[112:115], 0
    v_mfma_f32_16x16x32_bf16 v[52:55], v[68:71], v[112:115], 0
    v_mfma_f32_16x16x32_bf16 v[56:59], v[72:75], v[112:115], 0
    v_mfma_f32_16x16x32_bf16 v[60:63], v[76:79], v[112:115], 0
L_at_51:
    s_lshl_b32 s35, s25, 5
    s_add_u32 s35, s35, s4
    s_lshl_b32 s35, s35, 10
    s_lshl_b32 s27, s25, 13
    s_add_u32 s27, s27, s37
    s_add_u32 s27, s27, 0x1200000
    s_bfe_u32 s29, s39, 0x10001
    s_and_b32 s20, s39, 1
    s_lshl_b32 s20, s20, 20
    s_add_u32 s34, s20, s28
    s_add_u32 s39, s39, 1
    v_mov_b64 v[104:105], 0
    v_mov_b64 v[106:107], 0
    v_mov_b64 v[108:109], 0
    v_mov_b64 v[110:111], 0
    s_mov_b32 m0, s37
    s_mov_b32 s22, 0
L_atq_56:
    buffer_load_dwordx4 v0, s[8:11], s27 offen sc1 lds
    buffer_load_dwordx4 v0, s[8:11], s27 offen offset:1024 sc1 lds
    s_add_u32 s22, s22, 1
    s_cmp_gt_u32 s22, 100000
    s_cbranch_scc1 L_fail
    s_waitcnt vmcnt(0)
    ds_read2st64_b32 v[112:113], v13 offset0:0 offset1:4
    s_waitcnt lgkmcnt(0)
    v_cmp_eq_u32 vcc, s33, v112
    v_cmp_eq_u32 s[20:21], s33, v113
    s_nop 0
    s_or_b64 vcc, vcc, s[20:21]
    s_cbranch_vccz L_atk_57
    s_cmp_ge_u32 s25, 60
    s_cbranch_scc1 L_atq_56
    s_sleep 2
    s_branch L_atq_56
L_atk_57:
    s_barrier
    ds_read_b128 v[64:67], v0 offset:0
    ds_read_b128 v[68:71], v0 offset:1024
    ds_read_b128 v[72:75], v0 offset:2048
    ds_read_b128 v[76:79], v0 offset:3072
    v_mov_b64 v[112:113], 0
    v_mov_b64 v[114:115], 0
    v_mov_b64 v[120:121], 0
    v_mov_b64 v[122:123], 0
    buffer_load_dwordx2 v[124:125], v12, s[12:15], s35 offen
    s_waitcnt lgkmcnt(3)
    v_smfmac_f32_16x16x64_bf16 v[104:107], v[64:67], a[0:7], v1
    ds_read_b128 v[80:83], v0 offset:4096
    v_smfmac_f32_16x16x64_bf16 v[108:111], v[64:67], a[8:15], v1
    s_waitcnt lgkmcnt(3)
    v_smfmac_f32_16x16x64_bf16 v[104:107], v[68:71], a[16:23], v1
    ds_read_b128 v[84:87], v0 offset:5120
    v_smfmac_f32_16x16x64_bf16 v[108:111], v[68:71], a[24:31], v1
    s_waitcnt lgkmcnt(3)
    v_smfmac_f32_16x16x64_bf16 v[104:107], v[72:75], a[32:39], v1
    ds_read_b128 v[88:91], v0 offset:6144
    v_smfmac_f32_16x16x64_bf16 v[108:111], v[72:75], a[40:47], v1
    s_waitcnt lgkmcnt(3)
    v_smfmac_f32_16x16x64_bf16 v[104:107], v[76:79], a[48:55], v1
    ds_read_b128 v[92:95], v0 offset:7168
    v_smfmac_f32_16x16x64_bf16 v[108:111], v[76:79], a[56:63], v1
    s_waitcnt lgkmcnt(3)
    v_smfmac_f32_16x16x64_bf16 v[104:107], v[80:83], a[64:71], v1
    v_smfmac_f32_16x16x64_bf16 v[108:111], v[80:83], a[72:79], v1
    s_waitcnt lgkmcnt(2)
    v_smfmac_f32_16x16x64_bf16 v[104:107], v[84:87], a[80:87], v1
    v_smfmac_f32_16x16x64_bf16 v[108:111], v[84:87], a[88:95], v1
    s_waitcnt lgkmcnt(1)
    v_smfmac_f32_16x16x64_bf16 v[104:107], v[88:91], a[96:103], v1
    v_smfmac_f32_16x16x64_bf16 v[108:111], v[88:91], a[104:111], v1
    s_waitcnt lgkmcnt(0)
    v_smfmac_f32_16x16x64_bf16 v[104:107], v[92:95], a[112:119], v1
    v_smfmac_f32_16x16x64_bf16 v[108:111], v[92:95], a[120:127], v1
    v_smfmac_f32_16x16x64_bf16 v[112:115], v[64:67], a[128:135], v1
    v_smfmac_f32_16x16x64_bf16 v[120:123], v[64:67], a[136:143], v1
    v_cvt_pk_bf16_f32 v104, v104, v105
    v_cvt_pk_bf16_f32 v105, v106, v107
    ds_write_b64 v3, v[104:105]
    v_cvt_pk_bf16_f32 v106, v108, v109
    v_cvt_pk_bf16_f32 v107, v110, v111
    ds_write_b64 v3, v[106:107] offset:512
    v_smfmac_f32_16x16x64_bf16 v[112:115], v[68:71], a[144:151], v1
    v_smfmac_f32_16x16x64_bf16 v[120:123], v[68:71], a[152:159], v1
    v_smfmac_f32_16x16x64_bf16 v[112:115], v[72:75], a[160:167], v1
    v_smfmac_f32_16x16x64_bf16 v[120:123], v[72:75], a[168:175], v1
    v_smfmac_f32_16x16x64_bf16 v[112:115], v[76:79], a[176:183], v1
    v_smfmac_f32_16x16x64_bf16 v[120:123], v[76:79], a[184:191], v1
    s_waitcnt lgkmcnt(0)
    s_barrier
    ds_read_b64_tr_b16 v[64:65], v2 offset:8192
    ds_read_b64_tr_b16 v[66:67], v2 offset:8704
    v_smfmac_f32_16x16x64_bf16 v[112:115], v[80:83], a[192:199], v1
    ds_read_b64_tr_b16 v[68:69], v2 offset:9216
    ds_read_b64_tr_b16 v[70:71], v2 offset:9728
    v_smfmac_f32_16x16x64_bf16 v[120:123], v[80:83], a[200:207], v1
    ds_read_b64_tr_b16 v[72:73], v2 offset:10240
    ds_read_b64_tr_b16 v[74:75], v2 offset:10752
    v_smfmac_f32_16x16x64_bf16 v[112:115], v[84:87], a[208:215], v1
    ds_read_b64_tr_b16 v[76:77], v2 offset:11264
    ds_read_b64_tr_b16 v[78:79], v2 offset:11776
    v_smfmac_f32_16x16x64_bf16 v[120:123], v[84:87], a[216:223], v1
    s_waitcnt lgkmcnt(6)
    v_mfma_f32_16x16x32_bf16 v[108:111], v[64:67], v[32:35], 0
    s_waitcnt lgkmcnt(4)
    v_mfma_f32_16x16x32_bf16 v[108:111], v[68:71], v[36:39], v[108:111]
    s_waitcnt lgkmcnt(2)
    v_mfma_f32_16x16x32_bf16 v[108:111], v[72:75], v[40:43], v[108:111]
    s_waitcnt lgkmcnt(0)
    v_mfma_f32_16x16x32_bf16 v[108:111], v[76:79], v[44:47], v[108:111]
    v_smfmac_f32_16x16x64_bf16 v[112:115], v[88:91], a[224:231], v1
    v_smfmac_f32_16x16x64_bf16 v[120:123], v[88:91], a[232:239], v1
    v_smfmac_f32_16x16x64_bf16 v[112:115], v[92:95], a[240:247], v1
    v_permlane32_swap_b32 v108, v110
    v_smfmac_f32_16x16x64_bf16 v[120:123], v[92:95], a[248:255], v1
    v_permlane32_swap_b32 v109, v111
    s_lshl_b32 s20, s3, 10
    v_add_u32 v104, s20, v0
    v_add_f32 v108, v108, v110
    v_add_f32 v109, v109, v111
    v_cvt_pk_bf16_f32 v112, v112, v113
    v_cvt_pk_bf16_f32 v113, v114, v115
    s_nop 0
    v_cvt_pk_bf16_f32 v114, v120, v121
    v_cvt_pk_bf16_f32 v115, v122, v123
    ds_write_b128 v104, v[112:115] offset:12288
    v_mul_f32 v108, s31, v108
    v_mul_f32 v109, s31, v109
    v_exp_f32 v110, v108
    v_exp_f32 v111, v109
    s_nop 0
    v_cvt_pk_bf16_f32 v120, v110, v111
    v_mov_b32 v121, v120
    s_nop 1
    v_permlane32_swap_b32 v120, v121
    s_waitcnt lgkmcnt(0)
    s_barrier
    ds_read_b128 v[80:83], v14
    ds_read_b128 v[84:87], v14 offset:1024
    v_mov_b64 v[112:113], v[120:121]
    s_waitcnt lgkmcnt(0)
    s_nop 0
    v_mfma_f32_16x16x16_bf16 v[116:119], v[4:5], v[112:113], v[116:119]
    v_mfma_f32_16x16x16_bf16 v[48:51], v[80:81], v[112:113], v[48:51]
    v_mfma_f32_16x16x16_bf16 v[52:55], v[82:83], v[112:113], v[52:55]
    v_mfma_f32_16x16x16_bf16 v[56:59], v[84:85], v[112:113], v[56:59]
    v_mfma_f32_16x16x16_bf16 v[60:63], v[86:87], v[112:113], v[60:63]
    v_rcp_f32 v114, v116
    s_nop 0
    v_max_f32 v115, v116, v114
    v_cmp_nge_f32 vcc, s32, v115
    s_cbranch_vccnz L_atfb_52
L_atfr_53:
    v_mul_f32 v48, v48, v114
    v_mul_f32 v49, v49, v114
    v_mul_f32 v50, v50, v114
    v_mul_f32 v51, v51, v114
    v_mul_f32 v52, v52, v114
    v_mul_f32 v53, v53, v114
    v_mul_f32 v54, v54, v114
    v_mul_f32 v55, v55, v114
    v_mul_f32 v56, v56, v114
    v_mul_f32 v57, v57, v114
    v_mul_f32 v58, v58, v114
    v_mul_f32 v59, v59, v114
    v_mul_f32 v60, v60, v114
    v_mul_f32 v61, v61, v114
    v_mul_f32 v62, v62, v114
    v_mul_f32 v63, v63, v114
    v_cvt_pk_bf16_f32 v48, v48, v49
    v_cvt_pk_bf16_f32 v49, v50, v51
    v_cvt_pk_bf16_f32 v50, v52, v53
    v_cvt_pk_bf16_f32 v51, v54, v55
    v_cvt_pk_bf16_f32 v52, v56, v57
    v_cvt_pk_bf16_f32 v53, v58, v59
    v_cvt_pk_bf16_f32 v54, v60, v61
    v_cvt_pk_bf16_f32 v55, v62, v63
    ds_write_b128 v10, v[48:51]
    ds_write_b128 v10, v[52:55] offset:1024
    s_lshl_b32 s20, s4, 10
    s_lshl_b32 s21, s3, 8
    s_add_u32 s20, s20, s21
    s_add_u32 s20, s20, s34
    s_add_u32 s21, s20, 0x80000
    s_waitcnt lgkmcnt(0)
    s_barrier
    ds_read_b128 v[64:67], v0 offset:16384
    ds_read_b128 v[68:71], v0 offset:17408
    ds_read_b128 v[72:75], v0 offset:18432
    ds_read_b128 v[76:79], v0 offset:19456
    ds_read_b128 v[80:83], v0 offset:20480
    ds_read_b128 v[84:87], v0 offset:21504
    ds_read_b128 v[88:91], v0 offset:22528
    ds_read_b128 v[92:95], v0 offset:23552
    s_waitcnt lgkmcnt(7)
    v_mfma_f32_16x16x32_bf16 v[96:99], v[128:131], v[64:67], 0
    v_mfma_f32_16x16x32_bf16 v[100:103], v[144:147], v[64:67], 0
    s_waitcnt lgkmcnt(6)
    v_mfma_f32_16x16x32_bf16 v[96:99], v[132:135], v[68:71], v[96:99]
    v_mfma_f32_16x16x32_bf16 v[100:103], v[148:151], v[68:71], v[100:103]
    s_waitcnt lgkmcnt(5)
    v_mfma_f32_16x16x32_bf16 v[96:99], v[136:139], v[72:75], v[96:99]
    v_mfma_f32_16x16x32_bf16 v[100:103], v[152:155], v[72:75], v[100:103]
    s_waitcnt lgkmcnt(4)
    v_mfma_f32_16x16x32_bf16 v[96:99], v[140:143], v[76:79], v[96:99]
    v_mfma_f32_16x16x32_bf16 v[100:103], v[156:159], v[76:79], v[100:103]
    v_mfma_f32_16x16x32_bf16 v[104:107], v[160:163], v[64:67], 0
    v_mfma_f32_16x16x32_bf16 v[108:111], v[176:179], v[64:67], 0
    v_mfma_f32_16x16x32_bf16 v[104:107], v[164:167], v[68:71], v[104:107]
    v_cvt_pk_bf16_f32 v48, v96, v97
    v_mfma_f32_16x16x32_bf16 v[108:111], v[180:183], v[68:71], v[108:111]
    v_cvt_pk_bf16_f32 v49, v98, v99
    v_mfma_f32_16x16x32_bf16 v[104:107], v[168:171], v[72:75], v[104:107]
    v_cvt_pk_bf16_f32 v50, v100, v101
    v_mfma_f32_16x16x32_bf16 v[108:111], v[184:187], v[72:75], v[108:111]
    v_cvt_pk_bf16_f32 v51, v102, v103
    v_mfma_f32_16x16x32_bf16 v[104:107], v[172:175], v[76:79], v[104:107]
    v_bfi_b32 v48, 1, s29, v48
    v_mfma_f32_16x16x32_bf16 v[108:111], v[188:191], v[76:79], v[108:111]
    buffer_store_dwordx4 v[48:51], v11, s[8:11], s20 offen offset:0
    v_mfma_f32_16x16x32_bf16 v[96:99], v[192:195], v[64:67], 0
    v_mfma_f32_16x16x32_bf16 v[100:103], v[208:211], v[64:67], 0
    v_mfma_f32_16x16x32_bf16 v[96:99], v[196:199], v[68:71], v[96:99]
    v_cvt_pk_bf16_f32 v52, v104, v105
    v_mfma_f32_16x16x32_bf16 v[100:103], v[212:215], v[68:71], v[100:103]
    v_cvt_pk_bf16_f32 v53, v106, v107
    v_mfma_f32_16x16x32_bf16 v[96:99], v[200:203], v[72:75], v[96:99]
    v_cvt_pk_bf16_f32 v54, v108, v109
    v_mfma_f32_16x16x32_bf16 v[100:103], v[216:219], v[72:75], v[100:103]
    v_cvt_pk_bf16_f32 v55, v110, v111
    v_mfma_f32_16x16x32_bf16 v[96:99], v[204:207], v[76:79], v[96:99]
    v_bfi_b32 v52, 1, s29, v52
    v_mfma_f32_16x16x32_bf16 v[100:103], v[220:223], v[76:79], v[100:103]
    buffer_store_dwordx4 v[52:55], v11, s[8:11], s20 offen offset:64
    v_mfma_f32_16x16x32_bf16 v[104:107], v[224:227], v[64:67], 0
    v_mfma_f32_16x16x32_bf16 v[108:111], v[240:243], v[64:67], 0
    v_mfma_f32_16x16x32_bf16 v[104:107], v[228:231], v[68:71], v[104:107]
    v_cvt_pk_bf16_f32 v56, v96, v97
    v_mfma_f32_16x16x32_bf16 v[108:111], v[244:247], v[68:71], v[108:111]
    v_cvt_pk_bf16_f32 v57, v98, v99
    v_mfma_f32_16x16x32_bf16 v[104:107], v[232:235], v[72:75], v[104:107]
    v_cvt_pk_bf16_f32 v58, v100, v101
    v_mfma_f32_16x16x32_bf16 v[108:111], v[248:251], v[72:75], v[108:111]
    v_cvt_pk_bf16_f32 v59, v102, v103
    v_mfma_f32_16x16x32_bf16 v[104:107], v[236:239], v[76:79], v[104:107]
    v_bfi_b32 v56, 1, s29, v56
    v_mfma_f32_16x16x32_bf16 v[108:111], v[252:255], v[76:79], v[108:111]
    buffer_store_dwordx4 v[56:59], v11, s[8:11], s20 offen offset:128
    s_waitcnt lgkmcnt(0)
    v_mfma_f32_16x16x32_bf16 v[96:99], v[128:131], v[80:83], 0
    v_mfma_f32_16x16x32_bf16 v[100:103], v[144:147], v[80:83], 0
    v_mfma_f32_16x16x32_bf16 v[96:99], v[132:135], v[84:87], v[96:99]
    v_cvt_pk_bf16_f32 v60, v104, v105
    v_mfma_f32_16x16x32_bf16 v[100:103], v[148:151], v[84:87], v[100:103]
    v_cvt_pk_bf16_f32 v61, v106, v107
    v_mfma_f32_16x16x32_bf16 v[96:99], v[136:139], v[88:91], v[96:99]
    v_cvt_pk_bf16_f32 v62, v108, v109
    v_mfma_f32_16x16x32_bf16 v[100:103], v[152:155], v[88:91], v[100:103]
    v_cvt_pk_bf16_f32 v63, v110, v111
    v_mfma_f32_16x16x32_bf16 v[96:99], v[140:143], v[92:95], v[96:99]
    v_bfi_b32 v60, 1, s29, v60
    v_mfma_f32_16x16x32_bf16 v[100:103], v[156:159], v[92:95], v[100:103]
    buffer_store_dwordx4 v[60:63], v11, s[8:11], s20 offen offset:192
    v_mfma_f32_16x16x32_bf16 v[104:107], v[160:163], v[80:83], 0
    v_mfma_f32_16x16x32_bf16 v[108:111], v[176:179], v[80:83], 0
    v_mfma_f32_16x16x32_bf16 v[104:107], v[164:167], v[84:87], v[104:107]
    v_cvt_pk_bf16_f32 v48, v96, v97
    v_mfma_f32_16x16x32_bf16 v[108:111], v[180:183], v[84:87], v[108:111]
    v_cvt_pk_bf16_f32 v49, v98, v99
    v_mfma_f32_16x16x32_bf16 v[104:107], v[168:171], v[88:91], v[104:107]
    v_cvt_pk_bf16_f32 v50, v100, v101
    v_mfma_f32_16x16x32_bf16 v[108:111], v[184:187], v[88:91], v[108:111]
    v_cvt_pk_bf16_f32 v51, v102, v103
    v_mfma_f32_16x16x32_bf16 v[104:107], v[172:175], v[92:95], v[104:107]
    v_bfi_b32 v48, 1, s29, v48
    v_mfma_f32_16x16x32_bf16 v[108:111], v[188:191], v[92:95], v[108:111]
    buffer_store_dwordx4 v[48:51], v11, s[8:11], s21 offen offset:0
    v_mfma_f32_16x16x32_bf16 v[96:99], v[192:195], v[80:83], 0
    v_mfma_f32_16x16x32_bf16 v[100:103], v[208:211], v[80:83], 0
    v_mfma_f32_16x16x32_bf16 v[96:99], v[196:199], v[84:87], v[96:99]
    v_cvt_pk_bf16_f32 v52, v104, v105
    v_mfma_f32_16x16x32_bf16 v[100:103], v[212:215], v[84:87], v[100:103]
    v_cvt_pk_bf16_f32 v53, v106, v107
    v_mfma_f32_16x16x32_bf16 v[96:99], v[200:203], v[88:91], v[96:99]
    v_cvt_pk_bf16_f32 v54, v108, v109
    v_mfma_f32_16x16x32_bf16 v[100:103], v[216:219], v[88:91], v[100:103]
    v_cvt_pk_bf16_f32 v55, v110, v111
    v_mfma_f32_16x16x32_bf16 v[96:99], v[204:207], v[92:95], v[96:99]
    v_bfi_b32 v52, 1, s29, v52
    v_mfma_f32_16x16x32_bf16 v[100:103], v[220:223], v[92:95], v[100:103]
    buffer_store_dwordx4 v[52:55], v11, s[8:11], s21 offen offset:64
    v_mfma_f32_16x16x32_bf16 v[104:107], v[224:227], v[80:83], 0
    v_mfma_f32_16x16x32_bf16 v[108:111], v[240:243], v[80:83], 0
    v_mfma_f32_16x16x32_bf16 v[104:107], v[228:231], v[84:87], v[104:107]
    v_cvt_pk_bf16_f32 v56, v96, v97
    v_mfma_f32_16x16x32_bf16 v[108:111], v[244:247], v[84:87], v[108:111]
    v_cvt_pk_bf16_f32 v57, v98, v99
    v_mfma_f32_16x16x32_bf16 v[104:107], v[232:235], v[88:91], v[104:107]
    v_cvt_pk_bf16_f32 v58, v100, v101
    v_mfma_f32_16x16x32_bf16 v[108:111], v[248:251], v[88:91], v[108:111]
    v_cvt_pk_bf16_f32 v59, v102, v103
    v_mfma_f32_16x16x32_bf16 v[104:107], v[236:239], v[92:95], v[104:107]
    v_bfi_b32 v56, 1, s29, v56
    v_mfma_f32_16x16x32_bf16 v[108:111], v[252:255], v[92:95], v[108:111]
    buffer_store_dwordx4 v[56:59], v11, s[8:11], s21 offen offset:128
    s_nop 3
    v_cvt_pk_bf16_f32 v60, v104, v105
    v_cvt_pk_bf16_f32 v61, v106, v107
    s_nop 0
    v_cvt_pk_bf16_f32 v62, v108, v109
    v_cvt_pk_bf16_f32 v63, v110, v111
    v_bfi_b32 v60, 1, s29, v60
    buffer_store_dwordx4 v[60:63], v11, s[8:11], s21 offen offset:192
    s_add_u32 s20, s25, 3
    s_cmp_lt_u32 s20, 64
    s_cbranch_scc0 L_atna_58
    s_xor_b32 s57, s57, 0x18000
    s_and_b32 s20, s3, 1
    s_lshl_b32 s20, s20, 12
    s_add_u32 s20, s20, s57
    v_add_u32 v126, s20, v0
    v_add_u32 v127, s57, v0
    s_lshr_b32 s20, s3, 1
    s_lshl_b32 s20, s20, 12
    s_add_u32 s20, s20, s57
    s_add_u32 s20, s20, 16384
    v_add_u32 v123, s20, v0
    ds_read_b128 v[32:35], v126 offset:0
    ds_read_b128 v[64:67], v127 offset:8192
    ds_read_b128 v[36:39], v126 offset:1024
    ds_read_b128 v[68:71], v127 offset:9216
    ds_read_b128 v[40:43], v126 offset:2048
    ds_read_b128 v[72:75], v127 offset:10240
    ds_read_b128 v[44:47], v126 offset:3072
    ds_read_b128 v[76:79], v127 offset:11264
    s_waitcnt lgkmcnt(6)
    v_mfma_f32_16x16x32_bf16 v[96:99], v[64:67], v[32:35], 0
    ds_read_b128 v[80:83], v127 offset:12288
    s_waitcnt lgkmcnt(5)
    v_mfma_f32_16x16x32_bf16 v[96:99], v[68:71], v[36:39], v[96:99]
    ds_read_b128 v[84:87], v127 offset:13312
    s_waitcnt lgkmcnt(4)
    v_mfma_f32_16x16x32_bf16 v[96:99], v[72:75], v[40:43], v[96:99]
    ds_read_b128 v[88:91], v127 offset:14336
    s_waitcnt lgkmcnt(3)
    v_mfma_f32_16x16x32_bf16 v[96:99], v[76:79], v[44:47], v[96:99]
    ds_read_b128 v[92:95], v127 offset:15360
    s_waitcnt lgkmcnt(3)
    v_mfma_f32_16x16x32_bf16 v[100:103], v[80:83], v[32:35], 0
    s_waitcnt lgkmcnt(2)
    v_mfma_f32_16x16x32_bf16 v[100:103], v[84:87], v[36:39], v[100:103]
    s_waitcnt lgkmcnt(1)
    v_mfma_f32_16x16x32_bf16 v[100:103], v[88:91], v[40:43], v[100:103]
    s_waitcnt lgkmcnt(0)
    v_mfma_f32_16x16x32_bf16 v[100:103], v[92:95], v[44:47], v[100:103]
    ds_read_b128 v[64:67], v123 offset:0
    ds_read_b128 v[68:71], v123 offset:1024
    ds_read_b128 v[72:75], v123 offset:2048
    ds_read_b128 v[76:79], v123 offset:3072
    v_exp_f32 v104, v96
    v_exp_f32 v105, v97
    v_exp_f32 v106, v98
    v_exp_f32 v107, v99
    v_exp_f32 v108, v100
    v_exp_f32 v109, v101
    v_exp_f32 v110, v102
    v_exp_f32 v111, v103
    v_cndmask_b32 v104, 0, v104, s[40:41]
    v_cndmask_b32 v105, 0, v105, s[42:43]
    v_cndmask_b32 v106, 0, v106, s[44:45]
    v_cndmask_b32 v107, 0, v107, s[46:47]
    v_cndmask_b32 v108, 0, v108, s[48:49]
    v_cndmask_b32 v109, 0, v109, s[50:51]
    v_cndmask_b32 v110, 0, v110, s[52:53]
    v_cndmask_b32 v111, 0, v111, s[54:55]
    v_cvt_pk_bf16_f32 v112, v104, v105
    v_cvt_pk_bf16_f32 v113, v106, v107
    v_cvt_pk_bf16_f32 v114, v108, v109
    v_cvt_pk_bf16_f32 v115, v110, v111
    s_waitcnt lgkmcnt(0)
    s_nop 0
    v_mfma_f32_16x16x32_bf16 v[116:119], v[6:9], v[112:115], 0
    v_mfma_f32_16x16x32_bf16 v[48:51], v[64:67], v[112:115], 0
    v_mfma_f32_16x16x32_bf16 v[52:55], v[68:71], v[112:115], 0
    v_mfma_f32_16x16x32_bf16 v[56:59], v[72:75], v[112:115], 0
    v_mfma_f32_16x16x32_bf16 v[60:63], v[76:79], v[112:115], 0
L_atna_58:
    s_lshl_b32 s20, s4, 15
    s_lshl_b32 s21, s3, 8
    s_add_u32 s20, s20, s21
    s_add_u32 s34, s34, s20
    s_nop 15
    s_nop 15
    s_nop 15
    s_nop 15
    s_nop 15
    s_nop 15
    s_nop 15
    s_nop 15
    s_mov_b32 s22, 0
L_rp_59:
    s_mov_b32 s20, s34
    buffer_load_dwordx4 v[64:67], v15, s[8:11], s20 offen sc1
    s_add_u32 s20, s20, 4096
    buffer_load_dwordx4 v[68:71], v15, s[8:11], s20 offen sc1
    s_add_u32 s20, s20, 4096
    buffer_load_dwordx4 v[72:75], v15, s[8:11], s20 offen sc1
    s_add_u32 s20, s20, 4096
    buffer_load_dwordx4 v[76:79], v15, s[8:11], s20 offen sc1
    s_add_u32 s20, s20, 4096
    buffer_load_dwordx4 v[80:83], v15, s[8:11], s20 offen sc1
    s_add_u32 s20, s20, 4096
    buffer_load_dwordx4 v[84:87], v15, s[8:11], s20 offen sc1
    s_add_u32 s20, s20, 4096
    buffer_load_dwordx4 v[88:91], v15, s[8:11], s20 offen sc1
    s_add_u32 s20, s20, 4096
    buffer_load_dwordx4 v[92:95], v15, s[8:11], s20 offen sc1
    s_add_u32 s22, s22, 1
    s_cmp_gt_u32 s22, 100000
    s_cbranch_scc1 L_fail
    s_waitcnt vmcnt(7)
    v_mfma_f32_16x16x32_bf16 v[104:107], v[28:31], v[64:67], 0
    v_xor_b32 v108, s29, v64
    s_waitcnt vmcnt(6)
    v_mfma_f32_16x16x32_bf16 v[104:107], v[28:31], v[68:71], v[104:107]
    v_bitop3_b32 v108, v108, v68, s29 bitop3:0xf6
    s_waitcnt vmcnt(5)
    v_mfma_f32_16x16x32_bf16 v[104:107], v[28:31], v[72:75], v[104:107]
    v_bitop3_b32 v108, v108, v72, s29 bitop3:0xf6
    s_waitcnt vmcnt(4)
    v_mfma_f32_16x16x32_bf16 v[104:107], v[28:31], v[76:79], v[104:107]
    v_bitop3_b32 v108, v108, v76, s29 bitop3:0xf6
    s_waitcnt vmcnt(3)
    v_mfma_f32_16x16x32_bf16 v[104:107], v[28:31], v[80:83], v[104:107]
    v_bitop3_b32 v108, v108, v80, s29 bitop3:0xf6
    s_waitcnt vmcnt(2)
    v_mfma_f32_16x16x32_bf16 v[104:107], v[28:31], v[84:87], v[104:107]
    v_bitop3_b32 v108, v108, v84, s29 bitop3:0xf6
    s_waitcnt vmcnt(1)
    v_mfma_f32_16x16x32_bf16 v[104:107], v[28:31], v[88:91], v[104:107]
    v_bitop3_b32 v108, v108, v88, s29 bitop3:0xf6
    s_waitcnt vmcnt(0)
    v_mfma_f32_16x16x32_bf16 v[104:107], v[28:31], v[92:95], v[104:107]
    v_bitop3_b32 v108, v108, v92, s29 bitop3:0xf6
    v_and_b32 v108, 1, v108
    v_cmp_ne_u32 vcc, 0, v108
    s_cbranch_vccnz L_rp_59
    v_lshlrev_b32 v108, 16, v124
    v_and_b32 v109, 0xffff0000, v124
    v_lshlrev_b32 v110, 16, v125
    v_and_b32 v111, 0xffff0000, v125
    v_cvt_pk_bf16_f32 v104, v104, v105
    v_cvt_pk_bf16_f32 v105, v106, v107
    v_lshlrev_b32 v106, 16, v105
    v_and_b32 v107, 0xffff0000, v105
    v_and_b32 v105, 0xffff0000, v104
    v_lshlrev_b32 v104, 16, v104
    v_mul_f32 v104, v16, v104
    v_mul_f32 v105, v17, v105
    v_mul_f32 v106, v18, v106
    v_mul_f32 v107, v19, v107
    v_cvt_pk_bf16_f32 v104, v104, v105
    v_cvt_pk_bf16_f32 v105, v106, v107
    v_lshlrev_b32 v106, 16, v105
    v_and_b32 v107, 0xffff0000, v105
    v_and_b32 v105, 0xffff0000, v104
    v_lshlrev_b32 v104, 16, v104
    v_add_f32 v108, v108, v104
    v_add_f32 v109, v109, v105
    v_add_f32 v110, v110, v106
    v_add_f32 v111, v111, v107
    v_cvt_pk_bf16_f32 v104, v108, v109
    v_cvt_pk_bf16_f32 v105, v110, v111
    s_add_u32 s20, s35, 0x600000
    buffer_store_dwordx2 v[104:105], v12, s[8:11], s20 offen sc1
    s_cmp_lt_u32 s56, 64
    s_cbranch_scc0 L_atnf_60
    s_mov_b32 s22, 0
L_atf_61:
    s_mov_b64 exec, 3
    buffer_load_dword v122, v0, s[8:11], s30 offen sc1
    s_add_u32 s22, s22, 1
    s_cmp_gt_u32 s22, 100000
    s_cbranch_scc1 L_fail
    s_add_u32 s20, s7, s56
    s_add_u32 s20, s20, 1
    s_sub_u32 s21, 63, s56
    s_waitcnt vmcnt(0)
    v_subrev_u32 v122, s20, v122
    v_cmp_lt_u32 vcc, s21, v122
    s_mov_b64 exec, -1
    s_cbranch_vccnz L_atf_61
    s_lshl_b32 s26, s4, 15
    s_lshl_b32 s20, s56, 20
    s_add_u32 s26, s26, s20
    s_add_u32 s26, s26, 0x2000000
    s_mul_i32 s20, s3, 6144
    s_add_u32 s26, s26, s20
    s_add_u32 s20, s20, s38
    s_xor_b32 s38, s38, 0x18000
    s_mov_b32 m0, s20
    s_nop 0
    buffer_load_dwordx4 v0, s[8:11], s26 offen offset:0 sc1 lds
    buffer_load_dwordx4 v0, s[8:11], s26 offen offset:1024 sc1 lds
    buffer_load_dwordx4 v0, s[8:11], s26 offen offset:2048 sc1 lds
    s_add_u32 s20, s20, 3072
    s_add_u32 s26, s26, 3072
    s_mov_b32 m0, s20
    s_nop 0
    buffer_load_dwordx4 v0, s[8:11], s26 offen offset:0 sc1 lds
    buffer_load_dwordx4 v0, s[8:11], s26 offen offset:1024 sc1 lds
    buffer_load_dwordx4 v0, s[8:11], s26 offen offset:2048 sc1 lds
    s_add_u32 s56, s56, 3
L_atnf_60:
    s_add_u32 s25, s25, 3
    s_cmp_lt_u32 s25, 64
    s_cbranch_scc1 L_at_51
    s_branch L_done
L_atfb_52:
    s_nop 15
    s_lshr_b32 s20, s3, 1
    s_lshl_b32 s20, s20, 12
    s_add_u32 s20, s20, s57
    s_add_u32 s20, s20, 16384
    v_add_u32 v123, s20, v0
    ds_read_b128 v[64:67], v123 offset:0
    ds_read_b128 v[68:71], v123 offset:1024
    ds_read_b128 v[72:75], v123 offset:2048
    ds_read_b128 v[76:79], v123 offset:3072
    v_mov_b32 v115, s36
    v_cndmask_b32 v96, v115, v96, s[40:41]
    v_mov_b32 v115, s36
    v_cndmask_b32 v97, v115, v97, s[42:43]
    v_mov_b32 v115, s36
    v_cndmask_b32 v98, v115, v98, s[44:45]
    v_mov_b32 v115, s36
    v_cndmask_b32 v99, v115, v99, s[46:47]
    v_mov_b32 v115, s36
    v_cndmask_b32 v100, v115, v100, s[48:49]
    v_mov_b32 v115, s36
    v_cndmask_b32 v101, v115, v101, s[50:51]
    v_mov_b32 v115, s36
    v_cndmask_b32 v102, v115, v102, s[52:53]
    v_mov_b32 v115, s36
    v_cndmask_b32 v103, v115, v103, s[54:55]
    v_max3_f32 v114, v96, v97, v98
    v_max3_f32 v114, v114, v99, v100
    v_max3_f32 v114, v114, v101, v102
    v_max3_f32 v114, v114, v103, v108
    v_max_f32 v114, v114, v109
    v_mov_b32 v115, v114
    s_nop 1
    v_permlane32_swap_b32 v114, v115
    v_max_f32 v114, v114, v115
    v_mov_b32 v115, v114
    s_nop 1
    v_permlane16_swap_b32 v114, v115
    v_max_f32 v114, v114, v115
    v_sub_f32 v96, v96, v114
    v_exp_f32 v96, v96
    v_sub_f32 v97, v97, v114
    v_exp_f32 v97, v97
    v_sub_f32 v98, v98, v114
    v_exp_f32 v98, v98
    v_sub_f32 v99, v99, v114
    v_exp_f32 v99, v99
    v_sub_f32 v100, v100, v114
    v_exp_f32 v100, v100
    v_sub_f32 v101, v101, v114
    v_exp_f32 v101, v101
    v_sub_f32 v102, v102, v114
    v_exp_f32 v102, v102
    v_sub_f32 v103, v103, v114
    v_exp_f32 v103, v103
    v_cndmask_b32 v96, 0, v96, s[40:41]
    v_cndmask_b32 v97, 0, v97, s[42:43]
    v_cndmask_b32 v98, 0, v98, s[44:45]
    v_cndmask_b32 v99, 0, v99, s[46:47]
    v_cndmask_b32 v100, 0, v100, s[48:49]
    v_cndmask_b32 v101, 0, v101, s[50:51]
    v_cndmask_b32 v102, 0, v102, s[52:53]
    v_cndmask_b32 v103, 0, v103, s[54:55]
    v_cvt_pk_bf16_f32 v88, v96, v97
    v_cvt_pk_bf16_f32 v89, v98, v99
    v_cvt_pk_bf16_f32 v90, v100, v101
    v_cvt_pk_bf16_f32 v91, v102, v103
    v_sub_f32 v110, v108, v114
    v_exp_f32 v110, v110
    v_sub_f32 v111, v109, v114
    v_exp_f32 v111, v111
    s_nop 0
    v_cvt_pk_bf16_f32 v112, v110, v111
    v_mov_b32 v113, v112
    s_nop 1
    v_permlane32_swap_b32 v112, v113
    s_waitcnt lgkmcnt(0)
    v_mfma_f32_16x16x32_bf16 v[116:119], v[6:9], v[88:91], 0
    v_mfma_f32_16x16x32_bf16 v[48:51], v[64:67], v[88:91], 0
    v_mfma_f32_16x16x32_bf16 v[52:55], v[68:71], v[88:91], 0
    v_mfma_f32_16x16x32_bf16 v[56:59], v[72:75], v[88:91], 0
    v_mfma_f32_16x16x32_bf16 v[60:63], v[76:79], v[88:91], 0
    v_mfma_f32_16x16x16_bf16 v[116:119], v[4:5], v[112:113], v[116:119]
    v_mfma_f32_16x16x16_bf16 v[48:51], v[80:81], v[112:113], v[48:51]
    v_mfma_f32_16x16x16_bf16 v[52:55], v[82:83], v[112:113], v[52:55]
    v_mfma_f32_16x16x16_bf16 v[56:59], v[84:85], v[112:113], v[56:59]
    v_mfma_f32_16x16x16_bf16 v[60:63], v[86:87], v[112:113], v[60:63]
    s_nop 11
    v_rcp_f32 v114, v116
    s_nop 1
    s_branch L_atfr_53
L_role_qkv:
    s_lshl_b32 s20, s5, 3
    s_add_u32 s20, s20, 16
    s_load_dwordx2 s[60:61], s[0:1], s20
    s_load_dwordx2 s[62:63], s[0:1], 16
    v_and_b32 v1, 63, v0
    v_lshrrev_b32 v2, 4, v1
    v_and_b32 v3, 15, v1
    v_lshrrev_b32 v4, 2, v3
    v_and_b32 v5, 3, v3
    v_lshlrev_b32 v6, 4, v1
    v_or_b32 v10, 0, v2
    v_lshlrev_b32 v10, 1, v10
    v_xor_b32 v10, v10, v3
    v_lshlrev_b32 v10, 4, v10
    v_lshl_add_u32 v8, v2, 13, v10
    v_or_b32 v10, 4, v2
    v_lshlrev_b32 v10, 1, v10
    v_xor_b32 v10, v10, v3
    v_lshlrev_b32 v10, 4, v10
    v_lshl_add_u32 v9, v2, 13, v10
    v_lshl_add_u32 v10, v2, 3, v4
    v_and_b32 v11, 1, v2
    v_lshl_add_u32 v11, v11, 2, v4
    s_lshl_b32 s20, s3, 1
    v_xor_b32 v11, s20, v11
    v_lshlrev_b32 v11, 5, v11
    v_lshl_add_u32 v11, v10, 8, v11
    v_lshl_add_u32 v12, v5, 3, v11
    v_xor_b32 v13, 32, v12
    v_bfe_u32 v16, v1, 4, 1
    v_or_b32 v16, 0, v16
    v_lshlrev_b32 v16, 1, v16
    v_and_b32 v17, 7, v1
    v_xor_b32 v16, v16, v17
    v_lshlrev_b32 v16, 4, v16
    v_lshrrev_b32 v17, 3, v1
    v_lshl_add_u32 v18, v17, 13, v16
    v_bfe_u32 v16, v1, 4, 1
    v_or_b32 v16, 2, v16
    v_lshlrev_b32 v16, 1, v16
    v_and_b32 v17, 7, v1
    v_xor_b32 v16, v16, v17
    v_lshlrev_b32 v16, 4, v16
    v_lshrrev_b32 v17, 3, v1
    v_lshl_add_u32 v19, v17, 13, v16
    v_lshrrev_b32 v16, 1, v4
    v_and_b32 v17, 1, v2
    v_lshl_add_u32 v16, v17, 1, v16
    s_and_b32 s20, s3, 1
    s_lshl_b32 s20, s20, 1
    v_xor_b32 v16, s20, v16
    v_lshlrev_b32 v16, 5, v16
    v_lshl_add_u32 v16, v10, 7, v16
    v_lshl_add_u32 v20, v5, 3, v16
    v_xor_b32 v21, 32, v20
    s_waitcnt lgkmcnt(0)
    s_mov_b32 s12, s60
    s_and_b32 s13, s61, 0xffff
    s_mov_b32 s14, 0x400000
    s_mov_b32 s15, 0x20000
    s_lshl_b32 s23, s3, 17
    s_lshl_b32 s20, s4, 8
    s_add_u32 s23, s23, s20
    s_add_u32 s23, s23, 0x0
    s_lshl_b32 s24, s3, 12
    s_add_u32 s24, s24, 0
    s_mov_b32 m0, s24
    s_add_u32 s24, s24, 1024
    buffer_load_dwordx4 v8, s[12:15], s23 offen  lds
    s_add_u32 s23, s23, 32768
    s_mov_b32 m0, s24
    s_add_u32 s24, s24, 1024
    buffer_load_dwordx4 v8, s[12:15], s23 offen  lds
    s_add_u32 s23, s23, 32768
    s_mov_b32 m0, s24
    s_add_u32 s24, s24, 1024
    buffer_load_dwordx4 v9, s[12:15], s23 offen  lds
    s_add_u32 s23, s23, 32768
    s_mov_b32 m0, s24
    s_nop 0
    buffer_load_dwordx4 v9, s[12:15], s23 offen  lds
    s_lshl_b32 s23, s3, 17
    s_lshl_b32 s20, s4, 8
    s_add_u32 s23, s23, s20
    s_add_u32 s23, s23, 0x80000
    s_lshl_b32 s24, s3, 12
    s_add_u32 s24, s24, 16384
    s_mov_b32 m0, s24
    s_add_u32 s24, s24, 1024
    buffer_load_dwordx4 v8, s[12:15], s23 offen  lds
    s_add_u32 s23, s23, 32768
    s_mov_b32 m0, s24
    s_add_u32 s24, s24, 1024
    buffer_load_dwordx4 v8, s[12:15], s23 offen  lds
    s_add_u32 s23, s23, 32768
    s_mov_b32 m0, s24
    s_add_u32 s24, s24, 1024
    buffer_load_dwordx4 v9, s[12:15], s23 offen  lds
    s_add_u32 s23, s23, 32768
    s_mov_b32 m0, s24
    s_nop 0
    buffer_load_dwordx4 v9, s[12:15], s23 offen  lds
    s_lshl_b32 s23, s3, 17
    s_lshl_b32 s20, s4, 8
    s_add_u32 s23, s23, s20
    s_add_u32 s23, s23, 0x100000
    s_lshl_b32 s24, s3, 12
    s_add_u32 s24, s24, 32768
    s_mov_b32 m0, s24
    s_add_u32 s24, s24, 1024
    buffer_load_dwordx4 v8, s[12:15], s23 offen  lds
    s_add_u32 s23, s23, 32768
    s_mov_b32 m0, s24
    s_add_u32 s24, s24, 1024
    buffer_load_dwordx4 v8, s[12:15], s23 offen  lds
    s_add_u32 s23, s23, 32768
    s_mov_b32 m0, s24
    s_add_u32 s24, s24, 1024
    buffer_load_dwordx4 v9, s[12:15], s23 offen  lds
    s_add_u32 s23, s23, 32768
    s_mov_b32 m0, s24
    s_nop 0
    buffer_load_dwordx4 v9, s[12:15], s23 offen  lds
    s_lshl_b32 s23, s3, 17
    s_lshl_b32 s20, s4, 8
    s_add_u32 s23, s23, s20
    s_add_u32 s23, s23, 0x180000
    s_lshl_b32 s24, s3, 12
    s_add_u32 s24, s24, 49152
    s_mov_b32 m0, s24
    s_add_u32 s24, s24, 1024
    buffer_load_dwordx4 v8, s[12:15], s23 offen  lds
    s_add_u32 s23, s23, 32768
    s_mov_b32 m0, s24
    s_add_u32 s24, s24, 1024
    buffer_load_dwordx4 v8, s[12:15], s23 offen  lds
    s_add_u32 s23, s23, 32768
    s_mov_b32 m0, s24
    s_add_u32 s24, s24, 1024
    buffer_load_dwordx4 v9, s[12:15], s23 offen  lds
    s_add_u32 s23, s23, 32768
    s_mov_b32 m0, s24
    s_nop 0
    buffer_load_dwordx4 v9, s[12:15], s23 offen  lds
    s_lshl_b32 s23, s3, 17
    s_lshl_b32 s20, s4, 8
    s_add_u32 s23, s23, s20
    s_add_u32 s23, s23, 0x200000
    s_lshl_b32 s24, s3, 12
    s_add_u32 s24, s24, 65536
    s_mov_b32 m0, s24
    s_add_u32 s24, s24, 1024
    buffer_load_dwordx4 v8, s[12:15], s23 offen  lds
    s_add_u32 s23, s23, 32768
    s_mov_b32 m0, s24
    s_add_u32 s24, s24, 1024
    buffer_load_dwordx4 v8, s[12:15], s23 offen  lds
    s_add_u32 s23, s23, 32768
    s_mov_b32 m0, s24
    s_add_u32 s24, s24, 1024
    buffer_load_dwordx4 v9, s[12:15], s23 offen  lds
    s_add_u32 s23, s23, 32768
    s_mov_b32 m0, s24
    s_nop 0
    buffer_load_dwordx4 v9, s[12:15], s23 offen  lds
    s_lshl_b32 s23, s3, 17
    s_lshl_b32 s20, s4, 8
    s_add_u32 s23, s23, s20
    s_add_u32 s23, s23, 0x280000
    s_lshl_b32 s24, s3, 12
    s_add_u32 s24, s24, 81920
    s_mov_b32 m0, s24
    s_add_u32 s24, s24, 1024
    buffer_load_dwordx4 v8, s[12:15], s23 offen  lds
    s_add_u32 s23, s23, 32768
    s_mov_b32 m0, s24
    s_add_u32 s24, s24, 1024
    buffer_load_dwordx4 v8, s[12:15], s23 offen  lds
    s_add_u32 s23, s23, 32768
    s_mov_b32 m0, s24
    s_add_u32 s24, s24, 1024
    buffer_load_dwordx4 v9, s[12:15], s23 offen  lds
    s_add_u32 s23, s23, 32768
    s_mov_b32 m0, s24
    s_nop 0
    buffer_load_dwordx4 v9, s[12:15], s23 offen  lds
    s_lshl_b32 s23, s3, 17
    s_lshl_b32 s20, s4, 8
    s_add_u32 s23, s23, s20
    s_add_u32 s23, s23, 0x300000
    s_lshl_b32 s24, s3, 12
    s_add_u32 s24, s24, 98304
    s_mov_b32 m0, s24
    s_add_u32 s24, s24, 1024
    buffer_load_dwordx4 v8, s[12:15], s23 offen  lds
    s_add_u32 s23, s23, 32768
    s_mov_b32 m0, s24
    s_add_u32 s24, s24, 1024
    buffer_load_dwordx4 v8, s[12:15], s23 offen  lds
    s_add_u32 s23, s23, 32768
    s_mov_b32 m0, s24
    s_add_u32 s24, s24, 1024
    buffer_load_dwordx4 v9, s[12:15], s23 offen  lds
    s_add_u32 s23, s23, 32768
    s_mov_b32 m0, s24
    s_nop 0
    buffer_load_dwordx4 v9, s[12:15], s23 offen  lds
    s_lshl_b32 s23, s3, 17
    s_lshl_b32 s20, s4, 8
    s_add_u32 s23, s23, s20
    s_add_u32 s23, s23, 0x380000
    s_lshl_b32 s24, s3, 12
    s_add_u32 s24, s24, 114688
    s_mov_b32 m0, s24
    s_add_u32 s24, s24, 1024
    buffer_load_dwordx4 v8, s[12:15], s23 offen  lds
    s_add_u32 s23, s23, 32768
    s_mov_b32 m0, s24
    s_add_u32 s24, s24, 1024
    buffer_load_dwordx4 v8, s[12:15], s23 offen  lds
    s_add_u32 s23, s23, 32768
    s_mov_b32 m0, s24
    s_add_u32 s24, s24, 1024
    buffer_load_dwordx4 v9, s[12:15], s23 offen  lds
    s_add_u32 s23, s23, 32768
    s_mov_b32 m0, s24
    s_nop 0
    buffer_load_dwordx4 v9, s[12:15], s23 offen  lds
    s_waitcnt vmcnt(28) lgkmcnt(0)
    s_barrier
    ds_read_b64_tr_b16 a[0:1], v12 offset:0
    ds_read_b64_tr_b16 a[2:3], v12 offset:1024
    ds_read_b64_tr_b16 a[4:5], v13 offset:0
    ds_read_b64_tr_b16 a[6:7], v13 offset:1024
    ds_read_b64_tr_b16 a[8:9], v12 offset:8192
    ds_read_b64_tr_b16 a[10:11], v12 offset:9216
    ds_read_b64_tr_b16 a[12:13], v13 offset:8192
    ds_read_b64_tr_b16 a[14:15], v13 offset:9216
    s_waitcnt vmcnt(24) lgkmcnt(0)
    s_barrier
    s_mov_b32 s12, s62
    s_and_b32 s13, s63, 0xffff
    s_mov_b32 s14, 0x400000
    s_mov_b32 s15, 0x20000
    s_lshl_b32 s23, s3, 18
    s_lshl_b32 s20, s4, 8
    s_add_u32 s23, s23, s20
    s_sub_u32 s20, s5, 1
    s_lshl_b32 s20, s20, 7
    s_add_u32 s23, s23, s20
    s_add_u32 s23, s23, 0x0
    s_lshl_b32 s24, s3, 12
    s_add_u32 s24, s24, 0
    s_mov_b32 m0, s24
    s_add_u32 s24, s24, 1024
    buffer_load_dwordx4 v18, s[12:15], s23 offen  lds
    s_add_u32 s23, s23, 65536
    s_mov_b32 m0, s24
    s_add_u32 s24, s24, 1024
    buffer_load_dwordx4 v19, s[12:15], s23 offen  lds
    s_add_u32 s23, s23, 65536
    s_mov_b32 m0, s24
    s_add_u32 s24, s24, 1024
    buffer_load_dwordx4 v18, s[12:15], s23 offen  lds
    s_add_u32 s23, s23, 65536
    s_mov_b32 m0, s24
    s_nop 0
    buffer_load_dwordx4 v19, s[12:15], s23 offen  lds
    ds_read_b64_tr_b16 a[16:17], v12 offset:16384
    ds_read_b64_tr_b16 a[18:19], v12 offset:17408
    ds_read_b64_tr_b16 a[20:21], v13 offset:16384
    ds_read_b64_tr_b16 a[22:23], v13 offset:17408
    ds_read_b64_tr_b16 a[24:25], v12 offset:24576
    ds_read_b64_tr_b16 a[26:27], v12 offset:25600
    ds_read_b64_tr_b16 a[28:29], v13 offset:24576
    ds_read_b64_tr_b16 a[30:31], v13 offset:25600
    s_waitcnt vmcnt(24) lgkmcnt(0)
    s_barrier
    s_lshl_b32 s23, s3, 18
    s_lshl_b32 s20, s4, 8
    s_add_u32 s23, s23, s20
    s_sub_u32 s20, s5, 1
    s_lshl_b32 s20, s20, 7
    s_add_u32 s23, s23, s20
    s_add_u32 s23, s23, 0x100000
    s_lshl_b32 s24, s3, 12
    s_add_u32 s24, s24, 16384
    s_mov_b32 m0, s24
    s_add_u32 s24, s24, 1024
    buffer_load_dwordx4 v18, s[12:15], s23 offen  lds
    s_add_u32 s23, s23, 65536
    s_mov_b32 m0, s24
    s_add_u32 s24, s24, 1024
    buffer_load_dwordx4 v19, s[12:15], s23 offen  lds
    s_add_u32 s23, s23, 65536
    s_mov_b32 m0, s24
    s_add_u32 s24, s24, 1024
    buffer_load_dwordx4 v18, s[12:15], s23 offen  lds
    s_add_u32 s23, s23, 65536
    s_mov_b32 m0, s24
    s_nop 0
    buffer_load_dwordx4 v19, s[12:15], s23 offen  lds
    ds_read_b64_tr_b16 a[32:33], v12 offset:32768
    ds_read_b64_tr_b16 a[34:35], v12 offset:33792
    ds_read_b64_tr_b16 a[36:37], v13 offset:32768
    ds_read_b64_tr_b16 a[38:39], v13 offset:33792
    ds_read_b64_tr_b16 a[40:41], v12 offset:40960
    ds_read_b64_tr_b16 a[42:43], v12 offset:41984
    ds_read_b64_tr_b16 a[44:45], v13 offset:40960
    ds_read_b64_tr_b16 a[46:47], v13 offset:41984
    s_waitcnt vmcnt(24) lgkmcnt(0)
    s_barrier
    s_lshl_b32 s23, s3, 18
    s_lshl_b32 s20, s4, 8
    s_add_u32 s23, s23, s20
    s_sub_u32 s20, s5, 1
    s_lshl_b32 s20, s20, 7
    s_add_u32 s23, s23, s20
    s_add_u32 s23, s23, 0x200000
    s_lshl_b32 s24, s3, 12
    s_add_u32 s24, s24, 32768
    s_mov_b32 m0, s24
    s_add_u32 s24, s24, 1024
    buffer_load_dwordx4 v18, s[12:15], s23 offen  lds
    s_add_u32 s23, s23, 65536
    s_mov_b32 m0, s24
    s_add_u32 s24, s24, 1024
    buffer_load_dwordx4 v19, s[12:15], s23 offen  lds
    s_add_u32 s23, s23, 65536
    s_mov_b32 m0, s24
    s_add_u32 s24, s24, 1024
    buffer_load_dwordx4 v18, s[12:15], s23 offen  lds
    s_add_u32 s23, s23, 65536
    s_mov_b32 m0, s24
    s_nop 0
    buffer_load_dwordx4 v19, s[12:15], s23 offen  lds
    ds_read_b64_tr_b16 a[48:49], v12 offset:49152
    ds_read_b64_tr_b16 a[50:51], v12 offset:50176
    ds_read_b64_tr_b16 a[52:53], v13 offset:49152
    ds_read_b64_tr_b16 a[54:55], v13 offset:50176
    ds_read_b64_tr_b16 a[56:57], v12 offset:57344
    ds_read_b64_tr_b16 a[58:59], v12 offset:58368
    ds_read_b64_tr_b16 a[60:61], v13 offset:57344
    ds_read_b64_tr_b16 a[62:63], v13 offset:58368
    s_waitcnt vmcnt(24) lgkmcnt(0)
    s_barrier
    s_lshl_b32 s23, s3, 18
    s_lshl_b32 s20, s4, 8
    s_add_u32 s23, s23, s20
    s_sub_u32 s20, s5, 1
    s_lshl_b32 s20, s20, 7
    s_add_u32 s23, s23, s20
    s_add_u32 s23, s23, 0x300000
    s_lshl_b32 s24, s3, 12
    s_add_u32 s24, s24, 49152
    s_mov_b32 m0, s24
    s_add_u32 s24, s24, 1024
    buffer_load_dwordx4 v18, s[12:15], s23 offen  lds
    s_add_u32 s23, s23, 65536
    s_mov_b32 m0, s24
    s_add_u32 s24, s24, 1024
    buffer_load_dwordx4 v19, s[12:15], s23 offen  lds
    s_add_u32 s23, s23, 65536
    s_mov_b32 m0, s24
    s_add_u32 s24, s24, 1024
    buffer_load_dwordx4 v18, s[12:15], s23 offen  lds
    s_add_u32 s23, s23, 65536
    s_mov_b32 m0, s24
    s_nop 0
    buffer_load_dwordx4 v19, s[12:15], s23 offen  lds
    v_add_u32 v14, 65536, v12
    ds_read_b64_tr_b16 a[64:65], v14 offset:0
    v_add_u32 v14, 65536, v12
    ds_read_b64_tr_b16 a[66:67], v14 offset:1024
    v_add_u32 v14, 65536, v13
    ds_read_b64_tr_b16 a[68:69], v14 offset:0
    v_add_u32 v14, 65536, v13
    ds_read_b64_tr_b16 a[70:71], v14 offset:1024
    v_add_u32 v14, 65536, v12
    ds_read_b64_tr_b16 a[72:73], v14 offset:8192
    v_add_u32 v14, 65536, v12
    ds_read_b64_tr_b16 a[74:75], v14 offset:9216
    v_add_u32 v14, 65536, v13
    ds_read_b64_tr_b16 a[76:77], v14 offset:8192
    v_add_u32 v14, 65536, v13
    ds_read_b64_tr_b16 a[78:79], v14 offset:9216
    s_waitcnt vmcnt(24) lgkmcnt(0)
    s_barrier
    v_add_u32 v14, 65536, v12
    ds_read_b64_tr_b16 a[80:81], v14 offset:16384
    v_add_u32 v14, 65536, v12
    ds_read_b64_tr_b16 a[82:83], v14 offset:17408
    v_add_u32 v14, 65536, v13
    ds_read_b64_tr_b16 a[84:85], v14 offset:16384
    v_add_u32 v14, 65536, v13
    ds_read_b64_tr_b16 a[86:87], v14 offset:17408
    v_add_u32 v14, 65536, v12
    ds_read_b64_tr_b16 a[88:89], v14 offset:24576
    v_add_u32 v14, 65536, v12
    ds_read_b64_tr_b16 a[90:91], v14 offset:25600
    v_add_u32 v14, 65536, v13
    ds_read_b64_tr_b16 a[92:93], v14 offset:24576
    v_add_u32 v14, 65536, v13
    ds_read_b64_tr_b16 a[94:95], v14 offset:25600
    s_waitcnt vmcnt(20) lgkmcnt(0)
    s_barrier
    v_add_u32 v14, 98304, v12
    ds_read_b64_tr_b16 a[96:97], v14 offset:0
    v_add_u32 v14, 98304, v12
    ds_read_b64_tr_b16 a[98:99], v14 offset:1024
    v_add_u32 v14, 98304, v13
    ds_read_b64_tr_b16 a[100:101], v14 offset:0
    v_add_u32 v14, 98304, v13
    ds_read_b64_tr_b16 a[102:103], v14 offset:1024
    v_add_u32 v14, 98304, v12
    ds_read_b64_tr_b16 a[104:105], v14 offset:8192
    v_add_u32 v14, 98304, v12
    ds_read_b64_tr_b16 a[106:107], v14 offset:9216
    v_add_u32 v14, 98304, v13
    ds_read_b64_tr_b16 a[108:109], v14 offset:8192
    v_add_u32 v14, 98304, v13
    ds_read_b64_tr_b16 a[110:111], v14 offset:9216
    s_waitcnt vmcnt(16) lgkmcnt(0)
    s_barrier
    v_add_u32 v14, 98304, v12
    ds_read_b64_tr_b16 a[112:113], v14 offset:16384
    v_add_u32 v14, 98304, v12
    ds_read_b64_tr_b16 a[114:115], v14 offset:17408
    v_add_u32 v14, 98304, v13
    ds_read_b64_tr_b16 a[116:117], v14 offset:16384
    v_add_u32 v14, 98304, v13
    ds_read_b64_tr_b16 a[118:119], v14 offset:17408
    v_add_u32 v14, 98304, v12
    ds_read_b64_tr_b16 a[120:121], v14 offset:24576
    v_add_u32 v14, 98304, v12
    ds_read_b64_tr_b16 a[122:123], v14 offset:25600
    v_add_u32 v14, 98304, v13
    ds_read_b64_tr_b16 a[124:125], v14 offset:24576
    v_add_u32 v14, 98304, v13
    ds_read_b64_tr_b16 a[126:127], v14 offset:25600
    s_waitcnt vmcnt(12) lgkmcnt(0)
    s_barrier
    ds_read_b64_tr_b16 a[128:129], v20 offset:0
    ds_read_b64_tr_b16 a[130:131], v20 offset:512
    ds_read_b64_tr_b16 a[132:133], v21 offset:0
    ds_read_b64_tr_b16 a[134:135], v21 offset:512
    ds_read_b64_tr_b16 a[136:137], v20 offset:4096
    ds_read_b64_tr_b16 a[138:139], v20 offset:4608
    ds_read_b64_tr_b16 a[140:141], v21 offset:4096
    ds_read_b64_tr_b16 a[142:143], v21 offset:4608
    ds_read_b64_tr_b16 a[144:145], v20 offset:8192
    ds_read_b64_tr_b16 a[146:147], v20 offset:8704
    ds_read_b64_tr_b16 a[148:149], v21 offset:8192
    ds_read_b64_tr_b16 a[150:151], v21 offset:8704
    ds_read_b64_tr_b16 a[152:153], v20 offset:12288
    ds_read_b64_tr_b16 a[154:155], v20 offset:12800
    ds_read_b64_tr_b16 a[156:157], v21 offset:12288
    ds_read_b64_tr_b16 a[158:159], v21 offset:12800
    s_waitcnt vmcnt(8) lgkmcnt(0)
    s_barrier
    ds_read_b64_tr_b16 a[160:161], v20 offset:16384
    ds_read_b64_tr_b16 a[162:163], v20 offset:16896
    ds_read_b64_tr_b16 a[164:165], v21 offset:16384
    ds_read_b64_tr_b16 a[166:167], v21 offset:16896
    ds_read_b64_tr_b16 a[168:169], v20 offset:20480
    ds_read_b64_tr_b16 a[170:171], v20 offset:20992
    ds_read_b64_tr_b16 a[172:173], v21 offset:20480
    ds_read_b64_tr_b16 a[174:175], v21 offset:20992
    ds_read_b64_tr_b16 a[176:177], v20 offset:24576
    ds_read_b64_tr_b16 a[178:179], v20 offset:25088
    ds_read_b64_tr_b16 a[180:181], v21 offset:24576
    ds_read_b64_tr_b16 a[182:183], v21 offset:25088
    ds_read_b64_tr_b16 a[184:185], v20 offset:28672
    ds_read_b64_tr_b16 a[186:187], v20 offset:29184
    ds_read_b64_tr_b16 a[188:189], v21 offset:28672
    ds_read_b64_tr_b16 a[190:191], v21 offset:29184
    s_waitcnt vmcnt(4) lgkmcnt(0)
    s_barrier
    ds_read_b64_tr_b16 a[192:193], v20 offset:32768
    ds_read_b64_tr_b16 a[194:195], v20 offset:33280
    ds_read_b64_tr_b16 a[196:197], v21 offset:32768
    ds_read_b64_tr_b16 a[198:199], v21 offset:33280
    ds_read_b64_tr_b16 a[200:201], v20 offset:36864
    ds_read_b64_tr_b16 a[202:203], v20 offset:37376
    ds_read_b64_tr_b16 a[204:205], v21 offset:36864
    ds_read_b64_tr_b16 a[206:207], v21 offset:37376
    ds_read_b64_tr_b16 a[208:209], v20 offset:40960
    ds_read_b64_tr_b16 a[210:211], v20 offset:41472
    ds_read_b64_tr_b16 a[212:213], v21 offset:40960
    ds_read_b64_tr_b16 a[214:215], v21 offset:41472
    ds_read_b64_tr_b16 a[216:217], v20 offset:45056
    ds_read_b64_tr_b16 a[218:219], v20 offset:45568
    ds_read_b64_tr_b16 a[220:221], v21 offset:45056
    ds_read_b64_tr_b16 a[222:223], v21 offset:45568
    s_waitcnt vmcnt(0) lgkmcnt(0)
    s_barrier
    ds_read_b64_tr_b16 a[224:225], v20 offset:49152
    ds_read_b64_tr_b16 a[226:227], v20 offset:49664
    ds_read_b64_tr_b16 a[228:229], v21 offset:49152
    ds_read_b64_tr_b16 a[230:231], v21 offset:49664
    ds_read_b64_tr_b16 a[232:233], v20 offset:53248
    ds_read_b64_tr_b16 a[234:235], v20 offset:53760
    ds_read_b64_tr_b16 a[236:237], v21 offset:53248
    ds_read_b64_tr_b16 a[238:239], v21 offset:53760
    ds_read_b64_tr_b16 a[240:241], v20 offset:57344
    ds_read_b64_tr_b16 a[242:243], v20 offset:57856
    ds_read_b64_tr_b16 a[244:245], v21 offset:57344
    ds_read_b64_tr_b16 a[246:247], v21 offset:57856
    ds_read_b64_tr_b16 a[248:249], v20 offset:61440
    ds_read_b64_tr_b16 a[250:251], v20 offset:61952
    ds_read_b64_tr_b16 a[252:253], v21 offset:61440
    ds_read_b64_tr_b16 a[254:255], v21 offset:61952
    s_waitcnt lgkmcnt(0)
    s_barrier
    v_mov_b32 v23, 163584
    s_cmp_eq_u32 s3, 0
    s_cbranch_scc0 L_nb_62
    s_mov_b64 exec, 1
    s_mov_b32 s22, 0
L_gn_64:
    buffer_load_dword v22, off, s[16:19], 0 offset:8 sc1
    s_add_u32 s22, s22, 1
    s_cmp_gt_u32 s22, 100000
    s_cbranch_scc1 L_fail
    s_waitcnt vmcnt(0)
    v_readfirstlane_b32 s7, v22
    s_nop 0
    s_cmp_lg_u32 s7, 0
    s_cbranch_scc1 L_go_65
    s_sleep 10
    s_branch L_gn_64
L_go_65:
L_nh_63:
    ds_write_b32 v23, v22
    s_mov_b64 exec, -1
    s_waitcnt lgkmcnt(0)
L_nb_62:
    s_barrier
    ds_read_b32 v22, v23
    s_waitcnt lgkmcnt(0)
    v_readfirstlane_b32 s7, v22
    s_cmp_eq_u32 s3, 0
    s_cbranch_scc0 L_wg_67
    s_mov_b32 s22, 0
    v_mbcnt_lo_u32_b32 v16, -1, 0
    v_mbcnt_hi_u32_b32 v16, -1, v16
    v_lshlrev_b32 v16, 2, v16
    v_and_b32 v17, 127, v16
L_wf_66:
    v_mov_b32 v18, s7
    v_mov_b32 v19, s7
    v_mov_b32 v20, s7
    s_mov_b32 s20, 0x11000
    s_mov_b64 exec, 0xffff
    buffer_load_dword v18, v16, s[8:11], s20 offen sc1
    s_mov_b64 exec, -1
    s_add_u32 s22, s22, 1
    s_cmp_gt_u32 s22, 100000
    s_cbranch_scc1 L_fail
    s_waitcnt vmcnt(0)
    v_bitop3_b32 v18, v18, v19, s7 bitop3:0x7e
    v_bitop3_b32 v18, v18, v20, s7 bitop3:0xf6
    v_cmp_ne_u32 vcc, 0, v18
    s_cbranch_vccz L_wh_68
    s_sleep 3
    s_branch L_wf_66
L_wh_68:
L_wg_67:
    s_barrier
    s_lshl_b32 s26, s4, 15
    s_add_u32 s26, s26, 0x2000000
    s_lshr_b32 s20, s3, 1
    s_lshl_b32 s20, s20, 12
    s_sub_u32 s21, s5, 1
    s_lshl_b32 s21, s21, 11
    s_add_u32 s30, s26, s21
    s_add_u32 s30, s30, s20
    s_and_b32 s21, s3, 1
    s_lshl_b32 s21, s21, 10
    s_add_u32 s30, s30, s21
    s_lshl_b32 s21, s5, 13
    s_add_u32 s26, s26, s21
    s_lshl_b32 s20, s20, 2
    v_add_u32 v15, s20, v6
    v_xor_b32 v7, 0x4000, v15
    s_sub_u32 s20, s5, 1
    s_lshl_b32 s20, s20, 4
    s_lshl_b32 s28, s4, 7
    s_add_u32 s28, s28, s20
    s_add_u32 s28, s28, 0x10000
    s_mov_b32 s29, 0x3e0293ee
    s_lshl_b32 s27, s3, 13
    s_add_u32 s27, s27, 0x200000
    s_lshl_b32 s24, s3, 13
    s_lshl_b32 s32, s4, 10
    s_lshl_b32 s20, s3, 15
    s_add_u32 s32, s32, s20
    s_add_u32 s32, s32, 0x200000
    buffer_load_dwordx4 v[40:43], v6, s[8:11], s32 offen sc1
    s_add_u32 s32, s32, 0x20000
    buffer_load_dwordx4 v[44:47], v6, s[8:11], s32 offen sc1
    s_add_u32 s32, s32, 0x20000
    s_waitcnt vmcnt(1)
    s_barrier
    s_add_u32 s20, s27, 4096
    s_add_u32 s21, s24, 4096
    s_mov_b32 m0, s24
    s_nop 0
    buffer_load_dwordx4 v6, s[8:11], s27 offen offset:0 sc1 lds
    buffer_load_dwordx4 v6, s[8:11], s27 offen offset:1024 sc1 lds
    buffer_load_dwordx4 v6, s[8:11], s27 offen offset:2048 sc1 lds
    buffer_load_dwordx4 v6, s[8:11], s27 offen offset:3072 sc1 lds
    s_mov_b32 m0, s21
    s_nop 0
    buffer_load_dwordx4 v6, s[8:11], s20 offen offset:0 sc1 lds
    buffer_load_dwordx4 v6, s[8:11], s20 offen offset:1024 sc1 lds
    buffer_load_dwordx4 v6, s[8:11], s20 offen offset:2048 sc1 lds
    buffer_load_dwordx4 v6, s[8:11], s20 offen offset:3072 sc1 lds
    s_add_u32 s27, s27, 0x8000
    s_add_u32 s24, s24, 0x8000
    s_and_b32 s24, s24, 0x1ffff
    s_add_u32 s20, s27, 4096
    s_add_u32 s21, s24, 4096
    s_mov_b32 m0, s24
    s_nop 0
    buffer_load_dwordx4 v6, s[8:11], s27 offen offset:0 sc1 lds
    buffer_load_dwordx4 v6, s[8:11], s27 offen offset:1024 sc1 lds
    buffer_load_dwordx4 v6, s[8:11], s27 offen offset:2048 sc1 lds
    buffer_load_dwordx4 v6, s[8:11], s27 offen offset:3072 sc1 lds
    s_mov_b32 m0, s21
    s_nop 0
    buffer_load_dwordx4 v6, s[8:11], s20 offen offset:0 sc1 lds
    buffer_load_dwordx4 v6, s[8:11], s20 offen offset:1024 sc1 lds
    buffer_load_dwordx4 v6, s[8:11], s20 offen offset:2048 sc1 lds
    buffer_load_dwordx4 v6, s[8:11], s20 offen offset:3072 sc1 lds
    s_add_u32 s27, s27, 0x8000
    s_add_u32 s24, s24, 0x8000
    s_and_b32 s24, s24, 0x1ffff
    s_add_u32 s20, s27, 4096
    s_add_u32 s21, s24, 4096
    s_mov_b32 m0, s24
    s_nop 0
    buffer_load_dwordx4 v6, s[8:11], s27 offen offset:0 sc1 lds
    buffer_load_dwordx4 v6, s[8:11], s27 offen offset:1024 sc1 lds
    buffer_load_dwordx4 v6, s[8:11], s27 offen offset:2048 sc1 lds
    buffer_load_dwordx4 v6, s[8:11], s27 offen offset:3072 sc1 lds
    s_mov_b32 m0, s21
    s_nop 0
    buffer_load_dwordx4 v6, s[8:11], s20 offen offset:0 sc1 lds
    buffer_load_dwordx4 v6, s[8:11], s20 offen offset:1024 sc1 lds
    buffer_load_dwordx4 v6, s[8:11], s20 offen offset:2048 sc1 lds
    buffer_load_dwordx4 v6, s[8:11], s20 offen offset:3072 sc1 lds
    s_add_u32 s27, s27, 0x8000
    s_add_u32 s24, s24, 0x8000
    s_and_b32 s24, s24, 0x1ffff
    s_mov_b32 s25, 0
    s_cmp_eq_u32 s5, 2
    s_cbranch_scc1 L_qv_69
    s_lshl_b32 s20, s3, 10
    s_add_u32 s26, s26, s20
    s_lshr_b32 s20, s3, 1
    s_lshl_b32 s20, s20, 12
    s_add_u32 s26, s26, s20
    s_xor_b32 s31, s26, 4096
    s_waitcnt vmcnt(16)
L_ql_70:
    s_barrier
    s_cmp_eq_u32 s3, 0
    s_cbranch_scc0 L_qnf_71
    s_cmp_lt_u32 s25, 4
    s_cbranch_scc1 L_qnf_71
    s_sub_u32 s20, s25, 1
    s_add_u32 s20, s20, s7
    v_mov_b32 v10, s20
    s_mov_b64 exec, 1
    buffer_store_dword v10, off, s[8:11], s28 sc1
    s_mov_b64 exec, -1
L_qnf_71:
    ds_read_b128 v[40:43], v15 offset:0
    ds_read_b128 v[44:47], v7 offset:0
    ds_read_b128 v[48:51], v15 offset:1024
    ds_read_b128 v[52:55], v7 offset:1024
    ds_read_b128 v[56:59], v15 offset:2048
    ds_read_b128 v[60:63], v7 offset:2048
    ds_read_b128 v[64:67], v15 offset:3072
    ds_read_b128 v[68:71], v7 offset:3072
    s_waitcnt lgkmcnt(7)
    v_mfma_f32_16x16x32_bf16 v[16:19], a[0:3], v[40:43], 0
    ds_read_b128 v[72:75], v15 offset:4096
    v_mfma_f32_16x16x32_bf16 v[20:23], a[4:7], v[40:43], 0
    v_mfma_f32_16x16x32_bf16 v[32:35], a[128:131], v[40:43], 0
    v_mfma_f32_16x16x32_bf16 v[36:39], a[132:135], v[40:43], 0
    s_waitcnt lgkmcnt(7)
    v_mfma_f32_16x16x32_bf16 v[24:27], a[0:3], v[44:47], 0
    ds_read_b128 v[76:79], v7 offset:4096
    v_mfma_f32_16x16x32_bf16 v[28:31], a[4:7], v[44:47], 0
    s_waitcnt lgkmcnt(7)
    v_mfma_f32_16x16x32_bf16 v[16:19], a[8:11], v[48:51], v[16:19]
    ds_read_b128 v[80:83], v15 offset:5120
    v_mfma_f32_16x16x32_bf16 v[20:23], a[12:15], v[48:51], v[20:23]
    v_mfma_f32_16x16x32_bf16 v[32:35], a[136:139], v[48:51], v[32:35]
    v_mfma_f32_16x16x32_bf16 v[36:39], a[140:143], v[48:51], v[36:39]
    s_mov_b32 m0, s24
    s_add_u32 s20, s27, 4096
    s_add_u32 s21, s24, 4096
    buffer_load_dwordx4 v6, s[8:11], s27 offen offset:0 sc1 lds
    s_waitcnt lgkmcnt(7)
    v_mfma_f32_16x16x32_bf16 v[24:27], a[8:11], v[52:55], v[24:27]
    ds_read_b128 v[84:87], v7 offset:5120
    v_mfma_f32_16x16x32_bf16 v[28:31], a[12:15], v[52:55], v[28:31]
    s_waitcnt lgkmcnt(7)
    v_mfma_f32_16x16x32_bf16 v[16:19], a[16:19], v[56:59], v[16:19]
    ds_read_b128 v[88:91], v15 offset:6144
    v_mfma_f32_16x16x32_bf16 v[20:23], a[20:23], v[56:59], v[20:23]
    v_mfma_f32_16x16x32_bf16 v[32:35], a[144:147], v[56:59], v[32:35]
    v_mfma_f32_16x16x32_bf16 v[36:39], a[148:151], v[56:59], v[36:39]
    s_waitcnt lgkmcnt(7)
    v_mfma_f32_16x16x32_bf16 v[24:27], a[16:19], v[60:63], v[24:27]
    ds_read_b128 v[92:95], v7 offset:6144
    v_mfma_f32_16x16x32_bf16 v[28:31], a[20:23], v[60:63], v[28:31]
    buffer_load_dwordx4 v6, s[8:11], s27 offen offset:1024 sc1 lds
    s_waitcnt lgkmcnt(7)
    v_mfma_f32_16x16x32_bf16 v[16:19], a[24:27], v[64:67], v[16:19]
    ds_read_b128 v[96:99], v15 offset:7168
    v_mfma_f32_16x16x32_bf16 v[20:23], a[28:31], v[64:67], v[20:23]
    v_mfma_f32_16x16x32_bf16 v[32:35], a[152:155], v[64:67], v[32:35]
    v_mfma_f32_16x16x32_bf16 v[36:39], a[156:159], v[64:67], v[36:39]
    s_waitcnt lgkmcnt(7)
    v_mfma_f32_16x16x32_bf16 v[24:27], a[24:27], v[68:71], v[24:27]
    ds_read_b128 v[100:103], v7 offset:7168
    v_mfma_f32_16x16x32_bf16 v[28:31], a[28:31], v[68:71], v[28:31]
    s_waitcnt lgkmcnt(7)
    v_mfma_f32_16x16x32_bf16 v[16:19], a[32:35], v[72:75], v[16:19]
    ds_read_b128 v[40:43], v15 offset:8192
    v_mfma_f32_16x16x32_bf16 v[20:23], a[36:39], v[72:75], v[20:23]
    v_mfma_f32_16x16x32_bf16 v[32:35], a[160:163], v[72:75], v[32:35]
    v_mfma_f32_16x16x32_bf16 v[36:39], a[164:167], v[72:75], v[36:39]
    buffer_load_dwordx4 v6, s[8:11], s27 offen offset:2048 sc1 lds
    s_waitcnt lgkmcnt(7)
    v_mfma_f32_16x16x32_bf16 v[24:27], a[32:35], v[76:79], v[24:27]
    ds_read_b128 v[44:47], v7 offset:8192
    v_mfma_f32_16x16x32_bf16 v[28:31], a[36:39], v[76:79], v[28:31]
    s_waitcnt lgkmcnt(7)
    v_mfma_f32_16x16x32_bf16 v[16:19], a[40:43], v[80:83], v[16:19]
    ds_read_b128 v[48:51], v15 offset:9216
    v_mfma_f32_16x16x32_bf16 v[20:23], a[44:47], v[80:83], v[20:23]
    v_mfma_f32_16x16x32_bf16 v[32:35], a[168:171], v[80:83], v[32:35]
    v_mfma_f32_16x16x32_bf16 v[36:39], a[172:175], v[80:83], v[36:39]
    s_waitcnt lgkmcnt(7)
    v_mfma_f32_16x16x32_bf16 v[24:27], a[40:43], v[84:87], v[24:27]
    ds_read_b128 v[52:55], v7 offset:9216
    v_mfma_f32_16x16x32_bf16 v[28:31], a[44:47], v[84:87], v[28:31]
    buffer_load_dwordx4 v6, s[8:11], s27 offen offset:3072 sc1 lds
    s_waitcnt lgkmcnt(7)
    v_mfma_f32_16x16x32_bf16 v[16:19], a[48:51], v[88:91], v[16:19]
    ds_read_b128 v[56:59], v15 offset:10240
    v_mfma_f32_16x16x32_bf16 v[20:23], a[52:55], v[88:91], v[20:23]
    v_mfma_f32_16x16x32_bf16 v[32:35], a[176:179], v[88:91], v[32:35]
    v_mfma_f32_16x16x32_bf16 v[36:39], a[180:183], v[88:91], v[36:39]
    s_waitcnt lgkmcnt(7)
    v_mfma_f32_16x16x32_bf16 v[24:27], a[48:51], v[92:95], v[24:27]
    ds_read_b128 v[60:63], v7 offset:10240
    v_mfma_f32_16x16x32_bf16 v[28:31], a[52:55], v[92:95], v[28:31]
    s_waitcnt lgkmcnt(7)
    v_mfma_f32_16x16x32_bf16 v[16:19], a[56:59], v[96:99], v[16:19]
    ds_read_b128 v[64:67], v15 offset:11264
    v_mfma_f32_16x16x32_bf16 v[20:23], a[60:63], v[96:99], v[20:23]
    v_mfma_f32_16x16x32_bf16 v[32:35], a[184:187], v[96:99], v[32:35]
    v_mfma_f32_16x16x32_bf16 v[36:39], a[188:191], v[96:99], v[36:39]
    s_mov_b32 m0, s21
    s_nop 0
    buffer_load_dwordx4 v6, s[8:11], s20 offen offset:0 sc1 lds
    s_waitcnt lgkmcnt(7)
    v_mfma_f32_16x16x32_bf16 v[24:27], a[56:59], v[100:103], v[24:27]
    ds_read_b128 v[68:71], v7 offset:11264
    v_mfma_f32_16x16x32_bf16 v[28:31], a[60:63], v[100:103], v[28:31]
    s_waitcnt lgkmcnt(7)
    v_mfma_f32_16x16x32_bf16 v[16:19], a[64:67], v[40:43], v[16:19]
    ds_read_b128 v[72:75], v15 offset:12288
    v_mfma_f32_16x16x32_bf16 v[20:23], a[68:71], v[40:43], v[20:23]
    v_mfma_f32_16x16x32_bf16 v[32:35], a[192:195], v[40:43], v[32:35]
    v_mfma_f32_16x16x32_bf16 v[36:39], a[196:199], v[40:43], v[36:39]
    s_waitcnt lgkmcnt(7)
    v_mfma_f32_16x16x32_bf16 v[24:27], a[64:67], v[44:47], v[24:27]
    ds_read_b128 v[76:79], v7 offset:12288
    v_mfma_f32_16x16x32_bf16 v[28:31], a[68:71], v[44:47], v[28:31]
    buffer_load_dwordx4 v6, s[8:11], s20 offen offset:1024 sc1 lds
    s_waitcnt lgkmcnt(7)
    v_mfma_f32_16x16x32_bf16 v[16:19], a[72:75], v[48:51], v[16:19]
    ds_read_b128 v[80:83], v15 offset:13312
    v_mfma_f32_16x16x32_bf16 v[20:23], a[76:79], v[48:51], v[20:23]
    v_mfma_f32_16x16x32_bf16 v[32:35], a[200:203], v[48:51], v[32:35]
    v_mfma_f32_16x16x32_bf16 v[36:39], a[204:207], v[48:51], v[36:39]
    s_waitcnt lgkmcnt(7)
    v_mfma_f32_16x16x32_bf16 v[24:27], a[72:75], v[52:55], v[24:27]
    ds_read_b128 v[84:87], v7 offset:13312
    v_mfma_f32_16x16x32_bf16 v[28:31], a[76:79], v[52:55], v[28:31]
    s_waitcnt lgkmcnt(7)
    v_mfma_f32_16x16x32_bf16 v[16:19], a[80:83], v[56:59], v[16:19]
    ds_read_b128 v[88:91], v15 offset:14336
    v_mfma_f32_16x16x32_bf16 v[20:23], a[84:87], v[56:59], v[20:23]
    v_mfma_f32_16x16x32_bf16 v[32:35], a[208:211], v[56:59], v[32:35]
    v_mfma_f32_16x16x32_bf16 v[36:39], a[212:215], v[56:59], v[36:39]
    buffer_load_dwordx4 v6, s[8:11], s20 offen offset:2048 sc1 lds
    s_waitcnt lgkmcnt(7)
    v_mfma_f32_16x16x32_bf16 v[24:27], a[80:83], v[60:63], v[24:27]
    ds_read_b128 v[92:95], v7 offset:14336
    v_mfma_f32_16x16x32_bf16 v[28:31], a[84:87], v[60:63], v[28:31]
    s_waitcnt lgkmcnt(7)
    v_mfma_f32_16x16x32_bf16 v[16:19], a[88:91], v[64:67], v[16:19]
    ds_read_b128 v[96:99], v15 offset:15360
    v_mfma_f32_16x16x32_bf16 v[20:23], a[92:95], v[64:67], v[20:23]
    v_mfma_f32_16x16x32_bf16 v[32:35], a[216:219], v[64:67], v[32:35]
    v_mfma_f32_16x16x32_bf16 v[36:39], a[220:223], v[64:67], v[36:39]
    s_waitcnt lgkmcnt(7)
    v_mfma_f32_16x16x32_bf16 v[24:27], a[88:91], v[68:71], v[24:27]
    ds_read_b128 v[100:103], v7 offset:15360
    v_mfma_f32_16x16x32_bf16 v[28:31], a[92:95], v[68:71], v[28:31]
    buffer_load_dwordx4 v6, s[8:11], s20 offen offset:3072 sc1 lds
    s_waitcnt lgkmcnt(7)
    v_mfma_f32_16x16x32_bf16 v[16:19], a[96:99], v[72:75], v[16:19]
    v_mfma_f32_16x16x32_bf16 v[20:23], a[100:103], v[72:75], v[20:23]
    v_mfma_f32_16x16x32_bf16 v[32:35], a[224:227], v[72:75], v[32:35]
    v_mfma_f32_16x16x32_bf16 v[36:39], a[228:231], v[72:75], v[36:39]
    s_waitcnt lgkmcnt(6)
    v_mfma_f32_16x16x32_bf16 v[24:27], a[96:99], v[76:79], v[24:27]
    v_mfma_f32_16x16x32_bf16 v[28:31], a[100:103], v[76:79], v[28:31]
    s_waitcnt lgkmcnt(5)
    v_mfma_f32_16x16x32_bf16 v[16:19], a[104:107], v[80:83], v[16:19]
    v_mfma_f32_16x16x32_bf16 v[20:23], a[108:111], v[80:83], v[20:23]
    v_mfma_f32_16x16x32_bf16 v[32:35], a[232:235], v[80:83], v[32:35]
    v_mfma_f32_16x16x32_bf16 v[36:39], a[236:239], v[80:83], v[36:39]
    s_waitcnt lgkmcnt(4)
    v_mfma_f32_16x16x32_bf16 v[24:27], a[104:107], v[84:87], v[24:27]
    v_mfma_f32_16x16x32_bf16 v[28:31], a[108:111], v[84:87], v[28:31]
    s_add_u32 s27, s27, 0x8000
    s_add_u32 s24, s24, 0x8000
    s_and_b32 s24, s24, 0x1ffff
    s_waitcnt lgkmcnt(3)
    v_mfma_f32_16x16x32_bf16 v[16:19], a[112:115], v[88:91], v[16:19]
    v_mfma_f32_16x16x32_bf16 v[20:23], a[116:119], v[88:91], v[20:23]
    v_mfma_f32_16x16x32_bf16 v[32:35], a[240:243], v[88:91], v[32:35]
    v_mfma_f32_16x16x32_bf16 v[36:39], a[244:247], v[88:91], v[36:39]
    s_waitcnt lgkmcnt(2)
    v_mfma_f32_16x16x32_bf16 v[24:27], a[112:115], v[92:95], v[24:27]
    v_mfma_f32_16x16x32_bf16 v[28:31], a[116:119], v[92:95], v[28:31]
    s_waitcnt lgkmcnt(1)
    v_mfma_f32_16x16x32_bf16 v[16:19], a[120:123], v[96:99], v[16:19]
    v_mfma_f32_16x16x32_bf16 v[20:23], a[124:127], v[96:99], v[20:23]
    v_mfma_f32_16x16x32_bf16 v[32:35], a[248:251], v[96:99], v[32:35]
    v_mfma_f32_16x16x32_bf16 v[36:39], a[252:255], v[96:99], v[36:39]
    s_waitcnt lgkmcnt(0)
    v_mfma_f32_16x16x32_bf16 v[24:27], a[120:123], v[100:103], v[24:27]
    v_mfma_f32_16x16x32_bf16 v[28:31], a[124:127], v[100:103], v[28:31]
    s_and_b32 s20, s25, 3
    s_cmp_eq_u32 s20, 2
    s_cbranch_scc0 L_qt_72
    buffer_load_dwordx4 v[116:119], v6, s[8:11], s32 offen sc1
    s_add_u32 s32, s32, 0x20000
L_qt_72:
    v_add_u32 v15, 0x8000, v15
    v_and_b32 v15, 0x1ffff, v15
    v_xor_b32 v7, 0x4000, v15
    v_cvt_pk_bf16_f32 v112, v32, v33
    v_cvt_pk_bf16_f32 v113, v34, v35
    v_cvt_pk_bf16_f32 v114, v36, v37
    v_cvt_pk_bf16_f32 v115, v38, v39
    buffer_store_dwordx4 v[112:115], v6, s[8:11], s30 offen sc1
    v_mul_f32 v16, s29, v16
    v_mul_f32 v17, s29, v17
    v_mul_f32 v18, s29, v18
    v_mul_f32 v19, s29, v19
    v_mul_f32 v20, s29, v20
    v_mul_f32 v21, s29, v21
    v_mul_f32 v22, s29, v22
    v_mul_f32 v23, s29, v23
    v_mul_f32 v24, s29, v24
    v_mul_f32 v25, s29, v25
    v_mul_f32 v26, s29, v26
    v_mul_f32 v27, s29, v27
    v_mul_f32 v28, s29, v28
    v_mul_f32 v29, s29, v29
    v_mul_f32 v30, s29, v30
    v_mul_f32 v31, s29, v31
    v_cvt_pk_bf16_f32 v104, v16, v17
    v_cvt_pk_bf16_f32 v105, v18, v19
    v_cvt_pk_bf16_f32 v106, v20, v21
    v_cvt_pk_bf16_f32 v107, v22, v23
    v_cvt_pk_bf16_f32 v108, v24, v25
    v_cvt_pk_bf16_f32 v109, v26, v27
    v_cvt_pk_bf16_f32 v110, v28, v29
    v_cvt_pk_bf16_f32 v111, v30, v31
    buffer_store_dwordx4 v[104:107], v6, s[8:11], s26 offen sc1
    buffer_store_dwordx4 v[108:111], v6, s[8:11], s31 offen sc1
    s_add_u32 s26, s26, 0x100000
    s_add_u32 s31, s31, 0x100000
    s_add_u32 s30, s30, 0x100000
    s_add_u32 s25, s25, 1
    s_cmp_gt_u32 s25, 2
    s_cbranch_scc1 L_qg_73
    s_waitcnt vmcnt(0)
    s_barrier
    s_add_u32 s20, s7, s25
    s_cmp_eq_u32 s3, 0
    s_cbranch_scc0 L_sf_75
    v_mov_b32 v10, s20
    s_mov_b64 exec, 1
    buffer_store_dword v10, off, s[8:11], s28 sc1
    s_mov_b64 exec, -1
L_sf_75:
    s_cmp_eq_u32 s25, 2
    s_cbranch_scc0 L_qg_73
    s_cmp_eq_u32 s3, 0
    s_cbranch_scc0 L_wg_77
    s_mov_b32 s22, 0
    v_mbcnt_lo_u32_b32 v120, -1, 0
    v_mbcnt_hi_u32_b32 v120, -1, v120
    v_lshlrev_b32 v120, 2, v120
    v_and_b32 v121, 127, v120
L_wf_76:
    v_mov_b32 v122, s7
    v_mov_b32 v123, s7
    v_mov_b32 v124, s7
    s_mov_b32 s20, 0x11000
    buffer_load_dword v122, v120, s[8:11], s20 offen sc1
    buffer_load_dword v123, v120, s[8:11], s20 offen offset:256 sc1
    s_add_u32 s22, s22, 1
    s_cmp_gt_u32 s22, 100000
    s_cbranch_scc1 L_fail
    s_waitcnt vmcnt(0)
    v_bitop3_b32 v122, v122, v123, s7 bitop3:0x7e
    v_bitop3_b32 v122, v122, v124, s7 bitop3:0xf6
    v_cmp_ne_u32 vcc, 0, v122
    s_cbranch_vccz L_wh_78
    s_sleep 6
    s_branch L_wf_76
L_wh_78:
L_wg_77:
    s_barrier
L_qg_73:
    s_cmp_lt_u32 s25, 64
    s_waitcnt vmcnt(11)
    s_cbranch_scc1 L_ql_70
    s_waitcnt vmcnt(0)
    s_barrier
    s_add_u32 s20, s7, 64
    s_cmp_eq_u32 s3, 0
    s_cbranch_scc0 L_sf_79
    v_mov_b32 v10, s20
    s_mov_b64 exec, 1
    buffer_store_dword v10, off, s[8:11], s28 sc1
    s_mov_b64 exec, -1
L_sf_79:
    s_branch L_done
L_qv_69:
    s_lshl_b32 s20, s3, 11
    s_add_u32 s26, s26, s20
    s_add_u32 s31, s26, 1024
    s_waitcnt vmcnt(16)
L_ql_80:
    s_barrier
    s_cmp_eq_u32 s3, 0
    s_cbranch_scc0 L_qnf_81
    s_cmp_lt_u32 s25, 4
    s_cbranch_scc1 L_qnf_81
    s_sub_u32 s20, s25, 1
    s_add_u32 s20, s20, s7
    v_mov_b32 v10, s20
    s_mov_b64 exec, 1
    buffer_store_dword v10, off, s[8:11], s28 sc1
    s_mov_b64 exec, -1
L_qnf_81:
    ds_read_b128 v[40:43], v15 offset:0
    ds_read_b128 v[44:47], v7 offset:0
    ds_read_b128 v[48:51], v15 offset:1024
    ds_read_b128 v[52:55], v7 offset:1024
    ds_read_b128 v[56:59], v15 offset:2048
    ds_read_b128 v[60:63], v7 offset:2048
    ds_read_b128 v[64:67], v15 offset:3072
    ds_read_b128 v[68:71], v7 offset:3072
    s_waitcnt lgkmcnt(7)
    v_mfma_f32_16x16x32_bf16 v[16:19], v[40:43], a[0:3], 0
    ds_read_b128 v[72:75], v15 offset:4096
    v_mfma_f32_16x16x32_bf16 v[24:27], v[40:43], a[4:7], 0
    v_mfma_f32_16x16x32_bf16 v[32:35], a[128:131], v[40:43], 0
    v_mfma_f32_16x16x32_bf16 v[36:39], a[132:135], v[40:43], 0
    s_waitcnt lgkmcnt(7)
    v_mfma_f32_16x16x32_bf16 v[20:23], v[44:47], a[0:3], 0
    ds_read_b128 v[76:79], v7 offset:4096
    v_mfma_f32_16x16x32_bf16 v[28:31], v[44:47], a[4:7], 0
    s_waitcnt lgkmcnt(7)
    v_mfma_f32_16x16x32_bf16 v[16:19], v[48:51], a[8:11], v[16:19]
    ds_read_b128 v[80:83], v15 offset:5120
    v_mfma_f32_16x16x32_bf16 v[24:27], v[48:51], a[12:15], v[24:27]
    v_mfma_f32_16x16x32_bf16 v[32:35], a[136:139], v[48:51], v[32:35]
    v_mfma_f32_16x16x32_bf16 v[36:39], a[140:143], v[48:51], v[36:39]
    s_mov_b32 m0, s24
    s_add_u32 s20, s27, 4096
    s_add_u32 s21, s24, 4096
    buffer_load_dwordx4 v6, s[8:11], s27 offen offset:0 sc1 lds
    s_waitcnt lgkmcnt(7)
    v_mfma_f32_16x16x32_bf16 v[20:23], v[52:55], a[8:11], v[20:23]
    ds_read_b128 v[84:87], v7 offset:5120
    v_mfma_f32_16x16x32_bf16 v[28:31], v[52:55], a[12:15], v[28:31]
    s_waitcnt lgkmcnt(7)
    v_mfma_f32_16x16x32_bf16 v[16:19], v[56:59], a[16:19], v[16:19]
    ds_read_b128 v[88:91], v15 offset:6144
    v_mfma_f32_16x16x32_bf16 v[24:27], v[56:59], a[20:23], v[24:27]
    v_mfma_f32_16x16x32_bf16 v[32:35], a[144:147], v[56:59], v[32:35]
    v_mfma_f32_16x16x32_bf16 v[36:39], a[148:151], v[56:59], v[36:39]
    s_waitcnt lgkmcnt(7)
    v_mfma_f32_16x16x32_bf16 v[20:23], v[60:63], a[16:19], v[20:23]
    ds_read_b128 v[92:95], v7 offset:6144
    v_mfma_f32_16x16x32_bf16 v[28:31], v[60:63], a[20:23], v[28:31]
    buffer_load_dwordx4 v6, s[8:11], s27 offen offset:1024 sc1 lds
    s_waitcnt lgkmcnt(7)
    v_mfma_f32_16x16x32_bf16 v[16:19], v[64:67], a[24:27], v[16:19]
    ds_read_b128 v[96:99], v15 offset:7168
    v_mfma_f32_16x16x32_bf16 v[24:27], v[64:67], a[28:31], v[24:27]
    v_mfma_f32_16x16x32_bf16 v[32:35], a[152:155], v[64:67], v[32:35]
    v_mfma_f32_16x16x32_bf16 v[36:39], a[156:159], v[64:67], v[36:39]
    s_waitcnt lgkmcnt(7)
    v_mfma_f32_16x16x32_bf16 v[20:23], v[68:71], a[24:27], v[20:23]
    ds_read_b128 v[100:103], v7 offset:7168
    v_mfma_f32_16x16x32_bf16 v[28:31], v[68:71], a[28:31], v[28:31]
    s_waitcnt lgkmcnt(7)
    v_mfma_f32_16x16x32_bf16 v[16:19], v[72:75], a[32:35], v[16:19]
    ds_read_b128 v[40:43], v15 offset:8192
    v_mfma_f32_16x16x32_bf16 v[24:27], v[72:75], a[36:39], v[24:27]
    v_mfma_f32_16x16x32_bf16 v[32:35], a[160:163], v[72:75], v[32:35]
    v_mfma_f32_16x16x32_bf16 v[36:39], a[164:167], v[72:75], v[36:39]
    buffer_load_dwordx4 v6, s[8:11], s27 offen offset:2048 sc1 lds
    s_waitcnt lgkmcnt(7)
    v_mfma_f32_16x16x32_bf16 v[20:23], v[76:79], a[32:35], v[20:23]
    ds_read_b128 v[44:47], v7 offset:8192
    v_mfma_f32_16x16x32_bf16 v[28:31], v[76:79], a[36:39], v[28:31]
    s_waitcnt lgkmcnt(7)
    v_mfma_f32_16x16x32_bf16 v[16:19], v[80:83], a[40:43], v[16:19]
    ds_read_b128 v[48:51], v15 offset:9216
    v_mfma_f32_16x16x32_bf16 v[24:27], v[80:83], a[44:47], v[24:27]
    v_mfma_f32_16x16x32_bf16 v[32:35], a[168:171], v[80:83], v[32:35]
    v_mfma_f32_16x16x32_bf16 v[36:39], a[172:175], v[80:83], v[36:39]
    s_waitcnt lgkmcnt(7)
    v_mfma_f32_16x16x32_bf16 v[20:23], v[84:87], a[40:43], v[20:23]
    ds_read_b128 v[52:55], v7 offset:9216
    v_mfma_f32_16x16x32_bf16 v[28:31], v[84:87], a[44:47], v[28:31]
    buffer_load_dwordx4 v6, s[8:11], s27 offen offset:3072 sc1 lds
    s_waitcnt lgkmcnt(7)
    v_mfma_f32_16x16x32_bf16 v[16:19], v[88:91], a[48:51], v[16:19]
    ds_read_b128 v[56:59], v15 offset:10240
    v_mfma_f32_16x16x32_bf16 v[24:27], v[88:91], a[52:55], v[24:27]
    v_mfma_f32_16x16x32_bf16 v[32:35], a[176:179], v[88:91], v[32:35]
    v_mfma_f32_16x16x32_bf16 v[36:39], a[180:183], v[88:91], v[36:39]
    s_waitcnt lgkmcnt(7)
    v_mfma_f32_16x16x32_bf16 v[20:23], v[92:95], a[48:51], v[20:23]
    ds_read_b128 v[60:63], v7 offset:10240
    v_mfma_f32_16x16x32_bf16 v[28:31], v[92:95], a[52:55], v[28:31]
    s_waitcnt lgkmcnt(7)
    v_mfma_f32_16x16x32_bf16 v[16:19], v[96:99], a[56:59], v[16:19]
    ds_read_b128 v[64:67], v15 offset:11264
    v_mfma_f32_16x16x32_bf16 v[24:27], v[96:99], a[60:63], v[24:27]
    v_mfma_f32_16x16x32_bf16 v[32:35], a[184:187], v[96:99], v[32:35]
    v_mfma_f32_16x16x32_bf16 v[36:39], a[188:191], v[96:99], v[36:39]
    s_mov_b32 m0, s21
    s_nop 0
    buffer_load_dwordx4 v6, s[8:11], s20 offen offset:0 sc1 lds
    s_waitcnt lgkmcnt(7)
    v_mfma_f32_16x16x32_bf16 v[20:23], v[100:103], a[56:59], v[20:23]
    ds_read_b128 v[68:71], v7 offset:11264
    v_mfma_f32_16x16x32_bf16 v[28:31], v[100:103], a[60:63], v[28:31]
    s_waitcnt lgkmcnt(7)
    v_mfma_f32_16x16x32_bf16 v[16:19], v[40:43], a[64:67], v[16:19]
    ds_read_b128 v[72:75], v15 offset:12288
    v_mfma_f32_16x16x32_bf16 v[24:27], v[40:43], a[68:71], v[24:27]
    v_mfma_f32_16x16x32_bf16 v[32:35], a[192:195], v[40:43], v[32:35]
    v_mfma_f32_16x16x32_bf16 v[36:39], a[196:199], v[40:43], v[36:39]
    s_waitcnt lgkmcnt(7)
    v_mfma_f32_16x16x32_bf16 v[20:23], v[44:47], a[64:67], v[20:23]
    ds_read_b128 v[76:79], v7 offset:12288
    v_mfma_f32_16x16x32_bf16 v[28:31], v[44:47], a[68:71], v[28:31]
    buffer_load_dwordx4 v6, s[8:11], s20 offen offset:1024 sc1 lds
    s_waitcnt lgkmcnt(7)
    v_mfma_f32_16x16x32_bf16 v[16:19], v[48:51], a[72:75], v[16:19]
    ds_read_b128 v[80:83], v15 offset:13312
    v_mfma_f32_16x16x32_bf16 v[24:27], v[48:51], a[76:79], v[24:27]
    v_mfma_f32_16x16x32_bf16 v[32:35], a[200:203], v[48:51], v[32:35]
    v_mfma_f32_16x16x32_bf16 v[36:39], a[204:207], v[48:51], v[36:39]
    s_waitcnt lgkmcnt(7)
    v_mfma_f32_16x16x32_bf16 v[20:23], v[52:55], a[72:75], v[20:23]
    ds_read_b128 v[84:87], v7 offset:13312
    v_mfma_f32_16x16x32_bf16 v[28:31], v[52:55], a[76:79], v[28:31]
    s_waitcnt lgkmcnt(7)
    v_mfma_f32_16x16x32_bf16 v[16:19], v[56:59], a[80:83], v[16:19]
    ds_read_b128 v[88:91], v15 offset:14336
    v_mfma_f32_16x16x32_bf16 v[24:27], v[56:59], a[84:87], v[24:27]
    v_mfma_f32_16x16x32_bf16 v[32:35], a[208:211], v[56:59], v[32:35]
    v_mfma_f32_16x16x32_bf16 v[36:39], a[212:215], v[56:59], v[36:39]
    buffer_load_dwordx4 v6, s[8:11], s20 offen offset:2048 sc1 lds
    s_waitcnt lgkmcnt(7)
    v_mfma_f32_16x16x32_bf16 v[20:23], v[60:63], a[80:83], v[20:23]
    ds_read_b128 v[92:95], v7 offset:14336
    v_mfma_f32_16x16x32_bf16 v[28:31], v[60:63], a[84:87], v[28:31]
    s_waitcnt lgkmcnt(7)
    v_mfma_f32_16x16x32_bf16 v[16:19], v[64:67], a[88:91], v[16:19]
    ds_read_b128 v[96:99], v15 offset:15360
    v_mfma_f32_16x16x32_bf16 v[24:27], v[64:67], a[92:95], v[24:27]
    v_mfma_f32_16x16x32_bf16 v[32:35], a[216:219], v[64:67], v[32:35]
    v_mfma_f32_16x16x32_bf16 v[36:39], a[220:223], v[64:67], v[36:39]
    s_waitcnt lgkmcnt(7)
    v_mfma_f32_16x16x32_bf16 v[20:23], v[68:71], a[88:91], v[20:23]
    ds_read_b128 v[100:103], v7 offset:15360
    v_mfma_f32_16x16x32_bf16 v[28:31], v[68:71], a[92:95], v[28:31]
    buffer_load_dwordx4 v6, s[8:11], s20 offen offset:3072 sc1 lds
    s_waitcnt lgkmcnt(7)
    v_mfma_f32_16x16x32_bf16 v[16:19], v[72:75], a[96:99], v[16:19]
    v_mfma_f32_16x16x32_bf16 v[24:27], v[72:75], a[100:103], v[24:27]
    v_mfma_f32_16x16x32_bf16 v[32:35], a[224:227], v[72:75], v[32:35]
    v_mfma_f32_16x16x32_bf16 v[36:39], a[228:231], v[72:75], v[36:39]
    s_waitcnt lgkmcnt(6)
    v_mfma_f32_16x16x32_bf16 v[20:23], v[76:79], a[96:99], v[20:23]
    v_mfma_f32_16x16x32_bf16 v[28:31], v[76:79], a[100:103], v[28:31]
    s_waitcnt lgkmcnt(5)
    v_mfma_f32_16x16x32_bf16 v[16:19], v[80:83], a[104:107], v[16:19]
    v_mfma_f32_16x16x32_bf16 v[24:27], v[80:83], a[108:111], v[24:27]
    v_mfma_f32_16x16x32_bf16 v[32:35], a[232:235], v[80:83], v[32:35]
    v_mfma_f32_16x16x32_bf16 v[36:39], a[236:239], v[80:83], v[36:39]
    s_waitcnt lgkmcnt(4)
    v_mfma_f32_16x16x32_bf16 v[20:23], v[84:87], a[104:107], v[20:23]
    v_mfma_f32_16x16x32_bf16 v[28:31], v[84:87], a[108:111], v[28:31]
    s_add_u32 s27, s27, 0x8000
    s_add_u32 s24, s24, 0x8000
    s_and_b32 s24, s24, 0x1ffff
    s_waitcnt lgkmcnt(3)
    v_mfma_f32_16x16x32_bf16 v[16:19], v[88:91], a[112:115], v[16:19]
    v_mfma_f32_16x16x32_bf16 v[24:27], v[88:91], a[116:119], v[24:27]
    v_mfma_f32_16x16x32_bf16 v[32:35], a[240:243], v[88:91], v[32:35]
    v_mfma_f32_16x16x32_bf16 v[36:39], a[244:247], v[88:91], v[36:39]
    s_waitcnt lgkmcnt(2)
    v_mfma_f32_16x16x32_bf16 v[20:23], v[92:95], a[112:115], v[20:23]
    v_mfma_f32_16x16x32_bf16 v[28:31], v[92:95], a[116:119], v[28:31]
    s_waitcnt lgkmcnt(1)
    v_mfma_f32_16x16x32_bf16 v[16:19], v[96:99], a[120:123], v[16:19]
    v_mfma_f32_16x16x32_bf16 v[24:27], v[96:99], a[124:127], v[24:27]
    v_mfma_f32_16x16x32_bf16 v[32:35], a[248:251], v[96:99], v[32:35]
    v_mfma_f32_16x16x32_bf16 v[36:39], a[252:255], v[96:99], v[36:39]
    s_waitcnt lgkmcnt(0)
    v_mfma_f32_16x16x32_bf16 v[20:23], v[100:103], a[120:123], v[20:23]
    v_mfma_f32_16x16x32_bf16 v[28:31], v[100:103], a[124:127], v[28:31]
    s_and_b32 s20, s25, 3
    s_cmp_eq_u32 s20, 2
    s_cbranch_scc0 L_qt_82
    buffer_load_dwordx4 v[116:119], v6, s[8:11], s32 offen sc1
    s_add_u32 s32, s32, 0x20000
L_qt_82:
    v_add_u32 v15, 0x8000, v15
    v_and_b32 v15, 0x1ffff, v15
    v_xor_b32 v7, 0x4000, v15
    v_cvt_pk_bf16_f32 v112, v32, v33
    v_cvt_pk_bf16_f32 v113, v34, v35
    v_cvt_pk_bf16_f32 v114, v36, v37
    v_cvt_pk_bf16_f32 v115, v38, v39
    buffer_store_dwordx4 v[112:115], v6, s[8:11], s30 offen sc1
    v_cvt_pk_bf16_f32 v104, v16, v17
    v_cvt_pk_bf16_f32 v105, v18, v19
    v_cvt_pk_bf16_f32 v106, v20, v21
    v_cvt_pk_bf16_f32 v107, v22, v23
    v_cvt_pk_bf16_f32 v108, v24, v25
    v_cvt_pk_bf16_f32 v109, v26, v27
    v_cvt_pk_bf16_f32 v110, v28, v29
    v_cvt_pk_bf16_f32 v111, v30, v31
    s_cmp_lt_u32 s3, 2
    s_cbranch_scc1 L_qs_83
    v_swap_b32 v104, v106
    v_swap_b32 v105, v107
    v_swap_b32 v108, v110
    v_swap_b32 v109, v111
L_qs_83:
    buffer_store_dwordx4 v[104:107], v6, s[8:11], s26 offen sc1
    buffer_store_dwordx4 v[108:111], v6, s[8:11], s31 offen sc1
    s_add_u32 s26, s26, 0x100000
    s_add_u32 s31, s31, 0x100000
    s_add_u32 s30, s30, 0x100000
    s_add_u32 s25, s25, 1
    s_cmp_gt_u32 s25, 2
    s_cbranch_scc1 L_qg_84
    s_waitcnt vmcnt(0)
    s_barrier
    s_add_u32 s20, s7, s25
    s_cmp_eq_u32 s3, 0
    s_cbranch_scc0 L_sf_86
    v_mov_b32 v10, s20
    s_mov_b64 exec, 1
    buffer_store_dword v10, off, s[8:11], s28 sc1
    s_mov_b64 exec, -1
L_sf_86:
    s_cmp_eq_u32 s25, 2
    s_cbranch_scc0 L_qg_84
    s_cmp_eq_u32 s3, 0
    s_cbranch_scc0 L_wg_88
    s_mov_b32 s22, 0
    v_mbcnt_lo_u32_b32 v120, -1, 0
    v_mbcnt_hi_u32_b32 v120, -1, v120
    v_lshlrev_b32 v120, 2, v120
    v_and_b32 v121, 127, v120
L_wf_87:
    v_mov_b32 v122, s7
    v_mov_b32 v123, s7
    v_mov_b32 v124, s7
    s_mov_b32 s20, 0x11000
    buffer_load_dword v122, v120, s[8:11], s20 offen sc1
    buffer_load_dword v123, v120, s[8:11], s20 offen offset:256 sc1
    s_add_u32 s22, s22, 1
    s_cmp_gt_u32 s22, 100000
    s_cbranch_scc1 L_fail
    s_waitcnt vmcnt(0)
    v_bitop3_b32 v122, v122, v123, s7 bitop3:0x7e
    v_bitop3_b32 v122, v122, v124, s7 bitop3:0xf6
    v_cmp_ne_u32 vcc, 0, v122
    s_cbranch_vccz L_wh_89
    s_sleep 6
    s_branch L_wf_87
L_wh_89:
L_wg_88:
    s_barrier
L_qg_84:
    s_cmp_lt_u32 s25, 64
    s_waitcnt vmcnt(11)
    s_cbranch_scc1 L_ql_80
    s_waitcnt vmcnt(0)
    s_barrier
    s_add_u32 s20, s7, 64
    s_cmp_eq_u32 s3, 0
    s_cbranch_scc0 L_sf_90
    v_mov_b32 v10, s20
    s_mov_b64 exec, 1
    buffer_store_dword v10, off, s[8:11], s28 sc1
    s_mov_b64 exec, -1
L_sf_90:
    s_branch L_done
L_role_chain:
    s_load_dwordx2 s[60:61], s[0:1], 8
    s_load_dwordx4 s[64:67], s[0:1], 24
    s_load_dwordx2 s[62:63], s[0:1], 16
    s_load_dwordx2 s[68:69], s[0:1], 40
    v_and_b32 v20, 63, v0
    v_lshlrev_b32 v0, 4, v20
    v_lshrrev_b32 v21, 4, v20
    v_and_b32 v22, 15, v20
    v_and_b32 v23, 1, v21
    v_or_b32 v23, 0, v23
    v_lshlrev_b32 v23, 1, v23
    v_xor_b32 v23, v23, v22
    v_lshlrev_b32 v23, 4, v23
    v_lshl_add_u32 v30, v21, 13, v23
    v_and_b32 v23, 1, v21
    v_or_b32 v23, 2, v23
    v_lshlrev_b32 v23, 1, v23
    v_xor_b32 v23, v23, v22
    v_lshlrev_b32 v23, 4, v23
    v_lshl_add_u32 v31, v21, 13, v23
    v_and_b32 v23, 1, v21
    v_or_b32 v23, 4, v23
    v_lshlrev_b32 v23, 1, v23
    v_xor_b32 v23, v23, v22
    v_lshlrev_b32 v23, 4, v23
    v_lshl_add_u32 v32, v21, 13, v23
    v_and_b32 v23, 1, v21
    v_or_b32 v23, 6, v23
    v_lshlrev_b32 v23, 1, v23
    v_xor_b32 v23, v23, v22
    v_lshlrev_b32 v23, 4, v23
    v_lshl_add_u32 v33, v21, 13, v23
    v_xor_b32 v23, 0, v20
    v_lshlrev_b32 v34, 4, v23
    v_xor_b32 v23, 1, v20
    v_lshlrev_b32 v35, 4, v23
    v_xor_b32 v23, 8, v20
    v_lshlrev_b32 v36, 4, v23
    v_xor_b32 v23, 9, v20
    v_lshlrev_b32 v37, 4, v23
    v_lshrrev_b32 v26, 2, v22
    v_and_b32 v27, 3, v22
    v_lshrrev_b32 v23, 1, v21
    v_lshlrev_b32 v23, 4, v23
    v_lshrrev_b32 v24, 1, v26
    v_lshl_add_u32 v23, v24, 3, v23
    v_and_b32 v25, 1, v21
    v_lshl_add_u32 v23, v25, 2, v23
    v_and_b32 v28, 1, v26
    v_add_u32 v23, v23, v28
    v_lshl_add_u32 v28, v25, 1, v28
    v_lshl_add_u32 v28, v24, 2, v28
    s_lshl_b32 s34, s3, 1
    v_xor_b32 v28, s34, v28
    v_lshlrev_b32 v28, 5, v28
    v_lshl_add_u32 v28, v23, 8, v28
    v_lshl_add_u32 v28, v27, 3, v28
    v_add_u32 v38, 32768, v28
    v_xor_b32 v39, 32, v38
    v_and_b32 v28, 1, v26
    v_lshl_add_u32 v23, v21, 2, v28
    v_lshl_add_u32 v28, v25, 3, v28
    v_lshlrev_b32 v29, 2, v24
    v_and_b32 v24, 2, v27
    v_add_u32 v29, v29, v24
    s_lshl_b32 s34, s3, 4
    v_add_u32 v29, s34, v29
    v_xor_b32 v29, v29, v28
    v_lshlrev_b32 v29, 4, v29
    v_lshl_add_u32 v29, v23, 10, v29
    v_and_b32 v24, 1, v27
    v_lshl_add_u32 v29, v24, 3, v29
    v_add_u32 v40, 32768, v29
    v_and_b32 v23, 8, v20
    v_cmp_eq_u32 vcc, 0, v23
    v_mov_b32 v24, 0xeeeeeeee
    v_mov_b32 v25, 0x44444444
    v_cndmask_b32 v1, v24, v25, vcc
    v_lshrrev_b32 v23, 5, v20
    v_lshl_add_u32 v23, v23, 4, v22
    s_lshl_b32 s34, s3, 10
    v_lshlrev_b32 v23, 5, v23
    v_xor_b32 v24, v21, v26
    v_and_b32 v25, 1, v24
    v_lshl_add_u32 v23, v25, 3, v23
    s_add_u32 s35, s34, 8192
    v_add_u32 v2, s35, v23
    v_lshlrev_b32 v23, 5, v22
    v_lshl_add_u32 v23, v24, 3, v23
    s_add_u32 s35, s34, 16384
    v_add_u32 v4, s35, v23
    v_lshl_add_u32 v23, v21, 2, v26
    v_xor_b32 v24, v27, v21
    v_lshlrev_b32 v24, 3, v24
    v_lshl_add_u32 v3, v23, 5, v24
    v_lshrrev_b32 v24, 1, v21
    v_lshlrev_b32 v24, 8, v24
    v_lshl_add_u32 v24, v22, 4, v24
    v_and_b32 v25, 1, v21
    v_lshl_add_u32 v24, v25, 3, v24
    s_add_u32 s35, s34, 20480
    v_add_u32 v5, s35, v24
    s_lshl_b32 s35, s3, 3
    s_add_u32 s35, s35, 14336
    v_add_u32 v6, s35, v0
    s_cmp_lt_u32 s3, 2
    s_cbranch_scc1 L_chpw_91
    v_lshlrev_b32 v23, 8, v25
    v_lshl_add_u32 v23, v22, 4, v23
    v_lshrrev_b32 v24, 1, v21
    v_lshl_add_u32 v23, v24, 2, v23
    s_and_b32 s35, s3, 1
    s_lshl_b32 s35, s35, 9
    s_add_u32 s35, s35, 15360
    v_add_u32 v6, s35, v23
L_chpw_91:
    v_and_b32 v23, 7, v20
    v_lshlrev_b32 v23, 4, v23
    s_lshl_b32 s34, s3, 12
    s_add_u32 s34, s34, 32768
    v_add_u32 v7, s34, v0
    v_lshl_add_u32 v23, v25, 7, v23
    v_lshrrev_b32 v24, 5, v20
    v_bfe_u32 v25, v20, 3, 1
    v_lshl_add_u32 v24, v24, 1, v25
    s_lshl_b32 s34, s3, 3
    v_add_u32 v24, s34, v24
    v_lshl_add_u32 v9, v24, 13, v23
    v_lshrrev_b32 v23, 1, v21
    v_lshl_add_u32 v23, v23, 2, v27
    v_lshlrev_b32 v23, 4, v23
    v_and_b32 v24, 1, v26
    v_lshl_add_u32 v23, v24, 7, v23
    v_and_b32 v24, 1, v21
    v_lshl_add_u32 v8, v24, 3, v23
    v_mov_b32 v10, 0x3f003f00
    v_mov_b32 v11, 0x3f003f00
    v_mov_b32 v12, 0x3f803f80
    v_mov_b32 v13, 0x3f803f80
    v_mov_b32 v14, 0x3f803f80
    v_mov_b32 v15, 0x3f803f80
    v_and_b32 v23, 7, v20
    v_and_b32 v24, 1, v20
    v_lshlrev_b32 v24, 4, v24
    v_mov_b32 v25, 0x3f80
    v_lshlrev_b32 v25, v24, v25
    v_lshrrev_b32 v23, 1, v23
    v_cmp_eq_u32 vcc, 0, v23
    s_nop 1
    v_cndmask_b32 v44, 0, v25, vcc
    v_cmp_eq_u32 vcc, 1, v23
    s_nop 1
    v_cndmask_b32 v45, 0, v25, vcc
    v_cmp_eq_u32 vcc, 2, v23
    s_nop 1
    v_cndmask_b32 v46, 0, v25, vcc
    v_cmp_eq_u32 vcc, 3, v23
    s_nop 1
    v_cndmask_b32 v47, 0, v25, vcc
    ds_write_b128 v0, v[44:47] offset:12288
    v_and_b32 v23, 7, v20
    v_lshlrev_b32 v23, 10, v23
    v_lshl_add_u32 v23, v21, 5, v23
    v_bfe_u32 v24, v20, 3, 1
    v_lshl_add_u32 v42, v24, 4, v23
    s_mov_b32 s36, 0x7f817f81
    s_mov_b32 s37, 0x5d800000
    s_mov_b32 s38, 0x3e0293ee
    s_waitcnt lgkmcnt(0)
    v_lshlrev_b32 v43, 3, v0
    v_mov_b32 v44, 1
    v_mov_b32 v45, 0
    v_mov_b32 v46, 0
    v_mov_b32 v47, 0
    s_lshl_b32 s23, s4, 13
    s_lshl_b32 s43, s3, 11
    s_add_u32 s23, s23, s43
    s_add_u32 s23, s23, 0x100000
    s_add_u32 s21, s23, 0x40000
    v_mov_b32 v48, s36
    v_mov_b32 v49, s36
    s_lshl_b32 s25, s4, 8
    s_lshl_b32 s43, s3, 13
    s_add_u32 s25, s25, s43
    s_add_u32 s25, s25, 0x180000
    s_lshl_b32 s39, s4, 7
    s_add_u32 s39, s39, 0x10000
    s_lshl_b32 s28, s4, 15
    s_lshl_b32 s34, s3, 11
    s_add_u32 s28, s28, s34
    s_add_u32 s28, s28, 0x2002000
    s_add_u32 s31, s34, 24576
    s_mov_b32 s58, s34
    s_mov_b32 s41, s34
    s_mov_b32 s12, s64
    s_and_b32 s13, s65, 0xffff
    s_mov_b32 s14, 0x400000
    s_mov_b32 s15, 0x20000
    s_lshl_b32 s42, s3, 17
    s_lshl_b32 s43, s4, 8
    s_add_u32 s42, s42, s43
    s_add_u32 s42, s42, 0x0
    s_lshl_b32 s43, s3, 12
    s_add_u32 s43, s43, 32768
    s_mov_b32 m0, s43
    s_add_u32 s43, s43, 1024
    buffer_load_dwordx4 v30, s[12:15], s42 offen nt lds
    s_add_u32 s42, s42, 32768
    s_mov_b32 m0, s43
    s_add_u32 s43, s43, 1024
    buffer_load_dwordx4 v31, s[12:15], s42 offen nt lds
    s_add_u32 s42, s42, 32768
    s_mov_b32 m0, s43
    s_add_u32 s43, s43, 1024
    buffer_load_dwordx4 v32, s[12:15], s42 offen nt lds
    s_add_u32 s42, s42, 32768
    s_mov_b32 m0, s43
    s_nop 0
    buffer_load_dwordx4 v33, s[12:15], s42 offen nt lds
    s_lshl_b32 s42, s3, 17
    s_lshl_b32 s43, s4, 8
    s_add_u32 s42, s42, s43
    s_add_u32 s42, s42, 0x80000
    s_lshl_b32 s43, s3, 12
    s_add_u32 s43, s43, 49152
    s_mov_b32 m0, s43
    s_add_u32 s43, s43, 1024
    buffer_load_dwordx4 v30, s[12:15], s42 offen nt lds
    s_add_u32 s42, s42, 32768
    s_mov_b32 m0, s43
    s_add_u32 s43, s43, 1024
    buffer_load_dwordx4 v31, s[12:15], s42 offen nt lds
    s_add_u32 s42, s42, 32768
    s_mov_b32 m0, s43
    s_add_u32 s43, s43, 1024
    buffer_load_dwordx4 v32, s[12:15], s42 offen nt lds
    s_add_u32 s42, s42, 32768
    s_mov_b32 m0, s43
    s_nop 0
    buffer_load_dwordx4 v33, s[12:15], s42 offen nt lds
    s_lshl_b32 s42, s3, 17
    s_lshl_b32 s43, s4, 8
    s_add_u32 s42, s42, s43
    s_add_u32 s42, s42, 0x100000
    s_lshl_b32 s43, s3, 12
    s_add_u32 s43, s43, 65536
    s_mov_b32 m0, s43
    s_add_u32 s43, s43, 1024
    buffer_load_dwordx4 v30, s[12:15], s42 offen nt lds
    s_add_u32 s42, s42, 32768
    s_mov_b32 m0, s43
    s_add_u32 s43, s43, 1024
    buffer_load_dwordx4 v31, s[12:15], s42 offen nt lds
    s_add_u32 s42, s42, 32768
    s_mov_b32 m0, s43
    s_add_u32 s43, s43, 1024
    buffer_load_dwordx4 v32, s[12:15], s42 offen nt lds
    s_add_u32 s42, s42, 32768
    s_mov_b32 m0, s43
    s_nop 0
    buffer_load_dwordx4 v33, s[12:15], s42 offen nt lds
    buffer_store_dwordx4 v[44:47], v0, s[8:11], s23 offen offset:0
    buffer_store_dwordx4 v[44:47], v0, s[8:11], s23 offen offset:1024
    buffer_store_dwordx4 v[44:47], v0, s[8:11], s21 offen offset:0
    buffer_store_dwordx4 v[44:47], v0, s[8:11], s21 offen offset:1024
    buffer_store_dwordx2 v[48:49], v8, s[8:11], s25 offen
    s_cmp_eq_u32 s3, 0
    s_cbranch_scc0 L_chn0_92
    buffer_load_dword v50, off, s[16:19], 0 offset:8 sc1
L_chn0_92:
    s_waitcnt vmcnt(13) lgkmcnt(0)
    s_barrier
    s_lshl_b32 s42, s3, 17
    s_lshl_b32 s43, s4, 8
    s_add_u32 s42, s42, s43
    s_add_u32 s42, s42, 0x180000
    s_lshl_b32 s43, s3, 12
    s_add_u32 s43, s43, 81920
    s_mov_b32 m0, s43
    s_add_u32 s43, s43, 1024
    buffer_load_dwordx4 v30, s[12:15], s42 offen nt lds
    s_add_u32 s42, s42, 32768
    s_mov_b32 m0, s43
    s_add_u32 s43, s43, 1024
    buffer_load_dwordx4 v31, s[12:15], s42 offen nt lds
    s_add_u32 s42, s42, 32768
    s_mov_b32 m0, s43
    s_add_u32 s43, s43, 1024
    buffer_load_dwordx4 v32, s[12:15], s42 offen nt lds
    s_add_u32 s42, s42, 32768
    s_mov_b32 m0, s43
    s_nop 0
    buffer_load_dwordx4 v33, s[12:15], s42 offen nt lds
    ds_read_b64_tr_b16 a[0:1], v38 offset:0
    ds_read_b64_tr_b16 a[2:3], v38 offset:512
    ds_read_b64_tr_b16 a[4:5], v38 offset:8192
    ds_read_b64_tr_b16 a[6:7], v38 offset:8704
    ds_read_b64_tr_b16 a[8:9], v39 offset:0
    ds_read_b64_tr_b16 a[10:11], v39 offset:512
    ds_read_b64_tr_b16 a[12:13], v39 offset:8192
    ds_read_b64_tr_b16 a[14:15], v39 offset:8704
    s_waitcnt vmcnt(13) lgkmcnt(0)
    s_barrier
    s_lshl_b32 s42, s3, 17
    s_lshl_b32 s43, s4, 8
    s_add_u32 s42, s42, s43
    s_add_u32 s42, s42, 0x200000
    s_lshl_b32 s43, s3, 12
    s_add_u32 s43, s43, 98304
    s_mov_b32 m0, s43
    s_add_u32 s43, s43, 1024
    buffer_load_dwordx4 v30, s[12:15], s42 offen nt lds
    s_add_u32 s42, s42, 32768
    s_mov_b32 m0, s43
    s_add_u32 s43, s43, 1024
    buffer_load_dwordx4 v31, s[12:15], s42 offen nt lds
    s_add_u32 s42, s42, 32768
    s_mov_b32 m0, s43
    s_add_u32 s43, s43, 1024
    buffer_load_dwordx4 v32, s[12:15], s42 offen nt lds
    s_add_u32 s42, s42, 32768
    s_mov_b32 m0, s43
    s_nop 0
    buffer_load_dwordx4 v33, s[12:15], s42 offen nt lds
    s_lshl_b32 s42, s3, 17
    s_lshl_b32 s43, s4, 8
    s_add_u32 s42, s42, s43
    s_add_u32 s42, s42, 0x280000
    s_lshl_b32 s43, s3, 12
    s_add_u32 s43, s43, 114688
    s_mov_b32 m0, s43
    s_add_u32 s43, s43, 1024
    buffer_load_dwordx4 v30, s[12:15], s42 offen nt lds
    s_add_u32 s42, s42, 32768
    s_mov_b32 m0, s43
    s_add_u32 s43, s43, 1024
    buffer_load_dwordx4 v31, s[12:15], s42 offen nt lds
    s_add_u32 s42, s42, 32768
    s_mov_b32 m0, s43
    s_add_u32 s43, s43, 1024
    buffer_load_dwordx4 v32, s[12:15], s42 offen nt lds
    s_add_u32 s42, s42, 32768
    s_mov_b32 m0, s43
    s_nop 0
    buffer_load_dwordx4 v33, s[12:15], s42 offen nt lds
    ds_read_b64_tr_b16 a[16:17], v38 offset:16384
    ds_read_b64_tr_b16 a[18:19], v38 offset:16896
    ds_read_b64_tr_b16 a[20:21], v38 offset:24576
    ds_read_b64_tr_b16 a[22:23], v38 offset:25088
    ds_read_b64_tr_b16 a[24:25], v39 offset:16384
    ds_read_b64_tr_b16 a[26:27], v39 offset:16896
    ds_read_b64_tr_b16 a[28:29], v39 offset:24576
    ds_read_b64_tr_b16 a[30:31], v39 offset:25088
    s_waitcnt vmcnt(17) lgkmcnt(0)
    s_barrier
    s_lshl_b32 s42, s3, 17
    s_lshl_b32 s43, s4, 8
    s_add_u32 s42, s42, s43
    s_add_u32 s42, s42, 0x300000
    s_lshl_b32 s43, s3, 12
    s_add_u32 s43, s43, 131072
    s_mov_b32 m0, s43
    s_add_u32 s43, s43, 1024
    buffer_load_dwordx4 v30, s[12:15], s42 offen nt lds
    s_add_u32 s42, s42, 32768
    s_mov_b32 m0, s43
    s_add_u32 s43, s43, 1024
    buffer_load_dwordx4 v31, s[12:15], s42 offen nt lds
    s_add_u32 s42, s42, 32768
    s_mov_b32 m0, s43
    s_add_u32 s43, s43, 1024
    buffer_load_dwordx4 v32, s[12:15], s42 offen nt lds
    s_add_u32 s42, s42, 32768
    s_mov_b32 m0, s43
    s_nop 0
    buffer_load_dwordx4 v33, s[12:15], s42 offen nt lds
    s_lshl_b32 s42, s3, 17
    s_lshl_b32 s43, s4, 8
    s_add_u32 s42, s42, s43
    s_add_u32 s42, s42, 0x380000
    s_lshl_b32 s43, s3, 12
    s_add_u32 s43, s43, 147456
    s_mov_b32 m0, s43
    s_add_u32 s43, s43, 1024
    buffer_load_dwordx4 v30, s[12:15], s42 offen nt lds
    s_add_u32 s42, s42, 32768
    s_mov_b32 m0, s43
    s_add_u32 s43, s43, 1024
    buffer_load_dwordx4 v31, s[12:15], s42 offen nt lds
    s_add_u32 s42, s42, 32768
    s_mov_b32 m0, s43
    s_add_u32 s43, s43, 1024
    buffer_load_dwordx4 v32, s[12:15], s42 offen nt lds
    s_add_u32 s42, s42, 32768
    s_mov_b32 m0, s43
    s_nop 0
    buffer_load_dwordx4 v33, s[12:15], s42 offen nt lds
    v_add_u32 v41, 32768, v38
    ds_read_b64_tr_b16 a[32:33], v41 offset:0
    ds_read_b64_tr_b16 a[34:35], v41 offset:512
    ds_read_b64_tr_b16 a[36:37], v41 offset:8192
    ds_read_b64_tr_b16 a[38:39], v41 offset:8704
    v_add_u32 v41, 32768, v39
    ds_read_b64_tr_b16 a[40:41], v41 offset:0
    ds_read_b64_tr_b16 a[42:43], v41 offset:512
    ds_read_b64_tr_b16 a[44:45], v41 offset:8192
    ds_read_b64_tr_b16 a[46:47], v41 offset:8704
    s_waitcnt vmcnt(16) lgkmcnt(0)
    s_barrier
    s_mov_b32 s12, s66
    s_and_b32 s13, s67, 0xffff
    s_mov_b32 s14, 0x400000
    s_mov_b32 s15, 0x20000
    s_lshl_b32 s42, s3, 17
    s_lshl_b32 s43, s4, 8
    s_add_u32 s42, s42, s43
    s_add_u32 s42, s42, 0x0
    s_lshl_b32 s43, s3, 12
    s_add_u32 s43, s43, 32768
    s_mov_b32 m0, s43
    s_add_u32 s43, s43, 1024
    buffer_load_dwordx4 v30, s[12:15], s42 offen nt lds
    s_add_u32 s42, s42, 32768
    s_mov_b32 m0, s43
    s_add_u32 s43, s43, 1024
    buffer_load_dwordx4 v31, s[12:15], s42 offen nt lds
    s_add_u32 s42, s42, 32768
    s_mov_b32 m0, s43
    s_add_u32 s43, s43, 1024
    buffer_load_dwordx4 v32, s[12:15], s42 offen nt lds
    s_add_u32 s42, s42, 32768
    s_mov_b32 m0, s43
    s_nop 0
    buffer_load_dwordx4 v33, s[12:15], s42 offen nt lds
    s_lshl_b32 s42, s3, 17
    s_lshl_b32 s43, s4, 8
    s_add_u32 s42, s42, s43
    s_add_u32 s42, s42, 0x80000
    s_lshl_b32 s43, s3, 12
    s_add_u32 s43, s43, 49152
    s_mov_b32 m0, s43
    s_add_u32 s43, s43, 1024
    buffer_load_dwordx4 v30, s[12:15], s42 offen nt lds
    s_add_u32 s42, s42, 32768
    s_mov_b32 m0, s43
    s_add_u32 s43, s43, 1024
    buffer_load_dwordx4 v31, s[12:15], s42 offen nt lds
    s_add_u32 s42, s42, 32768
    s_mov_b32 m0, s43
    s_add_u32 s43, s43, 1024
    buffer_load_dwordx4 v32, s[12:15], s42 offen nt lds
    s_add_u32 s42, s42, 32768
    s_mov_b32 m0, s43
    s_nop 0
    buffer_load_dwordx4 v33, s[12:15], s42 offen nt lds
    v_add_u32 v41, 49152, v38
    ds_read_b64_tr_b16 a[48:49], v41 offset:0
    ds_read_b64_tr_b16 a[50:51], v41 offset:512
    ds_read_b64_tr_b16 a[52:53], v41 offset:8192
    ds_read_b64_tr_b16 a[54:55], v41 offset:8704
    v_add_u32 v41, 49152, v39
    ds_read_b64_tr_b16 a[56:57], v41 offset:0
    ds_read_b64_tr_b16 a[58:59], v41 offset:512
    ds_read_b64_tr_b16 a[60:61], v41 offset:8192
    ds_read_b64_tr_b16 a[62:63], v41 offset:8704
    s_waitcnt vmcnt(20) lgkmcnt(0)
    s_barrier
    s_lshl_b32 s42, s3, 17
    s_lshl_b32 s43, s4, 8
    s_add_u32 s42, s42, s43
    s_add_u32 s42, s42, 0x100000
    s_lshl_b32 s43, s3, 12
    s_add_u32 s43, s43, 65536
    s_mov_b32 m0, s43
    s_add_u32 s43, s43, 1024
    buffer_load_dwordx4 v30, s[12:15], s42 offen nt lds
    s_add_u32 s42, s42, 32768
    s_mov_b32 m0, s43
    s_add_u32 s43, s43, 1024
    buffer_load_dwordx4 v31, s[12:15], s42 offen nt lds
    s_add_u32 s42, s42, 32768
    s_mov_b32 m0, s43
    s_add_u32 s43, s43, 1024
    buffer_load_dwordx4 v32, s[12:15], s42 offen nt lds
    s_add_u32 s42, s42, 32768
    s_mov_b32 m0, s43
    s_nop 0
    buffer_load_dwordx4 v33, s[12:15], s42 offen nt lds
    s_lshl_b32 s42, s3, 17
    s_lshl_b32 s43, s4, 8
    s_add_u32 s42, s42, s43
    s_add_u32 s42, s42, 0x180000
    s_lshl_b32 s43, s3, 12
    s_add_u32 s43, s43, 81920
    s_mov_b32 m0, s43
    s_add_u32 s43, s43, 1024
    buffer_load_dwordx4 v30, s[12:15], s42 offen nt lds
    s_add_u32 s42, s42, 32768
    s_mov_b32 m0, s43
    s_add_u32 s43, s43, 1024
    buffer_load_dwordx4 v31, s[12:15], s42 offen nt lds
    s_add_u32 s42, s42, 32768
    s_mov_b32 m0, s43
    s_add_u32 s43, s43, 1024
    buffer_load_dwordx4 v32, s[12:15], s42 offen nt lds
    s_add_u32 s42, s42, 32768
    s_mov_b32 m0, s43
    s_nop 0
    buffer_load_dwordx4 v33, s[12:15], s42 offen nt lds
    v_add_u32 v41, 65536, v38
    ds_read_b64_tr_b16 a[64:65], v41 offset:0
    ds_read_b64_tr_b16 a[66:67], v41 offset:512
    ds_read_b64_tr_b16 a[68:69], v41 offset:8192
    ds_read_b64_tr_b16 a[70:71], v41 offset:8704
    v_add_u32 v41, 65536, v39
    ds_read_b64_tr_b16 a[72:73], v41 offset:0
    ds_read_b64_tr_b16 a[74:75], v41 offset:512
    ds_read_b64_tr_b16 a[76:77], v41 offset:8192
    ds_read_b64_tr_b16 a[78:79], v41 offset:8704
    s_waitcnt vmcnt(24) lgkmcnt(0)
    s_barrier
    s_lshl_b32 s42, s3, 17
    s_lshl_b32 s43, s4, 8
    s_add_u32 s42, s42, s43
    s_add_u32 s42, s42, 0x200000
    s_lshl_b32 s43, s3, 12
    s_add_u32 s43, s43, 98304
    s_mov_b32 m0, s43
    s_add_u32 s43, s43, 1024
    buffer_load_dwordx4 v30, s[12:15], s42 offen nt lds
    s_add_u32 s42, s42, 32768
    s_mov_b32 m0, s43
    s_add_u32 s43, s43, 1024
    buffer_load_dwordx4 v31, s[12:15], s42 offen nt lds
    s_add_u32 s42, s42, 32768
    s_mov_b32 m0, s43
    s_add_u32 s43, s43, 1024
    buffer_load_dwordx4 v32, s[12:15], s42 offen nt lds
    s_add_u32 s42, s42, 32768
    s_mov_b32 m0, s43
    s_nop 0
    buffer_load_dwordx4 v33, s[12:15], s42 offen nt lds
    v_add_u32 v41, 81920, v38
    ds_read_b64_tr_b16 a[80:81], v41 offset:0
    ds_read_b64_tr_b16 a[82:83], v41 offset:512
    ds_read_b64_tr_b16 a[84:85], v41 offset:8192
    ds_read_b64_tr_b16 a[86:87], v41 offset:8704
    v_add_u32 v41, 81920, v39
    ds_read_b64_tr_b16 a[88:89], v41 offset:0
    ds_read_b64_tr_b16 a[90:91], v41 offset:512
    ds_read_b64_tr_b16 a[92:93], v41 offset:8192
    ds_read_b64_tr_b16 a[94:95], v41 offset:8704
    s_waitcnt vmcnt(24) lgkmcnt(0)
    s_barrier
    s_lshl_b32 s42, s3, 17
    s_lshl_b32 s43, s4, 8
    s_add_u32 s42, s42, s43
    s_add_u32 s42, s42, 0x280000
    s_lshl_b32 s43, s3, 12
    s_add_u32 s43, s43, 114688
    s_mov_b32 m0, s43
    s_add_u32 s43, s43, 1024
    buffer_load_dwordx4 v30, s[12:15], s42 offen nt lds
    s_add_u32 s42, s42, 32768
    s_mov_b32 m0, s43
    s_add_u32 s43, s43, 1024
    buffer_load_dwordx4 v31, s[12:15], s42 offen nt lds
    s_add_u32 s42, s42, 32768
    s_mov_b32 m0, s43
    s_add_u32 s43, s43, 1024
    buffer_load_dwordx4 v32, s[12:15], s42 offen nt lds
    s_add_u32 s42, s42, 32768
    s_mov_b32 m0, s43
    s_nop 0
    buffer_load_dwordx4 v33, s[12:15], s42 offen nt lds
    v_add_u32 v41, 98304, v38
    ds_read_b64_tr_b16 a[96:97], v41 offset:0
    ds_read_b64_tr_b16 a[98:99], v41 offset:512
    ds_read_b64_tr_b16 a[100:101], v41 offset:8192
    ds_read_b64_tr_b16 a[102:103], v41 offset:8704
    v_add_u32 v41, 98304, v39
    ds_read_b64_tr_b16 a[104:105], v41 offset:0
    ds_read_b64_tr_b16 a[106:107], v41 offset:512
    ds_read_b64_tr_b16 a[108:109], v41 offset:8192
    ds_read_b64_tr_b16 a[110:111], v41 offset:8704
    s_waitcnt vmcnt(24) lgkmcnt(0)
    s_barrier
    s_lshl_b32 s42, s3, 17
    s_lshl_b32 s43, s4, 8
    s_add_u32 s42, s42, s43
    s_add_u32 s42, s42, 0x300000
    s_lshl_b32 s43, s3, 12
    s_add_u32 s43, s43, 131072
    s_mov_b32 m0, s43
    s_add_u32 s43, s43, 1024
    buffer_load_dwordx4 v30, s[12:15], s42 offen nt lds
    s_add_u32 s42, s42, 32768
    s_mov_b32 m0, s43
    s_add_u32 s43, s43, 1024
    buffer_load_dwordx4 v31, s[12:15], s42 offen nt lds
    s_add_u32 s42, s42, 32768
    s_mov_b32 m0, s43
    s_add_u32 s43, s43, 1024
    buffer_load_dwordx4 v32, s[12:15], s42 offen nt lds
    s_add_u32 s42, s42, 32768
    s_mov_b32 m0, s43
    s_nop 0
    buffer_load_dwordx4 v33, s[12:15], s42 offen nt lds
    v_add_u32 v41, 114688, v38
    ds_read_b64_tr_b16 a[112:113], v41 offset:0
    ds_read_b64_tr_b16 a[114:115], v41 offset:512
    ds_read_b64_tr_b16 a[116:117], v41 offset:8192
    ds_read_b64_tr_b16 a[118:119], v41 offset:8704
    v_add_u32 v41, 114688, v39
    ds_read_b64_tr_b16 a[120:121], v41 offset:0
    ds_read_b64_tr_b16 a[122:123], v41 offset:512
    ds_read_b64_tr_b16 a[124:125], v41 offset:8192
    ds_read_b64_tr_b16 a[126:127], v41 offset:8704
    s_waitcnt vmcnt(24) lgkmcnt(0)
    s_barrier
    s_mov_b32 s12, s62
    s_and_b32 s13, s63, 0xffff
    s_mov_b32 s14, 0x400000
    s_mov_b32 s15, 0x20000
    s_lshl_b32 s42, s3, 17
    s_lshl_b32 s43, s4, 8
    s_add_u32 s42, s42, s43
    s_add_u32 s42, s42, 0x80000
    s_lshl_b32 s43, s3, 12
    s_add_u32 s43, s43, 147456
    s_mov_b32 m0, s43
    s_add_u32 s43, s43, 1024
    buffer_load_dwordx4 v30, s[12:15], s42 offen nt lds
    s_add_u32 s42, s42, 32768
    s_mov_b32 m0, s43
    s_add_u32 s43, s43, 1024
    buffer_load_dwordx4 v31, s[12:15], s42 offen nt lds
    s_add_u32 s42, s42, 32768
    s_mov_b32 m0, s43
    s_add_u32 s43, s43, 1024
    buffer_load_dwordx4 v32, s[12:15], s42 offen nt lds
    s_add_u32 s42, s42, 32768
    s_mov_b32 m0, s43
    s_nop 0
    buffer_load_dwordx4 v33, s[12:15], s42 offen nt lds
    ds_read_b64_tr_b16 v[144:145], v38 offset:0
    ds_read_b64_tr_b16 v[146:147], v38 offset:512
    ds_read_b64_tr_b16 v[148:149], v38 offset:8192
    ds_read_b64_tr_b16 v[150:151], v38 offset:8704
    ds_read_b64_tr_b16 v[152:153], v39 offset:0
    ds_read_b64_tr_b16 v[154:155], v39 offset:512
    ds_read_b64_tr_b16 v[156:157], v39 offset:8192
    ds_read_b64_tr_b16 v[158:159], v39 offset:8704
    s_waitcnt vmcnt(24) lgkmcnt(0)
    s_barrier
    s_lshl_b32 s42, s3, 17
    s_lshl_b32 s43, s4, 8
    s_add_u32 s42, s42, s43
    s_add_u32 s42, s42, 0x180000
    s_lshl_b32 s43, s3, 12
    s_add_u32 s43, s43, 32768
    s_mov_b32 m0, s43
    s_add_u32 s43, s43, 1024
    buffer_load_dwordx4 v30, s[12:15], s42 offen nt lds
    s_add_u32 s42, s42, 32768
    s_mov_b32 m0, s43
    s_add_u32 s43, s43, 1024
    buffer_load_dwordx4 v31, s[12:15], s42 offen nt lds
    s_add_u32 s42, s42, 32768
    s_mov_b32 m0, s43
    s_add_u32 s43, s43, 1024
    buffer_load_dwordx4 v32, s[12:15], s42 offen nt lds
    s_add_u32 s42, s42, 32768
    s_mov_b32 m0, s43
    s_nop 0
    buffer_load_dwordx4 v33, s[12:15], s42 offen nt lds
    v_mov_b32 v51, 14080
    s_cmp_eq_u32 s3, 0
    s_cbranch_scc0 L_nb_94
    s_mov_b64 exec, 1
    v_readfirstlane_b32 s7, v50
    s_nop 0
    s_cmp_lg_u32 s7, 0
    s_cbranch_scc1 L_nh_95
    s_mov_b32 s33, 0
L_gn_96:
    buffer_load_dword v50, off, s[16:19], 0 offset:8 sc1
    s_add_u32 s33, s33, 1
    s_cmp_gt_u32 s33, 100000
    s_cbranch_scc1 L_fail
    s_waitcnt vmcnt(0)
    v_readfirstlane_b32 s7, v50
    s_nop 0
    s_cmp_lg_u32 s7, 0
    s_cbranch_scc1 L_go_97
    s_sleep 10
    s_branch L_gn_96
L_go_97:
L_nh_95:
    ds_write_b32 v51, v50
    s_mov_b64 exec, -1
    s_waitcnt lgkmcnt(0)
L_nb_94:
    s_barrier
    ds_read_b32 v50, v51
    s_waitcnt lgkmcnt(0)
    v_readfirstlane_b32 s7, v50
    s_lshl_b32 s34, s5, 5
    s_add_u32 s34, s34, s4
    s_lshl_b32 s34, s34, 2
    s_add_u32 s34, s34, 0x12000
    s_cmp_eq_u32 s3, 0
    s_cbranch_scc0 L_sf_98
    v_mov_b32 v50, s7
    s_mov_b64 exec, 1
    buffer_store_dword v50, off, s[8:11], s34 sc1
    s_mov_b64 exec, -1
L_sf_98:
    ds_read_b64_tr_b16 v[160:161], v38 offset:16384
    ds_read_b64_tr_b16 v[162:163], v38 offset:16896
    ds_read_b64_tr_b16 v[164:165], v38 offset:24576
    ds_read_b64_tr_b16 v[166:167], v38 offset:25088
    ds_read_b64_tr_b16 v[168:169], v39 offset:16384
    ds_read_b64_tr_b16 v[170:171], v39 offset:16896
    ds_read_b64_tr_b16 v[172:173], v39 offset:24576
    ds_read_b64_tr_b16 v[174:175], v39 offset:25088
    s_waitcnt vmcnt(24) lgkmcnt(0)
    s_barrier
    s_lshl_b32 s42, s3, 17
    s_lshl_b32 s43, s4, 8
    s_add_u32 s42, s42, s43
    s_add_u32 s42, s42, 0x280000
    s_lshl_b32 s43, s3, 12
    s_add_u32 s43, s43, 49152
    s_mov_b32 m0, s43
    s_add_u32 s43, s43, 1024
    buffer_load_dwordx4 v30, s[12:15], s42 offen nt lds
    s_add_u32 s42, s42, 32768
    s_mov_b32 m0, s43
    s_add_u32 s43, s43, 1024
    buffer_load_dwordx4 v31, s[12:15], s42 offen nt lds
    s_add_u32 s42, s42, 32768
    s_mov_b32 m0, s43
    s_add_u32 s43, s43, 1024
    buffer_load_dwordx4 v32, s[12:15], s42 offen nt lds
    s_add_u32 s42, s42, 32768
    s_mov_b32 m0, s43
    s_nop 0
    buffer_load_dwordx4 v33, s[12:15], s42 offen nt lds
    v_add_u32 v41, 32768, v38
    ds_read_b64_tr_b16 v[176:177], v41 offset:0
    ds_read_b64_tr_b16 v[178:179], v41 offset:512
    ds_read_b64_tr_b16 v[180:181], v41 offset:8192
    ds_read_b64_tr_b16 v[182:183], v41 offset:8704
    v_add_u32 v41, 32768, v39
    ds_read_b64_tr_b16 v[184:185], v41 offset:0
    ds_read_b64_tr_b16 v[186:187], v41 offset:512
    ds_read_b64_tr_b16 v[188:189], v41 offset:8192
    ds_read_b64_tr_b16 v[190:191], v41 offset:8704
    s_waitcnt vmcnt(24) lgkmcnt(0)
    s_barrier
    s_lshl_b32 s42, s3, 17
    s_lshl_b32 s43, s4, 8
    s_add_u32 s42, s42, s43
    s_add_u32 s42, s42, 0x300000
    s_lshl_b32 s43, s3, 12
    s_add_u32 s43, s43, 65536
    s_mov_b32 m0, s43
    s_add_u32 s43, s43, 1024
    buffer_load_dwordx4 v30, s[12:15], s42 offen nt lds
    s_add_u32 s42, s42, 32768
    s_mov_b32 m0, s43
    s_add_u32 s43, s43, 1024
    buffer_load_dwordx4 v31, s[12:15], s42 offen nt lds
    s_add_u32 s42, s42, 32768
    s_mov_b32 m0, s43
    s_add_u32 s43, s43, 1024
    buffer_load_dwordx4 v32, s[12:15], s42 offen nt lds
    s_add_u32 s42, s42, 32768
    s_mov_b32 m0, s43
    s_nop 0
    buffer_load_dwordx4 v33, s[12:15], s42 offen nt lds
    v_add_u32 v41, 49152, v38
    ds_read_b64_tr_b16 v[192:193], v41 offset:0
    ds_read_b64_tr_b16 v[194:195], v41 offset:512
    ds_read_b64_tr_b16 v[196:197], v41 offset:8192
    ds_read_b64_tr_b16 v[198:199], v41 offset:8704
    v_add_u32 v41, 49152, v39
    ds_read_b64_tr_b16 v[200:201], v41 offset:0
    ds_read_b64_tr_b16 v[202:203], v41 offset:512
    ds_read_b64_tr_b16 v[204:205], v41 offset:8192
    ds_read_b64_tr_b16 v[206:207], v41 offset:8704
    s_waitcnt vmcnt(24) lgkmcnt(0)
    s_barrier
    s_lshl_b32 s42, s3, 17
    s_lshl_b32 s43, s4, 8
    s_add_u32 s42, s42, s43
    s_add_u32 s42, s42, 0x380000
    s_lshl_b32 s43, s3, 12
    s_add_u32 s43, s43, 81920
    s_mov_b32 m0, s43
    s_add_u32 s43, s43, 1024
    buffer_load_dwordx4 v30, s[12:15], s42 offen nt lds
    s_add_u32 s42, s42, 32768
    s_mov_b32 m0, s43
    s_add_u32 s43, s43, 1024
    buffer_load_dwordx4 v31, s[12:15], s42 offen nt lds
    s_add_u32 s42, s42, 32768
    s_mov_b32 m0, s43
    s_add_u32 s43, s43, 1024
    buffer_load_dwordx4 v32, s[12:15], s42 offen nt lds
    s_add_u32 s42, s42, 32768
    s_mov_b32 m0, s43
    s_nop 0
    buffer_load_dwordx4 v33, s[12:15], s42 offen nt lds
    v_add_u32 v41, 65536, v38
    ds_read_b64_tr_b16 v[208:209], v41 offset:0
    ds_read_b64_tr_b16 v[210:211], v41 offset:512
    ds_read_b64_tr_b16 v[212:213], v41 offset:8192
    ds_read_b64_tr_b16 v[214:215], v41 offset:8704
    v_add_u32 v41, 65536, v39
    ds_read_b64_tr_b16 v[216:217], v41 offset:0
    ds_read_b64_tr_b16 v[218:219], v41 offset:512
    ds_read_b64_tr_b16 v[220:221], v41 offset:8192
    ds_read_b64_tr_b16 v[222:223], v41 offset:8704
    s_waitcnt vmcnt(24) lgkmcnt(0)
    s_barrier
    v_add_u32 v41, 81920, v38
    ds_read_b64_tr_b16 v[224:225], v41 offset:0
    ds_read_b64_tr_b16 v[226:227], v41 offset:512
    ds_read_b64_tr_b16 v[228:229], v41 offset:8192
    ds_read_b64_tr_b16 v[230:231], v41 offset:8704
    v_add_u32 v41, 81920, v39
    ds_read_b64_tr_b16 v[232:233], v41 offset:0
    ds_read_b64_tr_b16 v[234:235], v41 offset:512
    ds_read_b64_tr_b16 v[236:237], v41 offset:8192
    ds_read_b64_tr_b16 v[238:239], v41 offset:8704
    s_waitcnt vmcnt(20) lgkmcnt(0)
    s_barrier
    s_mov_b32 s12, s68
    s_and_b32 s13, s69, 0xffff
    s_mov_b32 s14, 0x400000
    s_mov_b32 s15, 0x20000
    s_lshl_b32 s42, s4, 17
    s_add_u32 s42, s42, 0
    s_mul_i32 s43, s4, 5
    s_lshl_b32 s56, s3, 3
    s_add_u32 s43, s43, s56
    s_and_b32 s43, s43, 31
    s_lshl_b32 s56, s43, 10
    s_add_u32 s57, s56, 98304
    s_mov_b32 m0, s57
    s_add_u32 s56, s56, s42
    s_and_b32 s57, s43, 1
    s_lshl_b32 s57, s57, 4
    s_bfe_u32 s55, s43, 0x10002
    s_lshl_b32 s55, s55, 7
    s_or_b32 s57, s57, s55
    v_xor_b32 v34, s57, v0
    buffer_load_dwordx4 v34, s[12:15], s56 offen nt lds
    s_add_u32 s43, s43, 1
    s_and_b32 s43, s43, 31
    s_lshl_b32 s56, s43, 10
    s_add_u32 s57, s56, 98304
    s_mov_b32 m0, s57
    s_add_u32 s56, s56, s42
    s_and_b32 s57, s43, 1
    s_lshl_b32 s57, s57, 4
    s_bfe_u32 s55, s43, 0x10002
    s_lshl_b32 s55, s55, 7
    s_or_b32 s57, s57, s55
    v_xor_b32 v35, s57, v0
    buffer_load_dwordx4 v35, s[12:15], s56 offen nt lds
    s_add_u32 s43, s43, 1
    s_and_b32 s43, s43, 31
    s_lshl_b32 s56, s43, 10
    s_add_u32 s57, s56, 98304
    s_mov_b32 m0, s57
    s_add_u32 s56, s56, s42
    s_and_b32 s57, s43, 1
    s_lshl_b32 s57, s57, 4
    s_bfe_u32 s55, s43, 0x10002
    s_lshl_b32 s55, s55, 7
    s_or_b32 s57, s57, s55
    v_xor_b32 v36, s57, v0
    buffer_load_dwordx4 v36, s[12:15], s56 offen nt lds
    s_add_u32 s43, s43, 1
    s_and_b32 s43, s43, 31
    s_lshl_b32 s56, s43, 10
    s_add_u32 s57, s56, 98304
    s_mov_b32 m0, s57
    s_add_u32 s56, s56, s42
    s_and_b32 s57, s43, 1
    s_lshl_b32 s57, s57, 4
    s_bfe_u32 s55, s43, 0x10002
    s_lshl_b32 s55, s55, 7
    s_or_b32 s57, s57, s55
    v_xor_b32 v37, s57, v0
    buffer_load_dwordx4 v37, s[12:15], s56 offen nt lds
    s_add_u32 s43, s43, 1
    s_and_b32 s43, s43, 31
    s_lshl_b32 s56, s43, 10
    s_add_u32 s57, s56, 98304
    s_mov_b32 m0, s57
    s_add_u32 s56, s56, s42
    s_and_b32 s57, s43, 1
    s_lshl_b32 s57, s57, 4
    s_bfe_u32 s55, s43, 0x10002
    s_lshl_b32 s55, s55, 7
    s_or_b32 s57, s57, s55
    v_xor_b32 v34, s57, v0
    buffer_load_dwordx4 v34, s[12:15], s56 offen nt lds
    s_add_u32 s43, s43, 1
    s_and_b32 s43, s43, 31
    s_lshl_b32 s56, s43, 10
    s_add_u32 s57, s56, 98304
    s_mov_b32 m0, s57
    s_add_u32 s56, s56, s42
    s_and_b32 s57, s43, 1
    s_lshl_b32 s57, s57, 4
    s_bfe_u32 s55, s43, 0x10002
    s_lshl_b32 s55, s55, 7
    s_or_b32 s57, s57, s55
    v_xor_b32 v35, s57, v0
    buffer_load_dwordx4 v35, s[12:15], s56 offen nt lds
    s_add_u32 s43, s43, 1
    s_and_b32 s43, s43, 31
    s_lshl_b32 s56, s43, 10
    s_add_u32 s57, s56, 98304
    s_mov_b32 m0, s57
    s_add_u32 s56, s56, s42
    s_and_b32 s57, s43, 1
    s_lshl_b32 s57, s57, 4
    s_bfe_u32 s55, s43, 0x10002
    s_lshl_b32 s55, s55, 7
    s_or_b32 s57, s57, s55
    v_xor_b32 v36, s57, v0
    buffer_load_dwordx4 v36, s[12:15], s56 offen nt lds
    s_add_u32 s43, s43, 1
    s_and_b32 s43, s43, 31
    s_lshl_b32 s56, s43, 10
    s_add_u32 s57, s56, 98304
    s_mov_b32 m0, s57
    s_add_u32 s56, s56, s42
    s_and_b32 s57, s43, 1
    s_lshl_b32 s57, s57, 4
    s_bfe_u32 s55, s43, 0x10002
    s_lshl_b32 s55, s55, 7
    s_or_b32 s57, s57, s55
    v_xor_b32 v37, s57, v0
    buffer_load_dwordx4 v37, s[12:15], s56 offen nt lds
    v_add_u32 v41, 98304, v38
    ds_read_b64_tr_b16 v[240:241], v41 offset:0
    ds_read_b64_tr_b16 v[242:243], v41 offset:512
    ds_read_b64_tr_b16 v[244:245], v41 offset:8192
    ds_read_b64_tr_b16 v[246:247], v41 offset:8704
    v_add_u32 v41, 98304, v39
    ds_read_b64_tr_b16 v[248:249], v41 offset:0
    ds_read_b64_tr_b16 v[250:251], v41 offset:512
    ds_read_b64_tr_b16 v[252:253], v41 offset:8192
    ds_read_b64_tr_b16 v[254:255], v41 offset:8704
    s_waitcnt vmcnt(24) lgkmcnt(0)
    s_barrier
    v_add_u32 v41, 114688, v38
    ds_read_b64_tr_b16 a[128:129], v41 offset:0
    ds_read_b64_tr_b16 a[130:131], v41 offset:512
    ds_read_b64_tr_b16 a[132:133], v41 offset:8192
    ds_read_b64_tr_b16 a[134:135], v41 offset:8704
    v_add_u32 v41, 114688, v39
    ds_read_b64_tr_b16 a[136:137], v41 offset:0
    ds_read_b64_tr_b16 a[138:139], v41 offset:512
    ds_read_b64_tr_b16 a[140:141], v41 offset:8192
    ds_read_b64_tr_b16 a[142:143], v41 offset:8704
    s_waitcnt vmcnt(20) lgkmcnt(0)
    s_barrier
    s_lshl_b32 s42, s4, 17
    s_add_u32 s42, s42, 32768
    s_mul_i32 s43, s4, 5
    s_lshl_b32 s56, s3, 3
    s_add_u32 s43, s43, s56
    s_and_b32 s43, s43, 31
    s_lshl_b32 s56, s43, 10
    s_add_u32 s57, s56, 131072
    s_mov_b32 m0, s57
    s_add_u32 s56, s56, s42
    s_and_b32 s57, s43, 1
    s_lshl_b32 s57, s57, 4
    s_bfe_u32 s55, s43, 0x10002
    s_lshl_b32 s55, s55, 7
    s_or_b32 s57, s57, s55
    v_xor_b32 v34, s57, v0
    buffer_load_dwordx4 v34, s[12:15], s56 offen nt lds
    s_add_u32 s43, s43, 1
    s_and_b32 s43, s43, 31
    s_lshl_b32 s56, s43, 10
    s_add_u32 s57, s56, 131072
    s_mov_b32 m0, s57
    s_add_u32 s56, s56, s42
    s_and_b32 s57, s43, 1
    s_lshl_b32 s57, s57, 4
    s_bfe_u32 s55, s43, 0x10002
    s_lshl_b32 s55, s55, 7
    s_or_b32 s57, s57, s55
    v_xor_b32 v35, s57, v0
    buffer_load_dwordx4 v35, s[12:15], s56 offen nt lds
    s_add_u32 s43, s43, 1
    s_and_b32 s43, s43, 31
    s_lshl_b32 s56, s43, 10
    s_add_u32 s57, s56, 131072
    s_mov_b32 m0, s57
    s_add_u32 s56, s56, s42
    s_and_b32 s57, s43, 1
    s_lshl_b32 s57, s57, 4
    s_bfe_u32 s55, s43, 0x10002
    s_lshl_b32 s55, s55, 7
    s_or_b32 s57, s57, s55
    v_xor_b32 v36, s57, v0
    buffer_load_dwordx4 v36, s[12:15], s56 offen nt lds
    s_add_u32 s43, s43, 1
    s_and_b32 s43, s43, 31
    s_lshl_b32 s56, s43, 10
    s_add_u32 s57, s56, 131072
    s_mov_b32 m0, s57
    s_add_u32 s56, s56, s42
    s_and_b32 s57, s43, 1
    s_lshl_b32 s57, s57, 4
    s_bfe_u32 s55, s43, 0x10002
    s_lshl_b32 s55, s55, 7
    s_or_b32 s57, s57, s55
    v_xor_b32 v37, s57, v0
    buffer_load_dwordx4 v37, s[12:15], s56 offen nt lds
    s_add_u32 s43, s43, 1
    s_and_b32 s43, s43, 31
    s_lshl_b32 s56, s43, 10
    s_add_u32 s57, s56, 131072
    s_mov_b32 m0, s57
    s_add_u32 s56, s56, s42
    s_and_b32 s57, s43, 1
    s_lshl_b32 s57, s57, 4
    s_bfe_u32 s55, s43, 0x10002
    s_lshl_b32 s55, s55, 7
    s_or_b32 s57, s57, s55
    v_xor_b32 v34, s57, v0
    buffer_load_dwordx4 v34, s[12:15], s56 offen nt lds
    s_add_u32 s43, s43, 1
    s_and_b32 s43, s43, 31
    s_lshl_b32 s56, s43, 10
    s_add_u32 s57, s56, 131072
    s_mov_b32 m0, s57
    s_add_u32 s56, s56, s42
    s_and_b32 s57, s43, 1
    s_lshl_b32 s57, s57, 4
    s_bfe_u32 s55, s43, 0x10002
    s_lshl_b32 s55, s55, 7
    s_or_b32 s57, s57, s55
    v_xor_b32 v35, s57, v0
    buffer_load_dwordx4 v35, s[12:15], s56 offen nt lds
    s_add_u32 s43, s43, 1
    s_and_b32 s43, s43, 31
    s_lshl_b32 s56, s43, 10
    s_add_u32 s57, s56, 131072
    s_mov_b32 m0, s57
    s_add_u32 s56, s56, s42
    s_and_b32 s57, s43, 1
    s_lshl_b32 s57, s57, 4
    s_bfe_u32 s55, s43, 0x10002
    s_lshl_b32 s55, s55, 7
    s_or_b32 s57, s57, s55
    v_xor_b32 v36, s57, v0
    buffer_load_dwordx4 v36, s[12:15], s56 offen nt lds
    s_add_u32 s43, s43, 1
    s_and_b32 s43, s43, 31
    s_lshl_b32 s56, s43, 10
    s_add_u32 s57, s56, 131072
    s_mov_b32 m0, s57
    s_add_u32 s56, s56, s42
    s_and_b32 s57, s43, 1
    s_lshl_b32 s57, s57, 4
    s_bfe_u32 s55, s43, 0x10002
    s_lshl_b32 s55, s55, 7
    s_or_b32 s57, s57, s55
    v_xor_b32 v37, s57, v0
    buffer_load_dwordx4 v37, s[12:15], s56 offen nt lds
    ds_read_b64_tr_b16 a[144:145], v38 offset:0
    ds_read_b64_tr_b16 a[146:147], v38 offset:512
    ds_read_b64_tr_b16 a[148:149], v38 offset:8192
    ds_read_b64_tr_b16 a[150:151], v38 offset:8704
    ds_read_b64_tr_b16 a[152:153], v39 offset:0
    ds_read_b64_tr_b16 a[154:155], v39 offset:512
    ds_read_b64_tr_b16 a[156:157], v39 offset:8192
    ds_read_b64_tr_b16 a[158:159], v39 offset:8704
    s_waitcnt vmcnt(24) lgkmcnt(0)
    s_barrier
    s_mov_b32 s12, s62
    s_and_b32 s13, s63, 0xffff
    s_mov_b32 s14, 0x400000
    s_mov_b32 s15, 0x20000
    s_lshl_b32 s42, s3, 17
    s_lshl_b32 s43, s4, 8
    s_add_u32 s42, s42, s43
    s_add_u32 s42, s42, 0x0
    s_lshl_b32 s43, s3, 12
    s_add_u32 s43, s43, 32768
    s_mov_b32 m0, s43
    s_add_u32 s43, s43, 1024
    buffer_load_dwordx4 v30, s[12:15], s42 offen nt lds
    s_add_u32 s42, s42, 32768
    s_mov_b32 m0, s43
    s_add_u32 s43, s43, 1024
    buffer_load_dwordx4 v31, s[12:15], s42 offen nt lds
    s_add_u32 s42, s42, 32768
    s_mov_b32 m0, s43
    s_add_u32 s43, s43, 1024
    buffer_load_dwordx4 v32, s[12:15], s42 offen nt lds
    s_add_u32 s42, s42, 32768
    s_mov_b32 m0, s43
    s_nop 0
    buffer_load_dwordx4 v33, s[12:15], s42 offen nt lds
    ds_read_b64_tr_b16 a[160:161], v38 offset:16384
    ds_read_b64_tr_b16 a[162:163], v38 offset:16896
    ds_read_b64_tr_b16 a[164:165], v38 offset:24576
    ds_read_b64_tr_b16 a[166:167], v38 offset:25088
    ds_read_b64_tr_b16 a[168:169], v39 offset:16384
    ds_read_b64_tr_b16 a[170:171], v39 offset:16896
    ds_read_b64_tr_b16 a[172:173], v39 offset:24576
    ds_read_b64_tr_b16 a[174:175], v39 offset:25088
    s_waitcnt vmcnt(24) lgkmcnt(0)
    s_barrier
    s_lshl_b32 s42, s3, 17
    s_lshl_b32 s43, s4, 8
    s_add_u32 s42, s42, s43
    s_add_u32 s42, s42, 0x100000
    s_lshl_b32 s43, s3, 12
    s_add_u32 s43, s43, 49152
    s_mov_b32 m0, s43
    s_add_u32 s43, s43, 1024
    buffer_load_dwordx4 v30, s[12:15], s42 offen nt lds
    s_add_u32 s42, s42, 32768
    s_mov_b32 m0, s43
    s_add_u32 s43, s43, 1024
    buffer_load_dwordx4 v31, s[12:15], s42 offen nt lds
    s_add_u32 s42, s42, 32768
    s_mov_b32 m0, s43
    s_add_u32 s43, s43, 1024
    buffer_load_dwordx4 v32, s[12:15], s42 offen nt lds
    s_add_u32 s42, s42, 32768
    s_mov_b32 m0, s43
    s_nop 0
    buffer_load_dwordx4 v33, s[12:15], s42 offen nt lds
    v_add_u32 v41, 32768, v38
    ds_read_b64_tr_b16 a[176:177], v41 offset:0
    ds_read_b64_tr_b16 a[178:179], v41 offset:512
    ds_read_b64_tr_b16 a[180:181], v41 offset:8192
    ds_read_b64_tr_b16 a[182:183], v41 offset:8704
    v_add_u32 v41, 32768, v39
    ds_read_b64_tr_b16 a[184:185], v41 offset:0
    ds_read_b64_tr_b16 a[186:187], v41 offset:512
    ds_read_b64_tr_b16 a[188:189], v41 offset:8192
    ds_read_b64_tr_b16 a[190:191], v41 offset:8704
    s_waitcnt vmcnt(24) lgkmcnt(0)
    s_barrier
    s_lshl_b32 s42, s3, 17
    s_lshl_b32 s43, s4, 8
    s_add_u32 s42, s42, s43
    s_add_u32 s42, s42, 0x200000
    s_lshl_b32 s43, s3, 12
    s_add_u32 s43, s43, 65536
    s_mov_b32 m0, s43
    s_add_u32 s43, s43, 1024
    buffer_load_dwordx4 v30, s[12:15], s42 offen nt lds
    s_add_u32 s42, s42, 32768
    s_mov_b32 m0, s43
    s_add_u32 s43, s43, 1024
    buffer_load_dwordx4 v31, s[12:15], s42 offen nt lds
    s_add_u32 s42, s42, 32768
    s_mov_b32 m0, s43
    s_add_u32 s43, s43, 1024
    buffer_load_dwordx4 v32, s[12:15], s42 offen nt lds
    s_add_u32 s42, s42, 32768
    s_mov_b32 m0, s43
    s_nop 0
    buffer_load_dwordx4 v33, s[12:15], s42 offen nt lds
    v_add_u32 v41, 49152, v38
    ds_read_b64_tr_b16 a[192:193], v41 offset:0
    ds_read_b64_tr_b16 a[194:195], v41 offset:512
    ds_read_b64_tr_b16 a[196:197], v41 offset:8192
    ds_read_b64_tr_b16 a[198:199], v41 offset:8704
    v_add_u32 v41, 49152, v39
    ds_read_b64_tr_b16 a[200:201], v41 offset:0
    ds_read_b64_tr_b16 a[202:203], v41 offset:512
    ds_read_b64_tr_b16 a[204:205], v41 offset:8192
    ds_read_b64_tr_b16 a[206:207], v41 offset:8704
    s_waitcnt vmcnt(20) lgkmcnt(0)
    s_barrier
    s_mov_b32 s12, s66
    s_and_b32 s13, s67, 0xffff
    s_mov_b32 s14, 0x400000
    s_mov_b32 s15, 0x20000
    s_lshl_b32 s42, s3, 17
    s_lshl_b32 s43, s4, 8
    s_add_u32 s42, s42, s43
    s_add_u32 s42, s42, 0x380000
    s_lshl_b32 s43, s3, 12
    s_add_u32 s43, s43, 81920
    s_mov_b32 m0, s43
    s_add_u32 s43, s43, 1024
    buffer_load_dwordx4 v30, s[12:15], s42 offen nt lds
    s_add_u32 s42, s42, 32768
    s_mov_b32 m0, s43
    s_add_u32 s43, s43, 1024
    buffer_load_dwordx4 v31, s[12:15], s42 offen nt lds
    s_add_u32 s42, s42, 32768
    s_mov_b32 m0, s43
    s_add_u32 s43, s43, 1024
    buffer_load_dwordx4 v32, s[12:15], s42 offen nt lds
    s_add_u32 s42, s42, 32768
    s_mov_b32 m0, s43
    s_nop 0
    buffer_load_dwordx4 v33, s[12:15], s42 offen nt lds
    v_xor_b32 v41, 0, v40
    v_add_u32 v41, 65536, v41
    ds_read_b64_tr_b16 a[208:209], v41 offset:0
    ds_read_b64_tr_b16 a[210:211], v41 offset:2048
    ds_read_b64_tr_b16 a[212:213], v41 offset:16384
    ds_read_b64_tr_b16 a[214:215], v41 offset:18432
    v_xor_b32 v41, 16, v40
    v_add_u32 v41, 65536, v41
    ds_read_b64_tr_b16 a[224:225], v41 offset:0
    ds_read_b64_tr_b16 a[226:227], v41 offset:2048
    ds_read_b64_tr_b16 a[228:229], v41 offset:16384
    ds_read_b64_tr_b16 a[230:231], v41 offset:18432
    v_xor_b32 v41, 128, v40
    v_add_u32 v41, 65536, v41
    ds_read_b64_tr_b16 a[240:241], v41 offset:0
    ds_read_b64_tr_b16 a[242:243], v41 offset:2048
    ds_read_b64_tr_b16 a[244:245], v41 offset:16384
    ds_read_b64_tr_b16 a[246:247], v41 offset:18432
    v_xor_b32 v41, 144, v40
    v_add_u32 v41, 65536, v41
    ds_read_b64_tr_b16 v[128:129], v41 offset:0
    ds_read_b64_tr_b16 v[130:131], v41 offset:2048
    ds_read_b64_tr_b16 v[132:133], v41 offset:16384
    ds_read_b64_tr_b16 v[134:135], v41 offset:18432
    s_waitcnt vmcnt(16) lgkmcnt(0)
    s_barrier
    s_mov_b32 s12, s68
    s_and_b32 s13, s69, 0xffff
    s_mov_b32 s14, 0x400000
    s_mov_b32 s15, 0x20000
    s_lshl_b32 s42, s4, 17
    s_add_u32 s42, s42, 65536
    s_mul_i32 s43, s4, 5
    s_lshl_b32 s56, s3, 3
    s_add_u32 s43, s43, s56
    s_and_b32 s43, s43, 31
    s_lshl_b32 s56, s43, 10
    s_add_u32 s57, s56, 98304
    s_mov_b32 m0, s57
    s_add_u32 s56, s56, s42
    s_and_b32 s57, s43, 1
    s_lshl_b32 s57, s57, 4
    s_bfe_u32 s55, s43, 0x10002
    s_lshl_b32 s55, s55, 7
    s_or_b32 s57, s57, s55
    v_xor_b32 v34, s57, v0
    buffer_load_dwordx4 v34, s[12:15], s56 offen nt lds
    s_add_u32 s43, s43, 1
    s_and_b32 s43, s43, 31
    s_lshl_b32 s56, s43, 10
    s_add_u32 s57, s56, 98304
    s_mov_b32 m0, s57
    s_add_u32 s56, s56, s42
    s_and_b32 s57, s43, 1
    s_lshl_b32 s57, s57, 4
    s_bfe_u32 s55, s43, 0x10002
    s_lshl_b32 s55, s55, 7
    s_or_b32 s57, s57, s55
    v_xor_b32 v35, s57, v0
    buffer_load_dwordx4 v35, s[12:15], s56 offen nt lds
    s_add_u32 s43, s43, 1
    s_and_b32 s43, s43, 31
    s_lshl_b32 s56, s43, 10
    s_add_u32 s57, s56, 98304
    s_mov_b32 m0, s57
    s_add_u32 s56, s56, s42
    s_and_b32 s57, s43, 1
    s_lshl_b32 s57, s57, 4
    s_bfe_u32 s55, s43, 0x10002
    s_lshl_b32 s55, s55, 7
    s_or_b32 s57, s57, s55
    v_xor_b32 v36, s57, v0
    buffer_load_dwordx4 v36, s[12:15], s56 offen nt lds
    s_add_u32 s43, s43, 1
    s_and_b32 s43, s43, 31
    s_lshl_b32 s56, s43, 10
    s_add_u32 s57, s56, 98304
    s_mov_b32 m0, s57
    s_add_u32 s56, s56, s42
    s_and_b32 s57, s43, 1
    s_lshl_b32 s57, s57, 4
    s_bfe_u32 s55, s43, 0x10002
    s_lshl_b32 s55, s55, 7
    s_or_b32 s57, s57, s55
    v_xor_b32 v37, s57, v0
    buffer_load_dwordx4 v37, s[12:15], s56 offen nt lds
    s_add_u32 s43, s43, 1
    s_and_b32 s43, s43, 31
    s_lshl_b32 s56, s43, 10
    s_add_u32 s57, s56, 98304
    s_mov_b32 m0, s57
    s_add_u32 s56, s56, s42
    s_and_b32 s57, s43, 1
    s_lshl_b32 s57, s57, 4
    s_bfe_u32 s55, s43, 0x10002
    s_lshl_b32 s55, s55, 7
    s_or_b32 s57, s57, s55
    v_xor_b32 v34, s57, v0
    buffer_load_dwordx4 v34, s[12:15], s56 offen nt lds
    s_add_u32 s43, s43, 1
    s_and_b32 s43, s43, 31
    s_lshl_b32 s56, s43, 10
    s_add_u32 s57, s56, 98304
    s_mov_b32 m0, s57
    s_add_u32 s56, s56, s42
    s_and_b32 s57, s43, 1
    s_lshl_b32 s57, s57, 4
    s_bfe_u32 s55, s43, 0x10002
    s_lshl_b32 s55, s55, 7
    s_or_b32 s57, s57, s55
    v_xor_b32 v35, s57, v0
    buffer_load_dwordx4 v35, s[12:15], s56 offen nt lds
    s_add_u32 s43, s43, 1
    s_and_b32 s43, s43, 31
    s_lshl_b32 s56, s43, 10
    s_add_u32 s57, s56, 98304
    s_mov_b32 m0, s57
    s_add_u32 s56, s56, s42
    s_and_b32 s57, s43, 1
    s_lshl_b32 s57, s57, 4
    s_bfe_u32 s55, s43, 0x10002
    s_lshl_b32 s55, s55, 7
    s_or_b32 s57, s57, s55
    v_xor_b32 v36, s57, v0
    buffer_load_dwordx4 v36, s[12:15], s56 offen nt lds
    s_add_u32 s43, s43, 1
    s_and_b32 s43, s43, 31
    s_lshl_b32 s56, s43, 10
    s_add_u32 s57, s56, 98304
    s_mov_b32 m0, s57
    s_add_u32 s56, s56, s42
    s_and_b32 s57, s43, 1
    s_lshl_b32 s57, s57, 4
    s_bfe_u32 s55, s43, 0x10002
    s_lshl_b32 s55, s55, 7
    s_or_b32 s57, s57, s55
    v_xor_b32 v37, s57, v0
    buffer_load_dwordx4 v37, s[12:15], s56 offen nt lds
    v_xor_b32 v41, 0, v40
    v_add_u32 v41, 98304, v41
    ds_read_b64_tr_b16 a[216:217], v41 offset:0
    ds_read_b64_tr_b16 a[218:219], v41 offset:2048
    ds_read_b64_tr_b16 a[220:221], v41 offset:16384
    ds_read_b64_tr_b16 a[222:223], v41 offset:18432
    v_xor_b32 v41, 16, v40
    v_add_u32 v41, 98304, v41
    ds_read_b64_tr_b16 a[232:233], v41 offset:0
    ds_read_b64_tr_b16 a[234:235], v41 offset:2048
    ds_read_b64_tr_b16 a[236:237], v41 offset:16384
    ds_read_b64_tr_b16 a[238:239], v41 offset:18432
    v_xor_b32 v41, 128, v40
    v_add_u32 v41, 98304, v41
    ds_read_b64_tr_b16 a[248:249], v41 offset:0
    ds_read_b64_tr_b16 a[250:251], v41 offset:2048
    ds_read_b64_tr_b16 a[252:253], v41 offset:16384
    ds_read_b64_tr_b16 a[254:255], v41 offset:18432
    v_xor_b32 v41, 144, v40
    v_add_u32 v41, 98304, v41
    ds_read_b64_tr_b16 v[136:137], v41 offset:0
    ds_read_b64_tr_b16 v[138:139], v41 offset:2048
    ds_read_b64_tr_b16 v[140:141], v41 offset:16384
    ds_read_b64_tr_b16 v[142:143], v41 offset:18432
    s_waitcnt vmcnt(20) lgkmcnt(0)
    s_barrier
    s_lshl_b32 s42, s4, 17
    s_add_u32 s42, s42, 98304
    s_mul_i32 s43, s4, 5
    s_lshl_b32 s56, s3, 3
    s_add_u32 s43, s43, s56
    s_and_b32 s43, s43, 31
    s_lshl_b32 s56, s43, 10
    s_add_u32 s57, s56, 131072
    s_mov_b32 m0, s57
    s_add_u32 s56, s56, s42
    s_and_b32 s57, s43, 1
    s_lshl_b32 s57, s57, 4
    s_bfe_u32 s55, s43, 0x10002
    s_lshl_b32 s55, s55, 7
    s_or_b32 s57, s57, s55
    v_xor_b32 v34, s57, v0
    buffer_load_dwordx4 v34, s[12:15], s56 offen nt lds
    s_add_u32 s43, s43, 1
    s_and_b32 s43, s43, 31
    s_lshl_b32 s56, s43, 10
    s_add_u32 s57, s56, 131072
    s_mov_b32 m0, s57
    s_add_u32 s56, s56, s42
    s_and_b32 s57, s43, 1
    s_lshl_b32 s57, s57, 4
    s_bfe_u32 s55, s43, 0x10002
    s_lshl_b32 s55, s55, 7
    s_or_b32 s57, s57, s55
    v_xor_b32 v35, s57, v0
    buffer_load_dwordx4 v35, s[12:15], s56 offen nt lds
    s_add_u32 s43, s43, 1
    s_and_b32 s43, s43, 31
    s_lshl_b32 s56, s43, 10
    s_add_u32 s57, s56, 131072
    s_mov_b32 m0, s57
    s_add_u32 s56, s56, s42
    s_and_b32 s57, s43, 1
    s_lshl_b32 s57, s57, 4
    s_bfe_u32 s55, s43, 0x10002
    s_lshl_b32 s55, s55, 7
    s_or_b32 s57, s57, s55
    v_xor_b32 v36, s57, v0
    buffer_load_dwordx4 v36, s[12:15], s56 offen nt lds
    s_add_u32 s43, s43, 1
    s_and_b32 s43, s43, 31
    s_lshl_b32 s56, s43, 10
    s_add_u32 s57, s56, 131072
    s_mov_b32 m0, s57
    s_add_u32 s56, s56, s42
    s_and_b32 s57, s43, 1
    s_lshl_b32 s57, s57, 4
    s_bfe_u32 s55, s43, 0x10002
    s_lshl_b32 s55, s55, 7
    s_or_b32 s57, s57, s55
    v_xor_b32 v37, s57, v0
    buffer_load_dwordx4 v37, s[12:15], s56 offen nt lds
    s_add_u32 s43, s43, 1
    s_and_b32 s43, s43, 31
    s_lshl_b32 s56, s43, 10
    s_add_u32 s57, s56, 131072
    s_mov_b32 m0, s57
    s_add_u32 s56, s56, s42
    s_and_b32 s57, s43, 1
    s_lshl_b32 s57, s57, 4
    s_bfe_u32 s55, s43, 0x10002
    s_lshl_b32 s55, s55, 7
    s_or_b32 s57, s57, s55
    v_xor_b32 v34, s57, v0
    buffer_load_dwordx4 v34, s[12:15], s56 offen nt lds
    s_add_u32 s43, s43, 1
    s_and_b32 s43, s43, 31
    s_lshl_b32 s56, s43, 10
    s_add_u32 s57, s56, 131072
    s_mov_b32 m0, s57
    s_add_u32 s56, s56, s42
    s_and_b32 s57, s43, 1
    s_lshl_b32 s57, s57, 4
    s_bfe_u32 s55, s43, 0x10002
    s_lshl_b32 s55, s55, 7
    s_or_b32 s57, s57, s55
    v_xor_b32 v35, s57, v0
    buffer_load_dwordx4 v35, s[12:15], s56 offen nt lds
    s_add_u32 s43, s43, 1
    s_and_b32 s43, s43, 31
    s_lshl_b32 s56, s43, 10
    s_add_u32 s57, s56, 131072
    s_mov_b32 m0, s57
    s_add_u32 s56, s56, s42
    s_and_b32 s57, s43, 1
    s_lshl_b32 s57, s57, 4
    s_bfe_u32 s55, s43, 0x10002
    s_lshl_b32 s55, s55, 7
    s_or_b32 s57, s57, s55
    v_xor_b32 v36, s57, v0
    buffer_load_dwordx4 v36, s[12:15], s56 offen nt lds
    s_add_u32 s43, s43, 1
    s_and_b32 s43, s43, 31
    s_lshl_b32 s56, s43, 10
    s_add_u32 s57, s56, 131072
    s_mov_b32 m0, s57
    s_add_u32 s56, s56, s42
    s_and_b32 s57, s43, 1
    s_lshl_b32 s57, s57, 4
    s_bfe_u32 s55, s43, 0x10002
    s_lshl_b32 s55, s55, 7
    s_or_b32 s57, s57, s55
    v_xor_b32 v37, s57, v0
    buffer_load_dwordx4 v37, s[12:15], s56 offen nt lds
    v_lshrrev_b32 v112, 2, v0
    v_and_b32 v113, 127, v112
    s_add_u32 s32, s7, 2
    v_mov_b32 v117, s32
    s_mov_b32 s34, 0x11400
    buffer_load_dword v114, v112, s[8:11], s34 offen sc1
    buffer_load_dword v115, v112, s[8:11], s34 offen offset:256 sc1
    s_mov_b32 s34, 0x12000
    buffer_load_dword v116, v113, s[8:11], s34 offen sc1
    s_mov_b64 exec, 3
    buffer_load_dword v117, v0, s[8:11], s39 offen sc1
    s_mov_b64 exec, -1
    s_mov_b32 s44, s60
    s_and_b32 s45, s61, 0xffff
    s_mov_b32 s46, 0x2000
    s_mov_b32 s47, 0x20000
    buffer_load_dwordx4 v[48:51], v42, s[44:47], 0 offen offset:0
    buffer_load_dwordx4 v[52:55], v42, s[44:47], 0 offen offset:128
    buffer_load_dwordx4 v[56:59], v42, s[44:47], 0 offen offset:256
    buffer_load_dwordx4 v[60:63], v42, s[44:47], 0 offen offset:384
    buffer_load_dwordx4 v[64:67], v42, s[44:47], 0 offen offset:512
    buffer_load_dwordx4 v[68:71], v42, s[44:47], 0 offen offset:640
    buffer_load_dwordx4 v[72:75], v42, s[44:47], 0 offen offset:768
    buffer_load_dwordx4 v[76:79], v42, s[44:47], 0 offen offset:896
    ds_read_b64_tr_b16 v[80:81], v38 offset:0
    ds_read_b64_tr_b16 v[82:83], v38 offset:512
    ds_read_b64_tr_b16 v[84:85], v38 offset:8192
    ds_read_b64_tr_b16 v[86:87], v38 offset:8704
    ds_read_b64_tr_b16 v[88:89], v39 offset:0
    ds_read_b64_tr_b16 v[90:91], v39 offset:512
    ds_read_b64_tr_b16 v[92:93], v39 offset:8192
    ds_read_b64_tr_b16 v[94:95], v39 offset:8704
    s_waitcnt vmcnt(36) lgkmcnt(0)
    s_barrier
    v_add_u32 v41, 0, v7
    ds_write_b128 v41, v[80:83] offset:0
    ds_write_b128 v41, v[84:87] offset:1024
    ds_write_b128 v41, v[88:91] offset:2048
    ds_write_b128 v41, v[92:95] offset:3072
    ds_read_b64_tr_b16 v[80:81], v38 offset:16384
    ds_read_b64_tr_b16 v[82:83], v38 offset:16896
    ds_read_b64_tr_b16 v[84:85], v38 offset:24576
    ds_read_b64_tr_b16 v[86:87], v38 offset:25088
    ds_read_b64_tr_b16 v[88:89], v39 offset:16384
    ds_read_b64_tr_b16 v[90:91], v39 offset:16896
    ds_read_b64_tr_b16 v[92:93], v39 offset:24576
    ds_read_b64_tr_b16 v[94:95], v39 offset:25088
    s_waitcnt vmcnt(32) lgkmcnt(0)
    s_barrier
    v_add_u32 v41, 16384, v7
    ds_write_b128 v41, v[80:83] offset:0
    ds_write_b128 v41, v[84:87] offset:1024
    ds_write_b128 v41, v[88:91] offset:2048
    ds_write_b128 v41, v[92:95] offset:3072
    v_add_u32 v41, 32768, v38
    ds_read_b64_tr_b16 v[80:81], v41 offset:0
    ds_read_b64_tr_b16 v[82:83], v41 offset:512
    ds_read_b64_tr_b16 v[84:85], v41 offset:8192
    ds_read_b64_tr_b16 v[86:87], v41 offset:8704
    v_add_u32 v41, 32768, v39
    ds_read_b64_tr_b16 v[88:89], v41 offset:0
    ds_read_b64_tr_b16 v[90:91], v41 offset:512
    ds_read_b64_tr_b16 v[92:93], v41 offset:8192
    ds_read_b64_tr_b16 v[94:95], v41 offset:8704
    s_waitcnt vmcnt(28) lgkmcnt(0)
    s_barrier
    v_add_u32 v41, 32768, v7
    ds_write_b128 v41, v[80:83] offset:0
    ds_write_b128 v41, v[84:87] offset:1024
    ds_write_b128 v41, v[88:91] offset:2048
    ds_write_b128 v41, v[92:95] offset:3072
    s_lshl_b32 s34, s4, 2
    s_add_u32 s34, s34, 0x12400
    s_cmp_eq_u32 s3, 0
    s_cbranch_scc0 L_sf_99
    v_mov_b32 v119, s7
    s_mov_b64 exec, 1
    buffer_store_dword v119, off, s[8:11], s34 sc1
    s_mov_b64 exec, -1
L_sf_99:
    v_add_u32 v41, 49152, v38
    ds_read_b64_tr_b16 v[80:81], v41 offset:0
    ds_read_b64_tr_b16 v[82:83], v41 offset:512
    ds_read_b64_tr_b16 v[84:85], v41 offset:8192
    ds_read_b64_tr_b16 v[86:87], v41 offset:8704
    v_add_u32 v41, 49152, v39
    ds_read_b64_tr_b16 v[88:89], v41 offset:0
    ds_read_b64_tr_b16 v[90:91], v41 offset:512
    ds_read_b64_tr_b16 v[92:93], v41 offset:8192
    ds_read_b64_tr_b16 v[94:95], v41 offset:8704
    s_waitcnt vmcnt(20) lgkmcnt(0)
    s_barrier
    v_add_u32 v41, 49152, v7
    ds_write_b128 v41, v[80:83] offset:0
    ds_write_b128 v41, v[84:87] offset:1024
    ds_write_b128 v41, v[88:91] offset:2048
    ds_write_b128 v41, v[92:95] offset:3072
    v_xor_b32 v41, 0, v40
    v_add_u32 v41, 65536, v41
    ds_read_b64_tr_b16 v[80:81], v41 offset:0
    ds_read_b64_tr_b16 v[82:83], v41 offset:2048
    ds_read_b64_tr_b16 v[84:85], v41 offset:16384
    ds_read_b64_tr_b16 v[86:87], v41 offset:18432
    v_xor_b32 v41, 16, v40
    v_add_u32 v41, 65536, v41
    ds_read_b64_tr_b16 v[88:89], v41 offset:0
    ds_read_b64_tr_b16 v[90:91], v41 offset:2048
    ds_read_b64_tr_b16 v[92:93], v41 offset:16384
    ds_read_b64_tr_b16 v[94:95], v41 offset:18432
    v_xor_b32 v41, 128, v40
    v_add_u32 v41, 65536, v41
    ds_read_b64_tr_b16 v[96:97], v41 offset:0
    ds_read_b64_tr_b16 v[98:99], v41 offset:2048
    ds_read_b64_tr_b16 v[100:101], v41 offset:16384
    ds_read_b64_tr_b16 v[102:103], v41 offset:18432
    v_xor_b32 v41, 144, v40
    v_add_u32 v41, 65536, v41
    ds_read_b64_tr_b16 v[104:105], v41 offset:0
    ds_read_b64_tr_b16 v[106:107], v41 offset:2048
    ds_read_b64_tr_b16 v[108:109], v41 offset:16384
    ds_read_b64_tr_b16 v[110:111], v41 offset:18432
    s_waitcnt vmcnt(8) lgkmcnt(0)
    s_barrier
    v_add_u32 v41, 65536, v7
    ds_write_b128 v41, v[80:83] offset:0
    ds_write_b128 v41, v[84:87] offset:1024
    ds_write_b128 v41, v[88:91] offset:2048
    ds_write_b128 v41, v[92:95] offset:3072
    ds_write_b128 v41, v[96:99] offset:16384
    ds_write_b128 v41, v[100:103] offset:17408
    ds_write_b128 v41, v[104:107] offset:18432
    ds_write_b128 v41, v[108:111] offset:19456
    v_bitop3_b32 v114, v114, v115, s7 bitop3:0x7e
    v_bitop3_b32 v114, v114, v116, s7 bitop3:0xf6
    v_cmp_ne_u32 s[56:57], 0, v114
    v_subrev_u32 v117, s32, v117
    v_cmp_lt_u32 vcc, 62, v117
    s_nop 0
    s_or_b64 vcc, vcc, s[56:57]
    s_cmp_eq_u64 vcc, 0
    s_cselect_b32 s59, 1, 0
    s_cbranch_scc0 L_chne_100
    s_mov_b32 m0, s31
    s_nop 0
    buffer_load_dwordx4 v0, s[8:11], s28 offen sc1 lds
    buffer_load_dwordx4 v0, s[8:11], s28 offen offset:1024 sc1 lds
    s_add_u32 s34, s28, 8192
    buffer_load_dwordx4 v[16:19], v0, s[8:11], s34 offen offset:0 sc1
    buffer_load_dwordx4 v[20:23], v0, s[8:11], s34 offen offset:1024 sc1
L_chne_100:
    s_mov_b32 m0, 13312
    v_lshlrev_b32 v112, 1, v0
    buffer_load_dword v112, s[8:11], s23 offen sc1 lds
    buffer_load_dword v112, s[8:11], s21 offen sc1 lds
    buffer_load_dword v8, s[8:11], s25 offen sc1 lds
    v_xor_b32 v41, 0, v40
    v_add_u32 v41, 98304, v41
    ds_read_b64_tr_b16 v[80:81], v41 offset:0
    ds_read_b64_tr_b16 v[82:83], v41 offset:2048
    ds_read_b64_tr_b16 v[84:85], v41 offset:16384
    ds_read_b64_tr_b16 v[86:87], v41 offset:18432
    v_xor_b32 v41, 16, v40
    v_add_u32 v41, 98304, v41
    ds_read_b64_tr_b16 v[88:89], v41 offset:0
    ds_read_b64_tr_b16 v[90:91], v41 offset:2048
    ds_read_b64_tr_b16 v[92:93], v41 offset:16384
    ds_read_b64_tr_b16 v[94:95], v41 offset:18432
    v_xor_b32 v41, 128, v40
    v_add_u32 v41, 98304, v41
    ds_read_b64_tr_b16 v[96:97], v41 offset:0
    ds_read_b64_tr_b16 v[98:99], v41 offset:2048
    ds_read_b64_tr_b16 v[100:101], v41 offset:16384
    ds_read_b64_tr_b16 v[102:103], v41 offset:18432
    v_xor_b32 v41, 144, v40
    v_add_u32 v41, 98304, v41
    ds_read_b64_tr_b16 v[104:105], v41 offset:0
    ds_read_b64_tr_b16 v[106:107], v41 offset:2048
    ds_read_b64_tr_b16 v[108:109], v41 offset:16384
    ds_read_b64_tr_b16 v[110:111], v41 offset:18432
    s_waitcnt lgkmcnt(0)
    s_barrier
    v_add_u32 v41, 98304, v7
    ds_write_b128 v41, v[80:83] offset:0
    ds_write_b128 v41, v[84:87] offset:1024
    ds_write_b128 v41, v[88:91] offset:2048
    ds_write_b128 v41, v[92:95] offset:3072
    ds_write_b128 v41, v[96:99] offset:16384
    ds_write_b128 v41, v[100:103] offset:17408
    ds_write_b128 v41, v[104:107] offset:18432
    ds_write_b128 v41, v[108:111] offset:19456
    s_cmp_eq_u32 s59, 1
    s_cbranch_scc1 L_chry_101
    s_mov_b32 s33, 0
L_chv_102:
    v_lshrrev_b32 v112, 2, v0
    v_mov_b32 v117, s32
    s_mov_b32 s34, 0x11400
    buffer_load_dword v114, v112, s[8:11], s34 offen sc1
    buffer_load_dword v115, v112, s[8:11], s34 offen offset:256 sc1
    s_mov_b32 s34, 0x12000
    buffer_load_dword v116, v113, s[8:11], s34 offen sc1
    s_mov_b64 exec, 3
    buffer_load_dword v117, v0, s[8:11], s39 offen sc1
    s_mov_b64 exec, -1
    s_add_u32 s33, s33, 1
    s_cmp_gt_u32 s33, 100000
    s_cbranch_scc1 L_fail
    s_waitcnt vmcnt(0)
    v_bitop3_b32 v114, v114, v115, s7 bitop3:0x7e
    v_bitop3_b32 v114, v114, v116, s7 bitop3:0xf6
    v_cmp_ne_u32 s[56:57], 0, v114
    v_subrev_u32 v117, s32, v117
    v_cmp_lt_u32 vcc, 62, v117
    s_nop 0
    s_or_b64 vcc, vcc, s[56:57]
    s_cbranch_vccnz L_chv_102
    s_mov_b32 m0, s31
    s_nop 0
    buffer_load_dwordx4 v0, s[8:11], s28 offen sc1 lds
    buffer_load_dwordx4 v0, s[8:11], s28 offen offset:1024 sc1 lds
    s_add_u32 s34, s28, 8192
    buffer_load_dwordx4 v[16:19], v0, s[8:11], s34 offen offset:0 sc1
    buffer_load_dwordx4 v[20:23], v0, s[8:11], s34 offen offset:1024 sc1
L_chry_101:
    s_add_u32 s40, s7, 64
    s_mov_b32 s20, 0
    s_lshl_b32 s29, s4, 8
    s_add_u32 s29, s29, 0x1200000
    s_mov_b64 s[74:75], 0
    s_cmp_lt_u32 s3, 2
    s_cselect_b64 s[72:73], -1, 0
    s_and_b32 s42, s3, 1
    s_lshl_b32 s42, s42, 12
    s_add_u32 s42, s42, 24576
    s_mov_b32 s96, 0
    s_mov_b32 s97, 0
    s_waitcnt lgkmcnt(0)
    s_barrier
    ds_read_b128 v[80:83], v7 offset:0
    ds_read_b128 v[84:87], v7 offset:1024
    ds_read_b128 v[88:91], v7 offset:2048
    ds_read_b128 v[92:95], v7 offset:3072
    ds_read_b128 v[96:99], v7 offset:16384
    ds_read_b128 v[100:103], v7 offset:17408
    ds_read_b128 v[104:107], v7 offset:18432
    ds_read_b128 v[108:111], v7 offset:19456
    ds_read_b128 v[112:115], v7 offset:32768
    ds_read_b128 v[116:119], v7 offset:33792
    ds_read_b128 v[120:123], v7 offset:34816
    ds_read_b128 v[124:127], v7 offset:35840
    v_mov_b64 v[24:25], 0
    v_mov_b64 v[26:27], 0
    v_mov_b64 v[28:29], 0
    v_mov_b64 v[30:31], 0
    v_mov_b64 v[32:33], 0
    v_mov_b64 v[34:35], 0
    v_mov_b64 v[36:37], 0
    v_mov_b64 v[38:39], 0
    v_mov_b64 v[40:41], 0
    v_mov_b64 v[42:43], 0
    v_mov_b64 v[44:45], 0
    v_mov_b64 v[46:47], 0
    s_waitcnt vmcnt(0)
    ds_write_b128 v0, v[48:51] offset:0
    ds_write_b128 v0, v[52:55] offset:1024
    ds_write_b128 v0, v[56:59] offset:2048
    ds_write_b128 v0, v[60:63] offset:3072
    ds_write_b128 v0, v[64:67] offset:4096
    ds_write_b128 v0, v[68:71] offset:5120
    ds_write_b128 v0, v[72:75] offset:6144
    ds_write_b128 v0, v[76:79] offset:7168
    s_add_u32 s26, s41, 0x1200000
    v_add_u32 v46, s41, v0
    v_lshlrev_b32 v43, 2, v0
    s_mov_b32 m0, s41
    s_waitcnt vmcnt(0) lgkmcnt(0)
    s_branch L_chA_106
.p2align 6
L_chhead_104:
    s_barrier
    s_cmp_eq_u32 s20, 63
    s_cbranch_scc1 L_chlast_105
L_chh0_111:
    s_nop 15
    buffer_load_dwordx4 v0, s[8:11], s26 offen sc1 lds
    buffer_load_dwordx4 v0, s[8:11], s26 offen offset:1024 sc1 lds
    s_nop 15
    s_nop 15
    s_nop 3
    buffer_load_dwordx4 v0, s[8:11], s26 offen sc1 lds
    buffer_load_dwordx4 v0, s[8:11], s26 offen offset:1024 sc1 lds
    s_waitcnt vmcnt(2)
    ds_read2st64_b32 v[40:41], v46 offset0:0 offset1:4
    s_waitcnt lgkmcnt(0)
    v_cmp_u_f32 vcc, v40, v41
    s_cbranch_vccnz L_chvx_112
L_chA_106:
    s_barrier
    ds_read_b128 v[48:51], v0 offset:0
    ds_read_b128 v[56:59], v0 offset:2048
    ds_read_b128 v[64:67], v0 offset:4096
    ds_read_b128 v[72:75], v0 offset:6144
    s_add_u32 s28, s28, 1048576
    s_add_u32 s43, s28, s58
    s_mov_b32 m0, 13312
    s_nop 0
    buffer_load_dword v43, s[8:11], s43 offen sc1 lds
    s_waitcnt lgkmcnt(3)
    v_smfmac_f32_16x16x64_bf16 v[24:27], v[48:51], v[80:87], v1
    ds_read_b128 v[52:55], v0 offset:1024
    v_smfmac_f32_16x16x64_bf16 v[28:31], v[48:51], v[88:95], v1
    ds_read_b128 v[60:63], v0 offset:3072
    s_waitcnt lgkmcnt(4)
    v_smfmac_f32_16x16x64_bf16 v[24:27], v[56:59], v[96:103], v1
    ds_read_b128 v[68:71], v0 offset:5120
    v_smfmac_f32_16x16x64_bf16 v[28:31], v[56:59], v[104:111], v1
    ds_read_b128 v[76:79], v0 offset:7168
    s_waitcnt lgkmcnt(5)
    v_smfmac_f32_16x16x64_bf16 v[24:27], v[64:67], v[112:119], v1
    v_smfmac_f32_16x16x64_bf16 v[28:31], v[64:67], v[120:127], v1
    s_waitcnt lgkmcnt(4)
    v_smfmac_f32_16x16x64_bf16 v[24:27], v[72:75], a[176:183], v1
    v_smfmac_f32_16x16x64_bf16 v[28:31], v[72:75], a[184:191], v1
    s_add_u32 s34, s20, 1
    s_and_b32 s34, s34, 3
    v_add_u32 v81, s42, v0
    s_waitcnt lgkmcnt(3)
    v_smfmac_f32_16x16x64_bf16 v[24:27], v[52:55], a[128:135], v1
    s_lshl_b32 s34, s34, 13
    ds_read_b128 v[96:99], v81 offset:0
    v_smfmac_f32_16x16x64_bf16 v[28:31], v[52:55], a[136:143], v1
    s_add_u32 s34, s34, 0x180000
    s_lshl_b32 s35, s4, 8
    ds_read_b128 v[100:103], v81 offset:1024
    s_waitcnt lgkmcnt(4)
    v_smfmac_f32_16x16x64_bf16 v[24:27], v[60:63], a[144:151], v1
    s_add_u32 s25, s34, s35
    ds_read_b128 v[104:107], v81 offset:2048
    v_smfmac_f32_16x16x64_bf16 v[28:31], v[60:63], a[152:159], v1
    s_xor_b32 s27, s25, 0x4000
    s_add_u32 s26, s34, s41
    ds_read_b128 v[108:111], v81 offset:3072
    s_waitcnt lgkmcnt(5)
    v_smfmac_f32_16x16x64_bf16 v[24:27], v[68:71], a[160:167], v1
    s_and_b32 s34, s20, 1
    ds_read_b128 v[112:115], v7 offset:49152
    v_smfmac_f32_16x16x64_bf16 v[28:31], v[68:71], a[168:175], v1
    s_lshl_b32 s34, s34, 18
    s_add_u32 s34, s34, 0x100000
    ds_read_b128 v[116:119], v7 offset:50176
    s_waitcnt lgkmcnt(6)
    v_smfmac_f32_16x16x64_bf16 v[24:27], v[76:79], a[192:199], v1
    s_add_u32 s21, s34, s35
    ds_read_b128 v[120:123], v7 offset:51200
    v_smfmac_f32_16x16x64_bf16 v[28:31], v[76:79], a[200:207], v1
    s_add_u32 s22, s21, 0x8000
    s_lshl_b32 s23, s4, 13
    ds_read_b128 v[124:127], v7 offset:52224
    v_smfmac_f32_16x16x64_bf16 v[32:35], v[48:51], a[0:7], v1
    s_add_u32 s23, s23, s34
    s_bfe_u32 s24, s20, 0x10001
    v_mov_b64 v[46:47], 0
    v_smfmac_f32_16x16x64_bf16 v[32:35], v[52:55], a[16:23], v1
    v_mov_b64 v[44:45], 0
    v_smfmac_f32_16x16x64_bf16 v[32:35], v[56:59], a[32:39], v1
    v_permlane32_swap_b32 v24, v28
    v_smfmac_f32_16x16x64_bf16 v[32:35], v[60:63], a[48:55], v1
    v_permlane32_swap_b32 v25, v29
    v_add_f32 v24, v24, v28
    v_smfmac_f32_16x16x64_bf16 v[32:35], v[64:67], a[64:71], v1
    v_permlane32_swap_b32 v26, v30
    v_add_f32 v25, v25, v29
    v_smfmac_f32_16x16x64_bf16 v[32:35], v[68:71], a[80:87], v1
    v_permlane32_swap_b32 v27, v31
    v_cvt_pk_bf16_f32 v24, v24, v25
    v_smfmac_f32_16x16x64_bf16 v[32:35], v[72:75], a[96:103], v1
    v_add_f32 v26, v26, v30
    v_add_f32 v27, v27, v31
    v_smfmac_f32_16x16x64_bf16 v[32:35], v[76:79], a[112:119], v1
    v_cvt_pk_bf16_f32 v25, v26, v27
    ds_write2_b64 v2, v[24:25], v[24:25] offset0:0 offset1:2
    v_smfmac_f32_16x16x64_bf16 v[36:39], v[48:51], a[8:15], v1
    v_mov_b64 v[40:41], 0
    v_smfmac_f32_16x16x64_bf16 v[36:39], v[52:55], a[24:31], v1
    v_mov_b64 v[42:43], 0
    v_smfmac_f32_16x16x64_bf16 v[36:39], v[56:59], a[40:47], v1
    v_cvt_pk_bf16_f32 v32, v32, v33
    v_smfmac_f32_16x16x64_bf16 v[36:39], v[60:63], a[56:63], v1
    v_cvt_pk_bf16_f32 v33, v34, v35
    v_smfmac_f32_16x16x64_bf16 v[36:39], v[64:67], a[72:79], v1
    ds_write_b64 v4, v[32:33]
    v_smfmac_f32_16x16x64_bf16 v[36:39], v[68:71], a[88:95], v1
    s_waitcnt lgkmcnt(1)
    s_barrier
    ds_read_b64_tr_b16 v[80:81], v3 offset:8192
    v_smfmac_f32_16x16x64_bf16 v[36:39], v[72:75], a[104:111], v1
    ds_read_b64_tr_b16 v[82:83], v3 offset:8704
    v_smfmac_f32_16x16x64_bf16 v[36:39], v[76:79], a[120:127], v1
    s_cmp_lt_u32 s3, 2
    ds_read_b64_tr_b16 v[84:85], v3 offset:9216
    v_smfmac_f32_16x16x64_bf16 v[44:47], v[48:51], v[144:151], v1
    ds_read_b64_tr_b16 v[86:87], v3 offset:9728
    v_smfmac_f32_16x16x64_bf16 v[44:47], v[52:55], v[160:167], v1
    s_nop 1
    v_cvt_pk_bf16_f32 v34, v36, v37
    v_cvt_pk_bf16_f32 v35, v38, v39
    ds_write_b64 v4, v[34:35] offset:512
    v_smfmac_f32_16x16x64_bf16 v[44:47], v[56:59], v[176:183], v1
    ds_read_b64_tr_b16 v[88:89], v3 offset:10240
    ds_read_b64_tr_b16 v[90:91], v3 offset:10752
    v_smfmac_f32_16x16x64_bf16 v[44:47], v[60:63], v[192:199], v1
    ds_read_b64_tr_b16 v[92:93], v3 offset:11264
    ds_read_b64_tr_b16 v[94:95], v3 offset:11776
    s_mov_b32 m0, s31
    s_waitcnt lgkmcnt(4)
    s_barrier
    s_cbranch_scc1 L_chX_113
    ds_read_b64_tr_b16 v[96:97], v3 offset:16384
    ds_read_b64_tr_b16 v[98:99], v3 offset:16896
    ds_read_b64_tr_b16 v[100:101], v3 offset:17408
    ds_read_b64_tr_b16 v[102:103], v3 offset:17920
    ds_read_b64_tr_b16 v[104:105], v3 offset:18432
    ds_read_b64_tr_b16 v[106:107], v3 offset:18944
    ds_read_b64_tr_b16 v[108:109], v3 offset:19456
    ds_read_b64_tr_b16 v[110:111], v3 offset:19968
    v_smfmac_f32_16x16x64_bf16 v[44:47], v[64:67], v[208:215], v1
    v_xor_b32 v7, 0x10000, v7
    v_smfmac_f32_16x16x64_bf16 v[44:47], v[68:71], v[224:231], v1
    s_waitcnt lgkmcnt(6)
    v_mfma_f32_16x16x32_bf16 v[36:39], v[96:99], v[80:83], 0
    s_waitcnt lgkmcnt(4)
    v_mfma_f32_16x16x32_bf16 v[36:39], v[100:103], v[84:87], v[36:39]
    s_waitcnt lgkmcnt(2)
    v_mfma_f32_16x16x32_bf16 v[36:39], v[104:107], v[88:91], v[36:39]
    s_waitcnt lgkmcnt(0)
    v_mfma_f32_16x16x32_bf16 v[36:39], v[108:111], v[92:95], v[36:39]
    v_smfmac_f32_16x16x64_bf16 v[44:47], v[72:75], v[240:247], v1
    buffer_load_dwordx4 v0, s[8:11], s28 offen offset:0 sc1 lds
    v_smfmac_f32_16x16x64_bf16 v[44:47], v[76:79], v[112:119], v1
    s_nop 1
    v_permlane32_swap_b32 v36, v38
    v_permlane32_swap_b32 v37, v39
    v_add_f32 v36, v36, v38
    v_add_f32 v37, v37, v39
    v_mul_f32 v36, s38, v36
    v_mul_f32 v37, s38, v37
    v_exp_f32 v38, v36
    v_exp_f32 v39, v37
    s_nop 0
    v_cvt_pk_bf16_f32 v28, v38, v39
    ds_write_b32 v6, v28
    v_smfmac_f32_16x16x64_bf16 v[40:43], v[48:51], v[152:159], v1
    buffer_load_dwordx4 v0, s[8:11], s28 offen offset:1024 sc1 lds
    v_smfmac_f32_16x16x64_bf16 v[40:43], v[52:55], v[168:175], v1
    v_smfmac_f32_16x16x64_bf16 v[40:43], v[56:59], v[184:191], v1
    v_smfmac_f32_16x16x64_bf16 v[40:43], v[60:63], v[200:207], v1
    s_waitcnt lgkmcnt(0)
    s_barrier
L_chJ_114:
    ds_read_b64 v[28:29], v0 offset:15360
    ds_read_b128 v[108:111], v0 offset:14336
    v_smfmac_f32_16x16x64_bf16 v[40:43], v[64:67], v[216:223], v1
    v_cvt_pk_bf16_f32 v44, v44, v45
    v_smfmac_f32_16x16x64_bf16 v[40:43], v[68:71], v[232:239], v1
    v_cvt_pk_bf16_f32 v45, v46, v47
    v_smfmac_f32_16x16x64_bf16 v[40:43], v[72:75], v[248:255], v1
    s_add_u32 s34, s28, 8192
    v_mov_b64 v[30:31], 0
    v_smfmac_f32_16x16x64_bf16 v[40:43], v[76:79], v[120:127], v1
    s_waitcnt lgkmcnt(0)
    v_mfma_f32_16x16x32_bf16 v[120:123], v[12:15], v[108:111], 0
    ds_read_b128 v[80:83], v7 offset:0
    v_mfma_f32_16x16x32_bf16 v[120:123], v[10:13], v[28:31], v[120:123]
    ds_read_b128 v[84:87], v7 offset:1024
    v_mfma_f32_16x16x32_bf16 v[112:115], v[16:19], v[108:111], 0
    v_cvt_pk_bf16_f32 v46, v40, v41
    v_cvt_pk_bf16_f32 v47, v42, v43
    s_nop 1
    v_mfma_f32_16x16x32_bf16 v[112:115], v[44:47], v[28:31], v[112:115]
    ds_read_b128 v[88:91], v7 offset:32768
    v_mfma_f32_16x16x32_bf16 v[116:119], v[20:23], v[108:111], 0
    v_rcp_f32 v34, v120
    v_mfma_f32_16x16x32_bf16 v[116:119], v[46:49], v[28:31], v[116:119]
    v_max_f32 v35, v120, v34
    v_cmp_nge_f32 vcc, s37, v35
    v_mul_f32 v112, v112, v34
    v_mul_f32 v113, v113, v34
    v_mul_f32 v114, v114, v34
    v_mul_f32 v115, v115, v34
    v_cvt_pk_bf16_f32 v112, v112, v113
    v_cvt_pk_bf16_f32 v113, v114, v115
    s_cbranch_vccnz L_chfb_109
    ds_write_b64 v5, v[112:113]
    buffer_load_dwordx4 v[16:19], v0, s[8:11], s34 offen offset:0 sc1
    v_mul_f32 v116, v116, v34
    v_mul_f32 v117, v117, v34
    v_mul_f32 v118, v118, v34
    v_mul_f32 v119, v119, v34
    v_cvt_pk_bf16_f32 v116, v116, v117
    v_cvt_pk_bf16_f32 v117, v118, v119
L_chfr_110:
    ds_write_b64 v5, v[116:117] offset:512
    buffer_load_dwordx4 v[20:23], v0, s[8:11], s34 offen offset:1024 sc1
    v_mov_b64 v[48:49], 0
    v_mov_b64 v[50:51], 0
    v_mov_b64 v[52:53], 0
    v_mov_b64 v[54:55], 0
    v_mov_b64 v[56:57], 0
    v_mov_b64 v[58:59], 0
    v_mov_b64 v[60:61], 0
    v_mov_b64 v[62:63], 0
    s_waitcnt lgkmcnt(0)
    s_barrier
    ds_read_b128 v[112:115], v0 offset:20480
    ds_read_b128 v[116:119], v0 offset:21504
    ds_read_b128 v[120:123], v0 offset:22528
    ds_read_b128 v[124:127], v0 offset:23552
    ds_read_b128 v[92:95], v7 offset:33792
    ds_read_b128 v[96:99], v7 offset:2048
    s_waitcnt lgkmcnt(5)
    v_smfmac_f32_16x16x64_bf16 v[48:51], v[112:115], a[208:215], v1
    ds_read_b128 v[100:103], v7 offset:3072
    s_waitcnt lgkmcnt(5)
    v_smfmac_f32_16x16x64_bf16 v[48:51], v[116:119], a[216:223], v1
    ds_read_b128 v[104:107], v7 offset:34816
    s_waitcnt lgkmcnt(5)
    v_smfmac_f32_16x16x64_bf16 v[48:51], v[120:123], v[80:87], v1
    ds_read_b128 v[108:111], v7 offset:35840
    s_waitcnt lgkmcnt(4)
    v_smfmac_f32_16x16x64_bf16 v[48:51], v[124:127], v[88:95], v1
    ds_read_b128 v[64:67], v7 offset:16384
    v_smfmac_f32_16x16x64_bf16 v[52:55], v[112:115], a[224:231], v1
    ds_read_b128 v[68:71], v7 offset:17408
    v_smfmac_f32_16x16x64_bf16 v[52:55], v[116:119], a[232:239], v1
    ds_read_b128 v[72:75], v7 offset:49152
    s_waitcnt lgkmcnt(5)
    v_smfmac_f32_16x16x64_bf16 v[52:55], v[120:123], v[96:103], v1
    ds_read_b128 v[76:79], v7 offset:50176
    v_cvt_pk_bf16_f32 v48, v48, v49
    s_waitcnt lgkmcnt(4)
    v_smfmac_f32_16x16x64_bf16 v[52:55], v[124:127], v[104:111], v1
    ds_read_b128 v[24:27], v7 offset:18432
    v_cvt_pk_bf16_f32 v49, v50, v51
    v_smfmac_f32_16x16x64_bf16 v[56:59], v[112:115], a[240:247], v1
    ds_read_b128 v[28:31], v7 offset:19456
    v_bfi_b32 v48, 1, s24, v48
    v_smfmac_f32_16x16x64_bf16 v[56:59], v[116:119], a[248:255], v1
    ds_read_b128 v[36:39], v7 offset:51200
    s_waitcnt lgkmcnt(5)
    v_smfmac_f32_16x16x64_bf16 v[56:59], v[120:123], v[64:71], v1
    ds_read_b128 v[40:43], v7 offset:52224
    v_cvt_pk_bf16_f32 v50, v52, v53
    s_waitcnt lgkmcnt(4)
    v_smfmac_f32_16x16x64_bf16 v[56:59], v[124:127], v[72:79], v1
    v_cvt_pk_bf16_f32 v51, v54, v55
    v_smfmac_f32_16x16x64_bf16 v[60:63], v[112:115], v[128:135], v1
    buffer_store_dwordx4 v[48:51], v9, s[8:11], s21 offen
    v_smfmac_f32_16x16x64_bf16 v[60:63], v[116:119], v[136:143], v1
    v_xor_b32 v7, 0x10000, v7
    s_waitcnt lgkmcnt(2)
    v_smfmac_f32_16x16x64_bf16 v[60:63], v[120:123], v[24:31], v1
    v_cvt_pk_bf16_f32 v56, v56, v57
    s_waitcnt lgkmcnt(0)
    v_smfmac_f32_16x16x64_bf16 v[60:63], v[124:127], v[36:43], v1
    v_cvt_pk_bf16_f32 v57, v58, v59
    v_bfi_b32 v56, 1, s24, v56
    s_add_u32 s20, s20, 1
    s_mov_b32 m0, s41
    s_cmp_eq_u32 s3, 0
    s_nop 2
    v_cvt_pk_bf16_f32 v58, v60, v61
    v_cvt_pk_bf16_f32 v59, v62, v63
    buffer_store_dwordx4 v[56:59], v9, s[8:11], s22 offen
    s_cbranch_scc1 L_chw0_116
    s_waitcnt vmcnt(2)
    s_add_u32 s32, s32, 1
    s_min_u32 s32, s32, s40
    s_and_b64 exec, s[72:73], 3
    v_cmp_gt_u32 vcc, s32, v32
    s_mov_b64 exec, -1
    ds_read_b128 v[80:83], v7 offset:0
    ds_read_b128 v[84:87], v7 offset:1024
    ds_read_b128 v[88:91], v7 offset:2048
    ds_read_b128 v[92:95], v7 offset:3072
    ds_read_b128 v[96:99], v7 offset:16384
    ds_read_b128 v[100:103], v7 offset:17408
    ds_read_b128 v[104:107], v7 offset:18432
    ds_read_b128 v[108:111], v7 offset:19456
    ds_read_b128 v[112:115], v7 offset:32768
    ds_read_b128 v[116:119], v7 offset:33792
    ds_read_b128 v[120:123], v7 offset:34816
    ds_read_b128 v[124:127], v7 offset:35840
    v_add_u32 v46, s41, v0
    v_lshlrev_b32 v43, 2, v0
    s_cbranch_vccz L_chf1_117
    s_mov_b32 s33, 0
L_fw_118:
    s_mov_b64 exec, 3
    buffer_load_dword v32, v0, s[8:11], s39 offen sc1
    s_mov_b64 exec, -1
    s_add_u32 s33, s33, 1
    s_cmp_gt_u32 s33, 100000
    s_cbranch_scc1 L_fail
    s_waitcnt vmcnt(0)
    s_mov_b64 exec, 3
    v_cmp_gt_u32 vcc, s32, v32
    s_mov_b64 exec, -1
    s_cbranch_vccnz L_fw_118
L_chf1_117:
    v_mov_b64 v[32:33], 0
    v_mov_b64 v[34:35], 0
    v_mov_b64 v[24:25], 0
    v_mov_b64 v[26:27], 0
    v_mov_b64 v[28:29], 0
    v_mov_b64 v[30:31], 0
    v_mov_b64 v[36:37], 0
    v_mov_b64 v[38:39], 0
    s_waitcnt lgkmcnt(0)
    s_branch L_chhead_104
L_chw0_116:
    ds_read_b128 v[28:31], v0 offset:12288
    v_mov_b32 v36, s36
    v_mov_b32 v37, s36
    buffer_store_dwordx2 v[36:37], v8, s[8:11], s27 offen
    s_add_u32 s35, s23, 4096
    s_mov_b64 s[74:75], -1
    s_mov_b32 s33, 0
    s_nop 15
    s_nop 15
    s_nop 15
    s_nop 15
    s_nop 11
    buffer_load_dwordx4 v[48:51], v0, s[8:11], s23 offen offset:0 sc1
    buffer_load_dwordx4 v[52:55], v0, s[8:11], s23 offen offset:1024 sc1
    buffer_load_dwordx4 v[56:59], v0, s[8:11], s23 offen offset:2048 sc1
    buffer_load_dwordx4 v[60:63], v0, s[8:11], s23 offen offset:3072 sc1
    buffer_load_dwordx4 v[64:67], v0, s[8:11], s35 offen offset:0 sc1
    buffer_load_dwordx4 v[68:71], v0, s[8:11], s35 offen offset:1024 sc1
    buffer_load_dwordx4 v[72:75], v0, s[8:11], s35 offen offset:2048 sc1
    buffer_load_dwordx4 v[76:79], v0, s[8:11], s35 offen offset:3072 sc1
    s_waitcnt vmcnt(11)
    s_add_u32 s32, s32, 1
    s_min_u32 s32, s32, s40
    s_and_b64 exec, s[72:73], 3
    v_cmp_gt_u32 vcc, s32, v32
    s_mov_b64 exec, -1
    ds_read_b128 v[80:83], v7 offset:0
    ds_read_b128 v[84:87], v7 offset:1024
    ds_read_b128 v[88:91], v7 offset:2048
    ds_read_b128 v[92:95], v7 offset:3072
    ds_read_b128 v[96:99], v7 offset:16384
    ds_read_b128 v[100:103], v7 offset:17408
    ds_read_b128 v[104:107], v7 offset:18432
    ds_read_b128 v[108:111], v7 offset:19456
    ds_read_b128 v[112:115], v7 offset:32768
    ds_read_b128 v[116:119], v7 offset:33792
    ds_read_b128 v[120:123], v7 offset:34816
    ds_read_b128 v[124:127], v7 offset:35840
    v_add_u32 v46, s41, v0
    v_lshlrev_b32 v43, 2, v0
    s_cbranch_vccz L_chf1_121
    s_mov_b32 s33, 0
L_fw_122:
    s_mov_b64 exec, 3
    buffer_load_dword v32, v0, s[8:11], s39 offen sc1
    s_mov_b64 exec, -1
    s_add_u32 s33, s33, 1
    s_cmp_gt_u32 s33, 100000
    s_cbranch_scc1 L_fail
    s_waitcnt vmcnt(0)
    s_mov_b64 exec, 3
    v_cmp_gt_u32 vcc, s32, v32
    s_mov_b64 exec, -1
    s_cbranch_vccnz L_fw_122
L_chf1_121:
    v_mov_b64 v[32:33], 0
    v_mov_b64 v[34:35], 0
    s_waitcnt vmcnt(7) lgkmcnt(0)
    v_mfma_f32_16x16x32_bf16 v[24:27], v[48:51], v[28:31], 0
    s_waitcnt vmcnt(6)
    v_mfma_f32_16x16x32_bf16 v[24:27], v[52:55], v[28:31], v[24:27]
    v_bitop3_b32 v36, v48, v52, s24 bitop3:0x7e
    s_waitcnt vmcnt(5)
    v_mfma_f32_16x16x32_bf16 v[24:27], v[56:59], v[28:31], v[24:27]
    s_waitcnt vmcnt(4)
    v_mfma_f32_16x16x32_bf16 v[24:27], v[60:63], v[28:31], v[24:27]
    v_bitop3_b32 v37, v56, v60, s24 bitop3:0x7e
    s_waitcnt vmcnt(3)
    v_mfma_f32_16x16x32_bf16 v[24:27], v[64:67], v[28:31], v[24:27]
    s_waitcnt vmcnt(2)
    v_mfma_f32_16x16x32_bf16 v[24:27], v[68:71], v[28:31], v[24:27]
    v_bitop3_b32 v38, v64, v68, s24 bitop3:0x7e
    v_or3_b32 v36, v36, v37, v38
    s_waitcnt vmcnt(1)
    v_mfma_f32_16x16x32_bf16 v[24:27], v[72:75], v[28:31], v[24:27]
    s_waitcnt vmcnt(0)
    v_mfma_f32_16x16x32_bf16 v[24:27], v[76:79], v[28:31], v[24:27]
    v_bitop3_b32 v39, v72, v76, s24 bitop3:0x7e
    v_or_b32 v36, v36, v39
    v_and_b32 v36, 1, v36
    v_cmp_ne_u32 vcc, 0, v36
    s_nop 3
    v_cvt_pk_bf16_f32 v44, v24, v25
    v_cvt_pk_bf16_f32 v45, v26, v27
    s_cbranch_vccnz L_chp_115
L_chok_119:
    buffer_store_dwordx2 v[44:45], v8, s[8:11], s25 offen
    s_barrier
    s_cmp_eq_u32 s20, 63
    s_cbranch_scc1 L_chlast_105
    ds_write_b64 v8, v[44:45] offset:13824
    v_mov_b64 v[24:25], 0
    v_mov_b64 v[26:27], 0
    v_mov_b64 v[28:29], 0
    v_mov_b64 v[30:31], 0
    v_mov_b64 v[36:37], 0
    v_mov_b64 v[38:39], 0
    s_branch L_chh0_111
L_chp_115:
    buffer_load_dwordx4 v[48:51], v0, s[8:11], s23 offen offset:0 sc1
    buffer_load_dwordx4 v[52:55], v0, s[8:11], s23 offen offset:1024 sc1
    buffer_load_dwordx4 v[56:59], v0, s[8:11], s23 offen offset:2048 sc1
    buffer_load_dwordx4 v[60:63], v0, s[8:11], s23 offen offset:3072 sc1
    buffer_load_dwordx4 v[64:67], v0, s[8:11], s35 offen offset:0 sc1
    buffer_load_dwordx4 v[68:71], v0, s[8:11], s35 offen offset:1024 sc1
    buffer_load_dwordx4 v[72:75], v0, s[8:11], s35 offen offset:2048 sc1
    buffer_load_dwordx4 v[76:79], v0, s[8:11], s35 offen offset:3072 sc1
    s_waitcnt vmcnt(7) lgkmcnt(0)
    v_mfma_f32_16x16x32_bf16 v[24:27], v[48:51], v[28:31], 0
    s_waitcnt vmcnt(6)
    v_mfma_f32_16x16x32_bf16 v[24:27], v[52:55], v[28:31], v[24:27]
    v_bitop3_b32 v36, v48, v52, s24 bitop3:0x7e
    s_waitcnt vmcnt(5)
    v_mfma_f32_16x16x32_bf16 v[24:27], v[56:59], v[28:31], v[24:27]
    s_waitcnt vmcnt(4)
    v_mfma_f32_16x16x32_bf16 v[24:27], v[60:63], v[28:31], v[24:27]
    v_bitop3_b32 v37, v56, v60, s24 bitop3:0x7e
    s_waitcnt vmcnt(3)
    v_mfma_f32_16x16x32_bf16 v[24:27], v[64:67], v[28:31], v[24:27]
    s_waitcnt vmcnt(2)
    v_mfma_f32_16x16x32_bf16 v[24:27], v[68:71], v[28:31], v[24:27]
    v_bitop3_b32 v38, v64, v68, s24 bitop3:0x7e
    v_or3_b32 v36, v36, v37, v38
    s_waitcnt vmcnt(1)
    v_mfma_f32_16x16x32_bf16 v[24:27], v[72:75], v[28:31], v[24:27]
    s_waitcnt vmcnt(0)
    v_mfma_f32_16x16x32_bf16 v[24:27], v[76:79], v[28:31], v[24:27]
    v_bitop3_b32 v39, v72, v76, s24 bitop3:0x7e
    v_or_b32 v36, v36, v39
    v_and_b32 v36, 1, v36
    v_cmp_ne_u32 vcc, 0, v36
    s_nop 3
    v_cvt_pk_bf16_f32 v44, v24, v25
    v_cvt_pk_bf16_f32 v45, v26, v27
    s_cbranch_vccz L_chok_119
    s_add_u32 s33, s33, 1
    s_cmp_gt_u32 s33, 100000
    s_cbranch_scc0 L_chp_115
    s_branch L_fail
L_chvx_112:
    buffer_load_dwordx4 v0, s[8:11], s26 offen sc1 lds
    buffer_load_dwordx4 v0, s[8:11], s26 offen offset:1024 sc1 lds
    s_mov_b32 s33, 0
L_chq_123:
    s_waitcnt vmcnt(2)
    ds_read2st64_b32 v[40:41], v46 offset0:0 offset1:4
    buffer_load_dwordx4 v0, s[8:11], s26 offen sc1 lds
    buffer_load_dwordx4 v0, s[8:11], s26 offen offset:1024 sc1 lds
    s_add_u32 s33, s33, 1
    s_waitcnt lgkmcnt(0)
    v_cmp_u_f32 vcc, v40, v41
    s_cbranch_vccz L_chqo_124
    v_cmp_eq_u32 vcc, s36, v40
    v_cmp_eq_u32 s[100:101], s36, v41
    s_nop 0
    s_or_b64 vcc, vcc, s[100:101]
    s_cbranch_vccz L_chqo_124
    s_cmp_gt_u32 s33, 100000
    s_cbranch_scc0 L_chq_123
    s_branch L_fail
L_chqo_124:
    s_branch L_chA_106
L_chX_113:
    ds_read_b64 v[34:35], v8 offset:13824
    s_waitcnt lgkmcnt(1)
    v_mfma_f32_16x16x32_bf16 v[24:27], v[96:99], v[80:83], 0
    v_xor_b32 v7, 0x10000, v7
    v_mfma_f32_16x16x32_bf16 v[24:27], v[100:103], v[84:87], v[24:27]
    buffer_load_dwordx4 v0, s[8:11], s28 offen offset:0 sc1 lds
    v_mfma_f32_16x16x32_bf16 v[24:27], v[104:107], v[88:91], v[24:27]
    s_mov_b64 exec, 3
    buffer_load_dword v32, v0, s[8:11], s39 offen sc1
    s_mov_b64 exec, -1
    v_mfma_f32_16x16x32_bf16 v[24:27], v[108:111], v[92:95], v[24:27]
    v_smfmac_f32_16x16x64_bf16 v[44:47], v[64:67], v[208:215], v1
    s_waitcnt lgkmcnt(0)
    s_mov_b64 exec, s[74:75]
    buffer_store_dwordx2 v[34:35], v8, s[8:11], s29 offen sc1
    s_mov_b64 exec, -1
    v_smfmac_f32_16x16x64_bf16 v[44:47], v[68:71], v[224:231], v1
    s_add_u32 s29, s29, 8192
    v_exp_f32 v28, v24
    v_smfmac_f32_16x16x64_bf16 v[44:47], v[72:75], v[240:247], v1
    v_exp_f32 v29, v25
    v_smfmac_f32_16x16x64_bf16 v[44:47], v[76:79], v[112:119], v1
    v_exp_f32 v30, v26
    v_smfmac_f32_16x16x64_bf16 v[40:43], v[48:51], v[152:159], v1
    v_exp_f32 v31, v27
    v_smfmac_f32_16x16x64_bf16 v[40:43], v[52:55], v[168:175], v1
    v_cvt_pk_bf16_f32 v28, v28, v29
    v_cvt_pk_bf16_f32 v29, v30, v31
    ds_write_b64 v6, v[28:29]
    v_smfmac_f32_16x16x64_bf16 v[40:43], v[56:59], v[184:191], v1
    buffer_load_dwordx4 v0, s[8:11], s28 offen offset:1024 sc1 lds
    v_smfmac_f32_16x16x64_bf16 v[40:43], v[60:63], v[200:207], v1
    s_waitcnt lgkmcnt(0)
    s_barrier
    s_branch L_chJ_114
L_chfb_109:
    s_nop 15
    s_lshl_b32 s35, s3, 10
    v_add_u32 v31, s35, v0
    s_cmp_lt_u32 s3, 2
    s_cbranch_scc0 L_chf2_126
    ds_write_b128 v31, v[24:27] offset:0
    s_branch L_chf3_127
L_chf2_126:
    ds_write_b128 v31, v[36:39] offset:0
L_chf3_127:
    s_waitcnt vmcnt(0) lgkmcnt(0)
    s_barrier
    ds_read_b128 v[112:115], v0 offset:0
    ds_read_b128 v[116:119], v0 offset:1024
    ds_read_b128 v[36:39], v0 offset:2048
    s_waitcnt lgkmcnt(0)
    v_max3_f32 v30, v112, v113, v114
    v_max3_f32 v30, v30, v115, v116
    v_max3_f32 v30, v30, v117, v118
    v_max3_f32 v30, v30, v119, v36
    v_max_f32 v30, v30, v37
    v_mov_b32 v31, v30
    s_nop 1
    v_permlane32_swap_b32 v30, v31
    v_max_f32 v30, v30, v31
    v_mov_b32 v31, v30
    s_nop 1
    v_permlane16_swap_b32 v30, v31
    v_max_f32 v30, v30, v31
    v_sub_f32 v112, v112, v30
    v_exp_f32 v112, v112
    v_sub_f32 v113, v113, v30
    v_exp_f32 v113, v113
    v_sub_f32 v114, v114, v30
    v_exp_f32 v114, v114
    v_sub_f32 v115, v115, v30
    v_exp_f32 v115, v115
    v_sub_f32 v116, v116, v30
    v_exp_f32 v116, v116
    v_sub_f32 v117, v117, v30
    v_exp_f32 v117, v117
    v_sub_f32 v118, v118, v30
    v_exp_f32 v118, v118
    v_sub_f32 v119, v119, v30
    v_exp_f32 v119, v119
    v_cvt_pk_bf16_f32 v124, v112, v113
    v_cvt_pk_bf16_f32 v125, v114, v115
    v_cvt_pk_bf16_f32 v126, v116, v117
    v_cvt_pk_bf16_f32 v127, v118, v119
    v_sub_f32 v38, v36, v30
    v_exp_f32 v38, v38
    v_sub_f32 v39, v37, v30
    v_exp_f32 v39, v39
    s_nop 0
    v_cvt_pk_bf16_f32 v28, v38, v39
    v_mov_b32 v29, v28
    s_nop 1
    v_permlane32_swap_b32 v28, v29
    s_waitcnt vmcnt(0)
    v_mfma_f32_16x16x32_bf16 v[120:123], v[12:15], v[124:127], 0
    v_mfma_f32_16x16x32_bf16 v[112:115], v[16:19], v[124:127], 0
    v_mfma_f32_16x16x32_bf16 v[116:119], v[20:23], v[124:127], 0
    v_mfma_f32_16x16x16_bf16 v[120:123], v[10:11], v[28:29], v[120:123]
    v_mfma_f32_16x16x16_bf16 v[112:115], v[44:45], v[28:29], v[112:115]
    v_mfma_f32_16x16x16_bf16 v[116:119], v[46:47], v[28:29], v[116:119]
    s_nop 11
    v_rcp_f32 v30, v120
    s_nop 0
    v_mul_f32 v112, v112, v30
    v_mul_f32 v113, v113, v30
    v_mul_f32 v114, v114, v30
    v_mul_f32 v115, v115, v30
    v_mul_f32 v116, v116, v30
    v_mul_f32 v117, v117, v30
    v_mul_f32 v118, v118, v30
    v_mul_f32 v119, v119, v30
    v_cvt_pk_bf16_f32 v112, v112, v113
    v_cvt_pk_bf16_f32 v113, v114, v115
    v_cvt_pk_bf16_f32 v116, v116, v117
    v_cvt_pk_bf16_f32 v117, v118, v119
    ds_write_b64 v5, v[112:113]
    buffer_load_dwordx4 v[16:19], v0, s[8:11], s34 offen offset:0 sc1
    s_branch L_chfr_110
L_chlast_105:
    s_mov_b64 exec, s[74:75]
    buffer_store_dwordx2 v[44:45], v8, s[8:11], s29 offen sc1
    s_mov_b64 exec, -1
    s_branch L_done
L_fail:
    v_mov_b32 v1, 1
    s_mov_b64 exec, 1
    buffer_atomic_add v1, off, s[16:19], 0 offset:64 sc1
L_done:
    s_waitcnt vmcnt(0)
L_end:
    s_endpgm
.section .rodata,"a"
.p2align 6
.amdhsa_kernel adaLN_cond__memory_aug_recurrent_mem_tr__dense_activation_silu__prompt_kernel
  .amdhsa_next_free_vgpr 512
  .amdhsa_next_free_sgpr 102
  .amdhsa_accum_offset 256
  .amdhsa_group_segment_fixed_size 0
  .amdhsa_kernarg_size 120
  .amdhsa_user_sgpr_count 2
  .amdhsa_user_sgpr_kernarg_segment_ptr 1
  .amdhsa_system_sgpr_workgroup_id_x 1
.end_amdhsa_kernel
```
